```python
import torch

def _softmax(x, axis=-1):
    return torch.softmax(x, dim=axis)
def _gelu(x):
    return torch.nn.functional.gelu(x, approximate="tanh")
def _silu(x):
    return torch.nn.functional.silu(x)
def _sigmoid(x):
    return torch.sigmoid(x)
def _layernorm(x, axis=-1, eps=1e-5):
    m = x.mean(dim=axis, keepdim=True)
    v = x.var(dim=axis, keepdim=True, unbiased=False)
    return (x - m) / torch.sqrt(v + eps)
def _scatter_add(tgt, idx, src, axis=0):
    return tgt.clone().index_add_(axis, idx, src)
def _segment_sum(src, seg, n):
    out = torch.zeros((n,) + src.shape[1:], dtype=src.dtype)
    return out.index_add_(0, seg, src)
def _pad(x, pw):
    flat = tuple(v for pair in reversed(pw) for v in pair)
    return torch.nn.functional.pad(x, flat)

kernel_name = 'concat_heads__mha_block_cached__mha_block_cached__near_ridge'

def setup_inputs():

    _w = (lambda a: (lambda t: t.to(torch.bfloat16) if t.is_floating_point() else t)(torch.as_tensor(a)))
    def _A_setup():
        B, Sq, D = 8, 144, 640
        H, Sk, Dh = 32, 512, 192
        return {
            "x": _w((lambda *s: torch.randn(*s, dtype=torch.bfloat16) * 0.8)(B, Sq, D)),
            "k_cache": _w((lambda *s: torch.randn(*s, dtype=torch.bfloat16) * 0.8)(B, H, Sk, Dh)),
            "v_cache": _w((lambda *s: torch.randn(*s, dtype=torch.bfloat16) * 0.05)(B, H, Sk, Dh)),
            "wq": _w((lambda *s: torch.randn(*s, dtype=torch.bfloat16) * 0.8)(D, H * Dh) * (D ** -0.5)),
            "wo": _w((lambda *s: torch.randn(*s, dtype=torch.bfloat16) * 0.05)(H * Dh, D) * ((H * Dh) ** -0.5)),
        }
    _A_in = _A_setup()

    def _B_setup():
        B, Sq, D = 8, 144, 640
        H, Sk, Dh = 32, 512, 192
        return {
            "x": _w((lambda *s: torch.randn(*s, dtype=torch.bfloat16) * 0.8)(B, Sq, D)),
            "k_cache": _w((lambda *s: torch.randn(*s, dtype=torch.bfloat16) * 0.8)(B, H, Sk, Dh)),
            "v_cache": _w((lambda *s: torch.randn(*s, dtype=torch.bfloat16) * 0.05)(B, H, Sk, Dh)),
            "wq": _w((lambda *s: torch.randn(*s, dtype=torch.bfloat16) * 0.8)(D, H * Dh) * (D ** -0.5)),
            "wo": _w((lambda *s: torch.randn(*s, dtype=torch.bfloat16) * 0.05)(H * Dh, D) * ((H * Dh) ** -0.5)),
        }
    _B_in = _B_setup()

    return {
        "A_x": _A_in["x"],
        "A_k_cache": _A_in["k_cache"],
        "A_v_cache": _A_in["v_cache"],
        "A_wq": _A_in["wq"],
        "A_wo": _A_in["wo"],
        "B_x": _B_in["x"],
        "B_k_cache": _B_in["k_cache"],
        "B_v_cache": _B_in["v_cache"],
        "B_wq": _B_in["wq"],
        "B_wo": _B_in["wo"],
    }

def reference(A_x, A_k_cache, A_v_cache, A_wq, A_wo, B_x, B_k_cache, B_v_cache, B_wq, B_wo):
    def _A_ref(x, k_cache, v_cache, wq, wo):
        B, Sq, D = x.shape
        H, Dh = 32, 192
        q = (lambda x, *d: x.permute(*d))((x @ wq).reshape(B, Sq, H, Dh), 0, 2, 1, 3)
        scores = torch.einsum("bhqd,bhkd->bhqk", q, k_cache) * (Dh ** -0.5)
        p = _softmax(scores, axis=-1)
        o = torch.einsum("bhqk,bhkd->bhqd", p, v_cache)
        return (lambda x, *d: x.permute(*d))(o, 0, 2, 1, 3).reshape(B, Sq, H * Dh) @ wo

    def _B_ref(x, k_cache, v_cache, wq, wo):
        B, Sq, D = x.shape
        H, Dh = 32, 192
        q = (lambda x, *d: x.permute(*d))((x @ wq).reshape(B, Sq, H, Dh), 0, 2, 1, 3)
        scores = torch.einsum("bhqd,bhkd->bhqk", q, k_cache) * (Dh ** -0.5)
        p = _softmax(scores, axis=-1)
        o = torch.einsum("bhqk,bhkd->bhqd", p, v_cache)
        return (lambda x, *d: x.permute(*d))(o, 0, 2, 1, 3).reshape(B, Sq, H * Dh) @ wo

    a = _A_ref(A_x, A_k_cache, A_v_cache, A_wq, A_wo)
    b = _B_ref(B_x, B_k_cache, B_v_cache, B_wq, B_wo)
    return torch.concatenate([a, b], axis=-1)
```

```asm
; @launch kernel=attn_kernel grid=(256,1,1) block=(512,1,1) lds=163840
; @launch kernel=oproj_kernel grid=(256,1,1) block=(512,1,1) lds=116736
.amdgcn_target "amdgcn-amd-amdhsa--gfx950"
.text
.globl attn_kernel
.p2align 8
.type attn_kernel,@function
attn_kernel:
    s_cmp_ge_u32 s2, 256
    s_cbranch_scc1 LA_end
    s_and_b32 s27, s2, 7
    s_lshr_b32 s54, s27, 2
    s_mul_i32 s29, s54, 40
    s_add_u32 s28, s0, s29
    s_addc_u32 s29, s1, 0
    s_load_dwordx8 s[44:51], s[28:29], 0
    s_load_dwordx2 s[52:53], s[0:1], 96
    s_load_dwordx2 s[64:65], s[28:29], 32
    s_lshr_b32 s30, s2, 3
    s_and_b32 s56, s27, 3
    s_lshl_b32 s56, s56, 3
    s_and_b32 s58, s30, 7
    s_add_u32 s56, s56, s58
    s_lshr_b32 s55, s30, 3
    s_and_b32 s35, s58, 1
    s_cselect_b32 s35, 2, 0
    s_lshr_b32 s43, s58, 1
    s_add_u32 s43, s43, s55
    s_and_b32 s43, s43, 3
    s_mul_i32 s43, s43, 5
    s_lshr_b32 s43, s43, 1
    s_mov_b32 s59, 0
    v_lshrrev_b32 v3, 6, v0
    v_and_b32 v0, 63, v0
    v_readfirstlane_b32 s24, v3
    v_lshlrev_b32 v1, 4, v0
    s_mov_b32 s36, 0x3dd53b95
    s_and_b32 s25, s24, 3
    s_lshr_b32 s26, s24, 2
    s_lshl_b32 s37, s24, 13
    s_add_u32 s37, s37, 0x18000
    s_lshl_b32 s34, s25, 10
    s_mul_i32 s33, s25, 4608
    s_mul_i32 s30, s25, 3
    s_add_u32 s30, s30, 0
    s_and_b32 s96, s30, 3
    s_lshr_b32 s99, s30, 2
    s_lshl_b32 s99, s99, 12
    s_lshr_b32 s57, s30, 1
    s_mul_i32 s57, s57, 9216
    s_and_b32 s30, s30, 1
    s_lshl_b32 s30, s30, 9
    s_add_u32 s40, s30, s57
    s_mul_i32 s30, s25, 3
    s_add_u32 s30, s30, 1
    s_and_b32 s97, s30, 3
    s_lshr_b32 s100, s30, 2
    s_lshl_b32 s100, s100, 12
    s_lshr_b32 s57, s30, 1
    s_mul_i32 s57, s57, 9216
    s_and_b32 s30, s30, 1
    s_lshl_b32 s30, s30, 9
    s_add_u32 s41, s30, s57
    s_mul_i32 s30, s25, 3
    s_add_u32 s30, s30, 2
    s_and_b32 s98, s30, 3
    s_lshr_b32 s101, s30, 2
    s_lshl_b32 s101, s101, 12
    s_lshr_b32 s57, s30, 1
    s_mul_i32 s57, s57, 9216
    s_and_b32 s30, s30, 1
    s_lshl_b32 s30, s30, 9
    s_add_u32 s42, s30, s57
    s_mul_i32 s30, s24, 60
    v_min_u32 v4, 59, v0
    v_add_u32 v4, s30, v4
    v_mul_u32_u24 v5, 0x2ab, v4
    v_lshrrev_b32 v5, 11, v5
    v_mul_u32_u24 v6, 3, v5
    v_sub_u32 v4, v4, v6
    s_mul_i32 s30, s55, 160
    v_add_u32 v5, s30, v5
    v_mul_u32_u24 v16, 0x3000, v5
    v_lshl_add_u32 v16, v4, 7, v16
    s_lshr_b32 s30, s58, 1
    s_mul_i32 s30, s30, 360
    s_mul_i32 s57, s24, 45
    s_add_u32 s30, s30, s57
    v_min_u32 v4, 44, v0
    v_add_u32 v4, s30, v4
    v_lshlrev_b32 v17, 7, v4
    v_lshrrev_b32 v4, 4, v0
    v_lshrrev_b32 v5, 3, v0
    s_lshl_b32 s30, s25, 3
    v_add_u32 v5, s30, v5
    v_bfe_u32 v6, v0, 1, 2
    v_and_b32 v7, 1, v4
    v_xor_b32 v6, v6, v7
    s_and_b32 s30, s25, 1
    s_lshl_b32 s30, s30, 1
    v_xor_b32 v6, s30, v6
    v_and_b32 v7, 1, v0
    v_lshlrev_b32 v7, 4, v7
    v_lshl_add_u32 v6, v6, 5, v7
    v_mul_u32_u24 v154, 0x3000, v5
    v_add_u32 v154, v154, v6
    v_mul_u32_u24 v2, 0x180, v5
    v_add_u32 v2, v2, v6
    s_mul_i32 s30, s25, 36
    v_lshrrev_b32 v5, 3, v0
    v_add_u32 v5, s30, v5
    v_bfe_u32 v6, v5, 1, 3
    v_and_b32 v7, 7, v0
    v_xor_b32 v6, v6, v7
    v_lshlrev_b32 v6, 4, v6
    v_mul_u32_u24 v5, 0x500, v5
    v_add_u32 v152, v5, v6
    v_xor_b32 v6, 64, v6
    v_add_u32 v153, v5, v6
    s_waitcnt lgkmcnt(0)
    s_mul_i32 s30, s55, 184320
    s_add_u32 s4, s44, s30
    s_addc_u32 s5, s45, 0
    s_mov_b32 s6, 184320
    s_mov_b32 s7, 0x20000
    s_mul_i32 s30, s56, 384
    s_add_u32 s8, s50, s30
    s_addc_u32 s9, s51, 0
    s_sub_u32 s10, 7864320, s30
    s_mov_b32 s11, 0x20000
    buffer_load_dword v17, v17, s[4:7], 0 offen
    buffer_load_dword v18, v16, s[8:11], 0 offen
LA_tt_1:
    s_lshl_b32 s30, s55, 5
    s_add_u32 s30, s30, s56
    s_lshl_b32 s57, s54, 8
    s_add_u32 s57, s57, s30
    s_mul_i32 s57, s57, 55296
    s_add_u32 s20, s52, s57
    s_addc_u32 s21, s53, 0
    s_mov_b32 s22, 55296
    s_mov_b32 s23, 0x20000
    s_mul_i32 s30, s30, 196608
    s_add_u32 s12, s46, s30
    s_addc_u32 s13, s47, 0
    s_mov_b32 s14, 196608
    s_mov_b32 s15, 0x20000
    s_add_u32 s16, s48, s30
    s_addc_u32 s17, s49, 0
    s_mov_b32 s18, 196608
    s_mov_b32 s19, 0x20000
    s_add_u32 s44, s4, 737280
    s_addc_u32 s45, s5, 0
    s_mov_b32 s46, 184320
    s_mov_b32 s47, 0x20000
    s_cmp_lt_u32 s2, 64
    s_cbranch_scc0 LA_z_2
    s_cmp_eq_u32 s24, 0
    s_cbranch_scc0 LA_z_2
    s_add_u32 s48, s52, 0x3f00000
    s_addc_u32 s49, s53, 0
    s_mov_b32 s50, 8192
    s_mov_b32 s51, 0x20000
    s_lshl_b32 s30, s2, 7
    v_mov_b32 v3, 0
    buffer_store_dword v3, off, s[48:51], s30
LA_z_2:
    s_lshr_b32 s30, s56, 3
    s_lshl_b32 s30, s30, 5
    s_lshr_b32 s57, s2, 3
    s_add_u32 s30, s30, s57
    s_mul_i32 s30, s30, 61440
    s_add_u32 s48, s64, s30
    s_addc_u32 s49, s65, 0
    s_mov_b32 s50, 61440
    s_mov_b32 s51, 0x20000
    s_lshl_b32 s31, s43, 7
    s_mul_i32 s32, s43, 0xc0000
    s_lshl_b32 s30, s24, 1
    s_add_u32 s30, s30, 0
    s_mul_i32 s57, s30, 43
    s_lshr_b32 s57, s57, 7
    s_mul_i32 s29, s57, 3
    s_sub_u32 s29, s30, s29
    s_lshl_b32 s29, s29, 7
    s_add_u32 s2, s57, 2
    s_add_u32 s57, s57, 6
    s_and_b32 s57, s57, 7
    s_mul_i32 s57, s57, 24576
    s_add_u32 s0, s57, s29
    s_cmp_ge_u32 s30, 15
    s_cselect_b32 s0, 0x100000, s0
    s_lshl_b32 s30, s24, 1
    s_add_u32 s30, s30, 1
    s_mul_i32 s57, s30, 43
    s_lshr_b32 s57, s57, 7
    s_mul_i32 s29, s57, 3
    s_sub_u32 s29, s30, s29
    s_lshl_b32 s29, s29, 7
    s_add_u32 s3, s57, 2
    s_add_u32 s57, s57, 6
    s_and_b32 s57, s57, 7
    s_mul_i32 s57, s57, 24576
    s_add_u32 s1, s57, s29
    s_cmp_ge_u32 s30, 15
    s_cselect_b32 s1, 0x100000, s1
    v_lshrrev_b32 v4, 4, v0
    v_and_b32 v5, 15, v0
    v_lshrrev_b32 v6, 4, v0
    v_bfe_u32 v7, v0, 2, 2
    v_lshl_add_u32 v6, v6, 3, v7
    v_and_b32 v7, 3, v0
    v_lshlrev_b32 v7, 3, v7
    v_lshl_add_u32 v6, v6, 7, v7
    v_bfe_u32 v7, v0, 3, 2
    v_xor_b32 v140, s96, v7
    v_lshl_add_u32 v140, v140, 5, v6
    s_add_u32 s30, s99, 0x4800
    v_add_u32 v140, s30, v140
    v_xor_b32 v141, s97, v7
    v_lshl_add_u32 v141, v141, 5, v6
    s_add_u32 s30, s100, 0x4800
    v_add_u32 v141, s30, v141
    v_xor_b32 v142, s98, v7
    v_lshl_add_u32 v142, v142, 5, v6
    s_add_u32 s30, s101, 0x4800
    v_add_u32 v142, s30, v142
    v_add_u32 v143, 0x15000, v140
    v_add_u32 v144, 0x15000, v141
    v_add_u32 v145, 0x15000, v142
    v_lshrrev_b32 v6, 1, v5
    v_xor_b32 v6, v6, v4
    v_lshlrev_b32 v6, 4, v6
    v_lshl_add_u32 v146, v5, 7, v6
    v_xor_b32 v147, 64, v146
    v_add_u32 v148, 0x10800, v146
    v_add_u32 v149, 0x10800, v147
    v_add_u32 v14, s37, v146
    v_add_u32 v15, s37, v147
    v_bfe_u32 v5, v0, 5, 1
    v_bfe_u32 v6, v0, 3, 2
    v_lshl_add_u32 v5, v5, 3, v6
    v_mul_u32_u24 v5, 0x180, v5
    s_mul_i32 s30, s24, 24576
    v_add_u32 v5, s30, v5
    v_and_b32 v7, 7, v0
    v_xor_b32 v6, v7, v4
    v_lshlrev_b32 v6, 4, v6
    v_add_u32 v12, v5, v6
    v_xor_b32 v6, 64, v6
    v_add_u32 v13, v5, v6
    v_add_u32 v13, 0x1800, v13
    v_and_b32 v157, 15, v0
    v_lshlrev_b32 v157, 4, v157
    v_lshrrev_b32 v155, 5, v0
    v_lshl_add_u32 v157, v155, 8, v157
    v_bfe_u32 v155, v0, 4, 1
    v_lshl_add_u32 v157, v155, 3, v157
    v_add_u32 v155, s40, v157
    v_add_u32 v156, s41, v157
    v_add_u32 v157, s42, v157
    s_mul_i32 s38, s26, 12288
    s_add_u32 s38, s38, s34
    s_mul_i32 s39, s26, 24576
    s_add_u32 s39, s39, 0x18000
    s_cmp_eq_u32 s35, 0
    s_cbranch_scc1 LA_p1
    s_cmp_eq_u32 s35, 1
    s_cbranch_scc1 LA_kh
    s_mov_b32 s30, 0x0
    s_add_u32 m0, s37, 0x0
    s_nop 0
    buffer_load_dwordx4 v12, s[12:15], s30 offen nt lds
    s_add_u32 m0, s37, 0x400
    s_nop 0
    buffer_load_dwordx4 v13, s[12:15], s30 offen nt lds
    s_mov_b32 s30, 0x600
    s_add_u32 m0, s37, 0x800
    s_nop 0
    buffer_load_dwordx4 v12, s[12:15], s30 offen nt lds
    s_add_u32 m0, s37, 0xc00
    s_nop 0
    buffer_load_dwordx4 v13, s[12:15], s30 offen nt lds
    s_mov_b32 s30, 0x80
    s_add_u32 m0, s37, 0x1000
    s_nop 0
    buffer_load_dwordx4 v12, s[12:15], s30 offen nt lds
    s_add_u32 m0, s37, 0x1400
    s_nop 0
    buffer_load_dwordx4 v13, s[12:15], s30 offen nt lds
    s_mov_b32 s30, 0x680
    s_add_u32 m0, s37, 0x1800
    s_nop 0
    buffer_load_dwordx4 v12, s[12:15], s30 offen nt lds
    s_add_u32 m0, s37, 0x1c00
    s_nop 0
    buffer_load_dwordx4 v13, s[12:15], s30 offen nt lds
    s_waitcnt vmcnt(6)
    ds_read_b128 v[160:163], v14 offset:0
    ds_read_b128 v[164:167], v15 offset:0
    s_waitcnt lgkmcnt(0)
    s_mov_b32 s30, 0x100
    s_add_u32 m0, s37, 0x0
    s_nop 0
    buffer_load_dwordx4 v12, s[12:15], s30 offen nt lds
    s_add_u32 m0, s37, 0x400
    s_nop 0
    buffer_load_dwordx4 v13, s[12:15], s30 offen nt lds
    s_waitcnt vmcnt(6)
    ds_read_b128 v[184:187], v14 offset:2048
    ds_read_b128 v[188:191], v15 offset:2048
    s_waitcnt lgkmcnt(0)
    s_mov_b32 s30, 0x700
    s_add_u32 m0, s37, 0x800
    s_nop 0
    buffer_load_dwordx4 v12, s[12:15], s30 offen nt lds
    s_add_u32 m0, s37, 0xc00
    s_nop 0
    buffer_load_dwordx4 v13, s[12:15], s30 offen nt lds
    s_waitcnt vmcnt(6)
    ds_read_b128 v[168:171], v14 offset:4096
    ds_read_b128 v[172:175], v15 offset:4096
    s_waitcnt lgkmcnt(0)
    s_mov_b32 s30, 0x3000
    s_add_u32 m0, s37, 0x1000
    s_nop 0
    buffer_load_dwordx4 v12, s[12:15], s30 offen nt lds
    s_add_u32 m0, s37, 0x1400
    s_nop 0
    buffer_load_dwordx4 v13, s[12:15], s30 offen nt lds
    s_waitcnt vmcnt(6)
    ds_read_b128 v[192:195], v14 offset:6144
    ds_read_b128 v[196:199], v15 offset:6144
    s_waitcnt lgkmcnt(0)
    s_mov_b32 s30, 0x3600
    s_add_u32 m0, s37, 0x1800
    s_nop 0
    buffer_load_dwordx4 v12, s[12:15], s30 offen nt lds
    s_add_u32 m0, s37, 0x1c00
    s_nop 0
    buffer_load_dwordx4 v13, s[12:15], s30 offen nt lds
    s_waitcnt vmcnt(6)
    ds_read_b128 v[176:179], v14 offset:0
    ds_read_b128 v[180:183], v15 offset:0
    s_waitcnt lgkmcnt(0)
    s_mov_b32 s30, 0x3080
    s_add_u32 m0, s37, 0x0
    s_nop 0
    buffer_load_dwordx4 v12, s[12:15], s30 offen nt lds
    s_add_u32 m0, s37, 0x400
    s_nop 0
    buffer_load_dwordx4 v13, s[12:15], s30 offen nt lds
    s_waitcnt vmcnt(6)
    ds_read_b128 v[200:203], v14 offset:2048
    ds_read_b128 v[204:207], v15 offset:2048
    s_waitcnt lgkmcnt(0)
    s_mov_b32 s30, 0x3680
    s_add_u32 m0, s37, 0x800
    s_nop 0
    buffer_load_dwordx4 v12, s[12:15], s30 offen nt lds
    s_add_u32 m0, s37, 0xc00
    s_nop 0
    buffer_load_dwordx4 v13, s[12:15], s30 offen nt lds
    s_waitcnt vmcnt(6)
    ds_read_b128 v[208:211], v14 offset:4096
    ds_read_b128 v[212:215], v15 offset:4096
    s_waitcnt lgkmcnt(0)
    s_mov_b32 s30, 0x3100
    s_add_u32 m0, s37, 0x1000
    s_nop 0
    buffer_load_dwordx4 v12, s[12:15], s30 offen nt lds
    s_add_u32 m0, s37, 0x1400
    s_nop 0
    buffer_load_dwordx4 v13, s[12:15], s30 offen nt lds
    s_waitcnt vmcnt(6)
    ds_read_b128 v[232:235], v14 offset:6144
    ds_read_b128 v[236:239], v15 offset:6144
    s_waitcnt lgkmcnt(0)
    s_mov_b32 s30, 0x3700
    s_add_u32 m0, s37, 0x1800
    s_nop 0
    buffer_load_dwordx4 v12, s[12:15], s30 offen nt lds
    s_add_u32 m0, s37, 0x1c00
    s_nop 0
    buffer_load_dwordx4 v13, s[12:15], s30 offen nt lds
    s_waitcnt vmcnt(6)
    ds_read_b128 v[216:219], v14 offset:0
    ds_read_b128 v[220:223], v15 offset:0
    s_waitcnt lgkmcnt(0)
    s_waitcnt vmcnt(4)
    ds_read_b128 v[240:243], v14 offset:2048
    ds_read_b128 v[244:247], v15 offset:2048
    s_waitcnt lgkmcnt(0)
    s_waitcnt vmcnt(2)
    ds_read_b128 v[224:227], v14 offset:4096
    ds_read_b128 v[228:231], v15 offset:4096
    s_waitcnt lgkmcnt(0)
    s_waitcnt vmcnt(0)
    ds_read_b128 v[248:251], v14 offset:6144
    ds_read_b128 v[252:255], v15 offset:6144
    s_waitcnt lgkmcnt(0)
    s_branch LA_kd
LA_kh:
    s_mov_b32 s30, 0x0
    s_add_u32 m0, s37, 0x0
    s_nop 0
    buffer_load_dwordx4 v12, s[12:15], s30 offen nt lds
    s_add_u32 m0, s37, 0x400
    s_nop 0
    buffer_load_dwordx4 v13, s[12:15], s30 offen nt lds
    s_mov_b32 s30, 0x600
    s_add_u32 m0, s37, 0x800
    s_nop 0
    buffer_load_dwordx4 v12, s[12:15], s30 offen nt lds
    s_add_u32 m0, s37, 0xc00
    s_nop 0
    buffer_load_dwordx4 v13, s[12:15], s30 offen nt lds
    s_mov_b32 s30, 0x80
    s_add_u32 m0, s37, 0x1000
    s_nop 0
    buffer_load_dwordx4 v12, s[12:15], s30 offen nt lds
    s_add_u32 m0, s37, 0x1400
    s_nop 0
    buffer_load_dwordx4 v13, s[12:15], s30 offen nt lds
    s_mov_b32 s30, 0x680
    s_add_u32 m0, s37, 0x1800
    s_nop 0
    buffer_load_dwordx4 v12, s[12:15], s30 offen nt lds
    s_add_u32 m0, s37, 0x1c00
    s_nop 0
    buffer_load_dwordx4 v13, s[12:15], s30 offen nt lds
    s_waitcnt vmcnt(6)
    ds_read_b128 v[160:163], v14 offset:0
    ds_read_b128 v[164:167], v15 offset:0
    s_waitcnt lgkmcnt(0)
    s_mov_b32 s30, 0x100
    s_add_u32 m0, s37, 0x0
    s_nop 0
    buffer_load_dwordx4 v12, s[12:15], s30 offen nt lds
    s_add_u32 m0, s37, 0x400
    s_nop 0
    buffer_load_dwordx4 v13, s[12:15], s30 offen nt lds
    s_waitcnt vmcnt(6)
    ds_read_b128 v[184:187], v14 offset:2048
    ds_read_b128 v[188:191], v15 offset:2048
    s_waitcnt lgkmcnt(0)
    s_mov_b32 s30, 0x700
    s_add_u32 m0, s37, 0x800
    s_nop 0
    buffer_load_dwordx4 v12, s[12:15], s30 offen nt lds
    s_add_u32 m0, s37, 0xc00
    s_nop 0
    buffer_load_dwordx4 v13, s[12:15], s30 offen nt lds
    s_waitcnt vmcnt(6)
    ds_read_b128 v[168:171], v14 offset:4096
    ds_read_b128 v[172:175], v15 offset:4096
    s_waitcnt lgkmcnt(0)
    s_waitcnt vmcnt(4)
    ds_read_b128 v[192:195], v14 offset:6144
    ds_read_b128 v[196:199], v15 offset:6144
    s_waitcnt lgkmcnt(0)
    s_waitcnt vmcnt(2)
    ds_read_b128 v[176:179], v14 offset:0
    ds_read_b128 v[180:183], v15 offset:0
    s_waitcnt lgkmcnt(0)
    s_waitcnt vmcnt(0)
    ds_read_b128 v[200:203], v14 offset:2048
    ds_read_b128 v[204:207], v15 offset:2048
    s_waitcnt lgkmcnt(0)
LA_kd:
    s_barrier
LA_p1:
    s_cmp_eq_u32 s26, 0
    s_cbranch_scc0 LA_p1_g1
    s_add_u32 m0, s34, 0x4800
    s_nop 0
    buffer_load_dwordx4 v154, s[8:11], s32 offen offset:0 lds
    s_add_u32 m0, s34, 0x5780
    s_nop 0
    buffer_load_dwordx4 v154, s[8:11], s32 offen offset:128 lds
    s_add_u32 m0, s34, 0x6700
    s_nop 0
    buffer_load_dwordx4 v154, s[8:11], s32 offen offset:256 lds
    s_add_u32 s32, s32, 0x60000
    s_add_u32 m0, s34, 0x7800
    s_nop 0
    buffer_load_dwordx4 v154, s[8:11], s32 offen offset:0 lds
    s_add_u32 m0, s34, 0x8780
    s_nop 0
    buffer_load_dwordx4 v154, s[8:11], s32 offen offset:128 lds
    s_add_u32 m0, s34, 0x9700
    s_nop 0
    buffer_load_dwordx4 v154, s[8:11], s32 offen offset:256 lds
    s_add_u32 s32, s32, 0x60000
    s_cmp_ge_u32 s32, 0x780000
    s_cselect_b32 s32, 0, s32
    s_add_u32 m0, s34, 0xa800
    s_nop 0
    buffer_load_dwordx4 v154, s[8:11], s32 offen offset:0 lds
    s_add_u32 m0, s34, 0xb780
    s_nop 0
    buffer_load_dwordx4 v154, s[8:11], s32 offen offset:128 lds
    s_add_u32 m0, s34, 0xc700
    s_nop 0
    buffer_load_dwordx4 v154, s[8:11], s32 offen offset:256 lds
    s_add_u32 s32, s32, 0x60000
    s_add_u32 m0, s34, 0xd800
    s_nop 0
    buffer_load_dwordx4 v154, s[8:11], s32 offen offset:0 lds
    s_add_u32 m0, s34, 0xe780
    s_nop 0
    buffer_load_dwordx4 v154, s[8:11], s32 offen offset:128 lds
    s_add_u32 m0, s34, 0xf700
    s_nop 0
    buffer_load_dwordx4 v154, s[8:11], s32 offen offset:256 lds
    s_add_u32 s32, s32, 0x60000
    s_cmp_ge_u32 s32, 0x780000
    s_cselect_b32 s32, 0, s32
    s_waitcnt vmcnt(6)
LA_p1_re0:
    s_barrier
    ds_read_b64_tr_b16 v[76:77], v140 offset:0
    ds_read_b64_tr_b16 v[78:79], v140 offset:512
    ds_read_b64_tr_b16 v[80:81], v141 offset:0
    ds_read_b64_tr_b16 v[82:83], v141 offset:512
    ds_read_b64_tr_b16 v[84:85], v142 offset:0
    ds_read_b64_tr_b16 v[86:87], v142 offset:512
    ds_read_b128 v[100:103], v146 offset:10240
    ds_read_b128 v[104:107], v146 offset:12288
    ds_read_b128 v[108:111], v146 offset:14336
    ds_read_b128 v[112:115], v146 offset:16384
    s_waitcnt lgkmcnt(0)
    v_mfma_f32_16x16x32_bf16 v[16:19], v[76:79], v[100:103], 0
    ds_read_b64_tr_b16 v[88:89], v140 offset:12288
    s_add_u32 m0, s34, 0x19800
    s_nop 0
    buffer_load_dwordx4 v154, s[8:11], s32 offen offset:0 lds
    v_mfma_f32_16x16x32_bf16 v[20:23], v[80:83], v[100:103], 0
    ds_read_b64_tr_b16 v[90:91], v140 offset:12800
    s_add_u32 m0, s34, 0x1a780
    s_nop 0
    buffer_load_dwordx4 v154, s[8:11], s32 offen offset:128 lds
    v_mfma_f32_16x16x32_bf16 v[24:27], v[84:87], v[100:103], 0
    ds_read_b64_tr_b16 v[92:93], v141 offset:12288
    v_mfma_f32_16x16x32_bf16 v[28:31], v[76:79], v[104:107], 0
    ds_read_b64_tr_b16 v[94:95], v141 offset:12800
    s_add_u32 m0, s34, 0x1b700
    s_nop 0
    buffer_load_dwordx4 v154, s[8:11], s32 offen offset:256 lds
    v_mfma_f32_16x16x32_bf16 v[32:35], v[80:83], v[104:107], 0
    ds_read_b64_tr_b16 v[96:97], v142 offset:12288
    s_add_u32 s32, s32, 0x60000
    v_mfma_f32_16x16x32_bf16 v[36:39], v[84:87], v[104:107], 0
    ds_read_b64_tr_b16 v[98:99], v142 offset:12800
    s_add_u32 m0, s34, 0x1c800
    s_nop 0
    buffer_load_dwordx4 v154, s[8:11], s32 offen offset:0 lds
    v_mfma_f32_16x16x32_bf16 v[40:43], v[76:79], v[108:111], 0
    ds_read_b128 v[120:123], v147 offset:10240
    v_mfma_f32_16x16x32_bf16 v[44:47], v[80:83], v[108:111], 0
    ds_read_b128 v[124:127], v147 offset:12288
    s_add_u32 m0, s34, 0x1d780
    s_nop 0
    buffer_load_dwordx4 v154, s[8:11], s32 offen offset:128 lds
    v_mfma_f32_16x16x32_bf16 v[48:51], v[84:87], v[108:111], 0
    ds_read_b128 v[128:131], v147 offset:14336
    s_add_u32 m0, s34, 0x1e700
    s_nop 0
    buffer_load_dwordx4 v154, s[8:11], s32 offen offset:256 lds
    v_mfma_f32_16x16x32_bf16 v[52:55], v[76:79], v[112:115], 0
    ds_read_b128 v[132:135], v147 offset:16384
    s_add_u32 s32, s32, 0x60000
    v_mfma_f32_16x16x32_bf16 v[56:59], v[80:83], v[112:115], 0
    v_mfma_f32_16x16x32_bf16 v[60:63], v[84:87], v[112:115], 0
    s_cmp_ge_u32 s32, 0x780000
    s_cselect_b32 s32, 0, s32
    s_waitcnt vmcnt(6) lgkmcnt(0)
    s_barrier
    v_mfma_f32_16x16x32_bf16 v[16:19], v[88:91], v[120:123], v[16:19]
    ds_read_b64_tr_b16 v[76:77], v140 offset:24576
    v_mfma_f32_16x16x32_bf16 v[20:23], v[92:95], v[120:123], v[20:23]
    ds_read_b64_tr_b16 v[78:79], v140 offset:25088
    s_add_u32 m0, s34, 0x4800
    s_nop 0
    buffer_load_dwordx4 v154, s[8:11], s32 offen offset:0 lds
    v_mfma_f32_16x16x32_bf16 v[24:27], v[96:99], v[120:123], v[24:27]
    ds_read_b64_tr_b16 v[80:81], v141 offset:24576
    v_mfma_f32_16x16x32_bf16 v[28:31], v[88:91], v[124:127], v[28:31]
    ds_read_b64_tr_b16 v[82:83], v141 offset:25088
    v_mfma_f32_16x16x32_bf16 v[32:35], v[92:95], v[124:127], v[32:35]
    ds_read_b64_tr_b16 v[84:85], v142 offset:24576
    s_add_u32 m0, s34, 0x5780
    s_nop 0
    buffer_load_dwordx4 v154, s[8:11], s32 offen offset:128 lds
    v_mfma_f32_16x16x32_bf16 v[36:39], v[96:99], v[124:127], v[36:39]
    ds_read_b64_tr_b16 v[86:87], v142 offset:25088
    v_mfma_f32_16x16x32_bf16 v[40:43], v[88:91], v[128:131], v[40:43]
    ds_read_b128 v[100:103], v148 offset:10240
    v_mfma_f32_16x16x32_bf16 v[44:47], v[92:95], v[128:131], v[44:47]
    ds_read_b128 v[104:107], v148 offset:12288
    s_add_u32 m0, s34, 0x6700
    s_nop 0
    buffer_load_dwordx4 v154, s[8:11], s32 offen offset:256 lds
    v_mfma_f32_16x16x32_bf16 v[48:51], v[96:99], v[128:131], v[48:51]
    ds_read_b128 v[108:111], v148 offset:14336
    v_mfma_f32_16x16x32_bf16 v[52:55], v[88:91], v[132:135], v[52:55]
    ds_read_b128 v[112:115], v148 offset:16384
    v_mfma_f32_16x16x32_bf16 v[56:59], v[92:95], v[132:135], v[56:59]
    s_add_u32 s32, s32, 0x60000
    v_mfma_f32_16x16x32_bf16 v[60:63], v[96:99], v[132:135], v[60:63]
    s_waitcnt lgkmcnt(0)
    v_mfma_f32_16x16x32_bf16 v[16:19], v[76:79], v[100:103], v[16:19]
    ds_read_b64_tr_b16 v[88:89], v140 offset:36864
    v_mfma_f32_16x16x32_bf16 v[20:23], v[80:83], v[100:103], v[20:23]
    ds_read_b64_tr_b16 v[90:91], v140 offset:37376
    s_add_u32 m0, s34, 0x7800
    s_nop 0
    buffer_load_dwordx4 v154, s[8:11], s32 offen offset:0 lds
    v_mfma_f32_16x16x32_bf16 v[24:27], v[84:87], v[100:103], v[24:27]
    ds_read_b64_tr_b16 v[92:93], v141 offset:36864
    v_mfma_f32_16x16x32_bf16 v[28:31], v[76:79], v[104:107], v[28:31]
    ds_read_b64_tr_b16 v[94:95], v141 offset:37376
    s_add_u32 m0, s34, 0x8780
    s_nop 0
    buffer_load_dwordx4 v154, s[8:11], s32 offen offset:128 lds
    v_mfma_f32_16x16x32_bf16 v[32:35], v[80:83], v[104:107], v[32:35]
    ds_read_b64_tr_b16 v[96:97], v142 offset:36864
    v_mfma_f32_16x16x32_bf16 v[36:39], v[84:87], v[104:107], v[36:39]
    ds_read_b64_tr_b16 v[98:99], v142 offset:37376
    s_add_u32 m0, s34, 0x9700
    s_nop 0
    buffer_load_dwordx4 v154, s[8:11], s32 offen offset:256 lds
    v_mfma_f32_16x16x32_bf16 v[40:43], v[76:79], v[108:111], v[40:43]
    ds_read_b128 v[120:123], v149 offset:10240
    v_mfma_f32_16x16x32_bf16 v[44:47], v[80:83], v[108:111], v[44:47]
    ds_read_b128 v[124:127], v149 offset:12288
    v_mfma_f32_16x16x32_bf16 v[48:51], v[84:87], v[108:111], v[48:51]
    ds_read_b128 v[128:131], v149 offset:14336
    s_add_u32 s32, s32, 0x60000
    v_mfma_f32_16x16x32_bf16 v[52:55], v[76:79], v[112:115], v[52:55]
    ds_read_b128 v[132:135], v149 offset:16384
    v_mfma_f32_16x16x32_bf16 v[56:59], v[80:83], v[112:115], v[56:59]
    s_cmp_ge_u32 s32, 0x780000
    s_cselect_b32 s32, 0, s32
    v_mfma_f32_16x16x32_bf16 v[60:63], v[84:87], v[112:115], v[60:63]
    s_waitcnt vmcnt(6) lgkmcnt(0)
    s_barrier
    v_mfma_f32_16x16x32_bf16 v[16:19], v[88:91], v[120:123], v[16:19]
    ds_read_b64_tr_b16 v[76:77], v143 offset:0
    v_mfma_f32_16x16x32_bf16 v[20:23], v[92:95], v[120:123], v[20:23]
    ds_read_b64_tr_b16 v[78:79], v143 offset:512
    s_add_u32 m0, s34, 0xa800
    s_nop 0
    buffer_load_dwordx4 v154, s[8:11], s32 offen offset:0 lds
    v_mfma_f32_16x16x32_bf16 v[24:27], v[96:99], v[120:123], v[24:27]
    ds_read_b64_tr_b16 v[80:81], v144 offset:0
    v_mfma_f32_16x16x32_bf16 v[28:31], v[88:91], v[124:127], v[28:31]
    ds_read_b64_tr_b16 v[82:83], v144 offset:512
    v_mfma_f32_16x16x32_bf16 v[32:35], v[92:95], v[124:127], v[32:35]
    ds_read_b64_tr_b16 v[84:85], v145 offset:0
    s_add_u32 m0, s34, 0xb780
    s_nop 0
    buffer_load_dwordx4 v154, s[8:11], s32 offen offset:128 lds
    v_mfma_f32_16x16x32_bf16 v[36:39], v[96:99], v[124:127], v[36:39]
    ds_read_b64_tr_b16 v[86:87], v145 offset:512
    v_mfma_f32_16x16x32_bf16 v[40:43], v[88:91], v[128:131], v[40:43]
    ds_read_b128 v[100:103], v148 offset:28672
    v_mfma_f32_16x16x32_bf16 v[44:47], v[92:95], v[128:131], v[44:47]
    ds_read_b128 v[104:107], v148 offset:30720
    s_add_u32 m0, s34, 0xc700
    s_nop 0
    buffer_load_dwordx4 v154, s[8:11], s32 offen offset:256 lds
    v_mfma_f32_16x16x32_bf16 v[48:51], v[96:99], v[128:131], v[48:51]
    ds_read_b128 v[108:111], v148 offset:32768
    v_mfma_f32_16x16x32_bf16 v[52:55], v[88:91], v[132:135], v[52:55]
    ds_read_b128 v[112:115], v148 offset:34816
    v_mfma_f32_16x16x32_bf16 v[56:59], v[92:95], v[132:135], v[56:59]
    s_add_u32 s32, s32, 0x60000
    v_mfma_f32_16x16x32_bf16 v[60:63], v[96:99], v[132:135], v[60:63]
    s_waitcnt lgkmcnt(0)
    v_mfma_f32_16x16x32_bf16 v[16:19], v[76:79], v[100:103], v[16:19]
    ds_read_b64_tr_b16 v[88:89], v143 offset:12288
    v_mfma_f32_16x16x32_bf16 v[20:23], v[80:83], v[100:103], v[20:23]
    ds_read_b64_tr_b16 v[90:91], v143 offset:12800
    s_add_u32 m0, s34, 0xd800
    s_nop 0
    buffer_load_dwordx4 v154, s[8:11], s32 offen offset:0 lds
    v_mfma_f32_16x16x32_bf16 v[24:27], v[84:87], v[100:103], v[24:27]
    ds_read_b64_tr_b16 v[92:93], v144 offset:12288
    v_mfma_f32_16x16x32_bf16 v[28:31], v[76:79], v[104:107], v[28:31]
    ds_read_b64_tr_b16 v[94:95], v144 offset:12800
    s_add_u32 m0, s34, 0xe780
    s_nop 0
    buffer_load_dwordx4 v154, s[8:11], s32 offen offset:128 lds
    v_mfma_f32_16x16x32_bf16 v[32:35], v[80:83], v[104:107], v[32:35]
    ds_read_b64_tr_b16 v[96:97], v145 offset:12288
    v_mfma_f32_16x16x32_bf16 v[36:39], v[84:87], v[104:107], v[36:39]
    ds_read_b64_tr_b16 v[98:99], v145 offset:12800
    s_add_u32 m0, s34, 0xf700
    s_nop 0
    buffer_load_dwordx4 v154, s[8:11], s32 offen offset:256 lds
    v_mfma_f32_16x16x32_bf16 v[40:43], v[76:79], v[108:111], v[40:43]
    ds_read_b128 v[120:123], v149 offset:28672
    v_mfma_f32_16x16x32_bf16 v[44:47], v[80:83], v[108:111], v[44:47]
    ds_read_b128 v[124:127], v149 offset:30720
    v_mfma_f32_16x16x32_bf16 v[48:51], v[84:87], v[108:111], v[48:51]
    ds_read_b128 v[128:131], v149 offset:32768
    s_add_u32 s32, s32, 0x60000
    v_mfma_f32_16x16x32_bf16 v[52:55], v[76:79], v[112:115], v[52:55]
    ds_read_b128 v[132:135], v149 offset:34816
    v_mfma_f32_16x16x32_bf16 v[56:59], v[80:83], v[112:115], v[56:59]
    s_cmp_ge_u32 s32, 0x780000
    s_cselect_b32 s32, 0, s32
    v_mfma_f32_16x16x32_bf16 v[60:63], v[84:87], v[112:115], v[60:63]
    s_waitcnt vmcnt(6) lgkmcnt(0)
    s_barrier
    v_mfma_f32_16x16x32_bf16 v[16:19], v[88:91], v[120:123], v[16:19]
    ds_read_b64_tr_b16 v[76:77], v140 offset:0
    v_mfma_f32_16x16x32_bf16 v[20:23], v[92:95], v[120:123], v[20:23]
    ds_read_b64_tr_b16 v[78:79], v140 offset:512
    s_add_u32 m0, s34, 0x19800
    s_nop 0
    buffer_load_dwordx4 v154, s[8:11], s32 offen offset:0 lds
    v_mfma_f32_16x16x32_bf16 v[24:27], v[96:99], v[120:123], v[24:27]
    ds_read_b64_tr_b16 v[80:81], v141 offset:0
    v_mfma_f32_16x16x32_bf16 v[28:31], v[88:91], v[124:127], v[28:31]
    ds_read_b64_tr_b16 v[82:83], v141 offset:512
    v_mfma_f32_16x16x32_bf16 v[32:35], v[92:95], v[124:127], v[32:35]
    ds_read_b64_tr_b16 v[84:85], v142 offset:0
    s_add_u32 m0, s34, 0x1a780
    s_nop 0
    buffer_load_dwordx4 v154, s[8:11], s32 offen offset:128 lds
    v_mfma_f32_16x16x32_bf16 v[36:39], v[96:99], v[124:127], v[36:39]
    ds_read_b64_tr_b16 v[86:87], v142 offset:512
    v_mfma_f32_16x16x32_bf16 v[40:43], v[88:91], v[128:131], v[40:43]
    ds_read_b128 v[100:103], v146 offset:10240
    v_mfma_f32_16x16x32_bf16 v[44:47], v[92:95], v[128:131], v[44:47]
    ds_read_b128 v[104:107], v146 offset:12288
    s_add_u32 m0, s34, 0x1b700
    s_nop 0
    buffer_load_dwordx4 v154, s[8:11], s32 offen offset:256 lds
    v_mfma_f32_16x16x32_bf16 v[48:51], v[96:99], v[128:131], v[48:51]
    ds_read_b128 v[108:111], v146 offset:14336
    v_mfma_f32_16x16x32_bf16 v[52:55], v[88:91], v[132:135], v[52:55]
    ds_read_b128 v[112:115], v146 offset:16384
    v_mfma_f32_16x16x32_bf16 v[56:59], v[92:95], v[132:135], v[56:59]
    s_add_u32 s32, s32, 0x60000
    v_mfma_f32_16x16x32_bf16 v[60:63], v[96:99], v[132:135], v[60:63]
    s_waitcnt lgkmcnt(0)
    v_mfma_f32_16x16x32_bf16 v[16:19], v[76:79], v[100:103], v[16:19]
    ds_read_b64_tr_b16 v[88:89], v140 offset:12288
    v_mfma_f32_16x16x32_bf16 v[20:23], v[80:83], v[100:103], v[20:23]
    ds_read_b64_tr_b16 v[90:91], v140 offset:12800
    s_add_u32 m0, s34, 0x1c800
    s_nop 0
    buffer_load_dwordx4 v154, s[8:11], s32 offen offset:0 lds
    v_mfma_f32_16x16x32_bf16 v[24:27], v[84:87], v[100:103], v[24:27]
    ds_read_b64_tr_b16 v[92:93], v141 offset:12288
    v_mfma_f32_16x16x32_bf16 v[28:31], v[76:79], v[104:107], v[28:31]
    ds_read_b64_tr_b16 v[94:95], v141 offset:12800
    s_add_u32 m0, s34, 0x1d780
    s_nop 0
    buffer_load_dwordx4 v154, s[8:11], s32 offen offset:128 lds
    v_mfma_f32_16x16x32_bf16 v[32:35], v[80:83], v[104:107], v[32:35]
    ds_read_b64_tr_b16 v[96:97], v142 offset:12288
    v_mfma_f32_16x16x32_bf16 v[36:39], v[84:87], v[104:107], v[36:39]
    ds_read_b64_tr_b16 v[98:99], v142 offset:12800
    s_add_u32 m0, s34, 0x1e700
    s_nop 0
    buffer_load_dwordx4 v154, s[8:11], s32 offen offset:256 lds
    v_mfma_f32_16x16x32_bf16 v[40:43], v[76:79], v[108:111], v[40:43]
    ds_read_b128 v[120:123], v147 offset:10240
    v_mfma_f32_16x16x32_bf16 v[44:47], v[80:83], v[108:111], v[44:47]
    ds_read_b128 v[124:127], v147 offset:12288
    v_mfma_f32_16x16x32_bf16 v[48:51], v[84:87], v[108:111], v[48:51]
    ds_read_b128 v[128:131], v147 offset:14336
    s_add_u32 s32, s32, 0x60000
    v_mfma_f32_16x16x32_bf16 v[52:55], v[76:79], v[112:115], v[52:55]
    ds_read_b128 v[132:135], v147 offset:16384
    v_mfma_f32_16x16x32_bf16 v[56:59], v[80:83], v[112:115], v[56:59]
    s_cmp_ge_u32 s32, 0x780000
    s_cselect_b32 s32, 0, s32
    v_mfma_f32_16x16x32_bf16 v[60:63], v[84:87], v[112:115], v[60:63]
    s_waitcnt vmcnt(6) lgkmcnt(0)
    s_barrier
    v_mfma_f32_16x16x32_bf16 v[16:19], v[88:91], v[120:123], v[16:19]
    ds_read_b64_tr_b16 v[76:77], v140 offset:24576
    v_mfma_f32_16x16x32_bf16 v[20:23], v[92:95], v[120:123], v[20:23]
    ds_read_b64_tr_b16 v[78:79], v140 offset:25088
    s_add_u32 m0, s34, 0x4800
    s_nop 0
    buffer_load_dwordx4 v154, s[8:11], s32 offen offset:0 lds
    v_mfma_f32_16x16x32_bf16 v[24:27], v[96:99], v[120:123], v[24:27]
    ds_read_b64_tr_b16 v[80:81], v141 offset:24576
    v_mfma_f32_16x16x32_bf16 v[28:31], v[88:91], v[124:127], v[28:31]
    ds_read_b64_tr_b16 v[82:83], v141 offset:25088
    v_mfma_f32_16x16x32_bf16 v[32:35], v[92:95], v[124:127], v[32:35]
    ds_read_b64_tr_b16 v[84:85], v142 offset:24576
    s_add_u32 m0, s34, 0x5780
    s_nop 0
    buffer_load_dwordx4 v154, s[8:11], s32 offen offset:128 lds
    v_mfma_f32_16x16x32_bf16 v[36:39], v[96:99], v[124:127], v[36:39]
    ds_read_b64_tr_b16 v[86:87], v142 offset:25088
    v_mfma_f32_16x16x32_bf16 v[40:43], v[88:91], v[128:131], v[40:43]
    ds_read_b128 v[100:103], v148 offset:10240
    v_mfma_f32_16x16x32_bf16 v[44:47], v[92:95], v[128:131], v[44:47]
    ds_read_b128 v[104:107], v148 offset:12288
    s_add_u32 m0, s34, 0x6700
    s_nop 0
    buffer_load_dwordx4 v154, s[8:11], s32 offen offset:256 lds
    v_mfma_f32_16x16x32_bf16 v[48:51], v[96:99], v[128:131], v[48:51]
    ds_read_b128 v[108:111], v148 offset:14336
    v_mfma_f32_16x16x32_bf16 v[52:55], v[88:91], v[132:135], v[52:55]
    ds_read_b128 v[112:115], v148 offset:16384
    v_mfma_f32_16x16x32_bf16 v[56:59], v[92:95], v[132:135], v[56:59]
    s_add_u32 s32, s32, 0x60000
    v_mfma_f32_16x16x32_bf16 v[60:63], v[96:99], v[132:135], v[60:63]
    s_waitcnt lgkmcnt(0)
    v_mfma_f32_16x16x32_bf16 v[16:19], v[76:79], v[100:103], v[16:19]
    ds_read_b64_tr_b16 v[88:89], v140 offset:36864
    v_mfma_f32_16x16x32_bf16 v[20:23], v[80:83], v[100:103], v[20:23]
    ds_read_b64_tr_b16 v[90:91], v140 offset:37376
    s_add_u32 m0, s34, 0x7800
    s_nop 0
    buffer_load_dwordx4 v154, s[8:11], s32 offen offset:0 lds
    v_mfma_f32_16x16x32_bf16 v[24:27], v[84:87], v[100:103], v[24:27]
    ds_read_b64_tr_b16 v[92:93], v141 offset:36864
    v_mfma_f32_16x16x32_bf16 v[28:31], v[76:79], v[104:107], v[28:31]
    ds_read_b64_tr_b16 v[94:95], v141 offset:37376
    s_add_u32 m0, s34, 0x8780
    s_nop 0
    buffer_load_dwordx4 v154, s[8:11], s32 offen offset:128 lds
    v_mfma_f32_16x16x32_bf16 v[32:35], v[80:83], v[104:107], v[32:35]
    ds_read_b64_tr_b16 v[96:97], v142 offset:36864
    v_mfma_f32_16x16x32_bf16 v[36:39], v[84:87], v[104:107], v[36:39]
    ds_read_b64_tr_b16 v[98:99], v142 offset:37376
    s_add_u32 m0, s34, 0x9700
    s_nop 0
    buffer_load_dwordx4 v154, s[8:11], s32 offen offset:256 lds
    v_mfma_f32_16x16x32_bf16 v[40:43], v[76:79], v[108:111], v[40:43]
    ds_read_b128 v[120:123], v149 offset:10240
    v_mfma_f32_16x16x32_bf16 v[44:47], v[80:83], v[108:111], v[44:47]
    ds_read_b128 v[124:127], v149 offset:12288
    v_mfma_f32_16x16x32_bf16 v[48:51], v[84:87], v[108:111], v[48:51]
    ds_read_b128 v[128:131], v149 offset:14336
    s_add_u32 s32, s32, 0x60000
    v_mfma_f32_16x16x32_bf16 v[52:55], v[76:79], v[112:115], v[52:55]
    ds_read_b128 v[132:135], v149 offset:16384
    v_mfma_f32_16x16x32_bf16 v[56:59], v[80:83], v[112:115], v[56:59]
    s_cmp_ge_u32 s32, 0x780000
    s_cselect_b32 s32, 0, s32
    v_mfma_f32_16x16x32_bf16 v[60:63], v[84:87], v[112:115], v[60:63]
    s_waitcnt vmcnt(6) lgkmcnt(0)
    s_barrier
    v_mfma_f32_16x16x32_bf16 v[16:19], v[88:91], v[120:123], v[16:19]
    ds_read_b64_tr_b16 v[76:77], v143 offset:0
    v_mfma_f32_16x16x32_bf16 v[20:23], v[92:95], v[120:123], v[20:23]
    ds_read_b64_tr_b16 v[78:79], v143 offset:512
    s_add_u32 m0, s34, 0xa800
    s_nop 0
    buffer_load_dwordx4 v154, s[8:11], s32 offen offset:0 lds
    v_mfma_f32_16x16x32_bf16 v[24:27], v[96:99], v[120:123], v[24:27]
    ds_read_b64_tr_b16 v[80:81], v144 offset:0
    v_mfma_f32_16x16x32_bf16 v[28:31], v[88:91], v[124:127], v[28:31]
    ds_read_b64_tr_b16 v[82:83], v144 offset:512
    v_mfma_f32_16x16x32_bf16 v[32:35], v[92:95], v[124:127], v[32:35]
    ds_read_b64_tr_b16 v[84:85], v145 offset:0
    s_add_u32 m0, s34, 0xb780
    s_nop 0
    buffer_load_dwordx4 v154, s[8:11], s32 offen offset:128 lds
    v_mfma_f32_16x16x32_bf16 v[36:39], v[96:99], v[124:127], v[36:39]
    ds_read_b64_tr_b16 v[86:87], v145 offset:512
    v_mfma_f32_16x16x32_bf16 v[40:43], v[88:91], v[128:131], v[40:43]
    ds_read_b128 v[100:103], v148 offset:28672
    v_mfma_f32_16x16x32_bf16 v[44:47], v[92:95], v[128:131], v[44:47]
    ds_read_b128 v[104:107], v148 offset:30720
    s_add_u32 m0, s34, 0xc700
    s_nop 0
    buffer_load_dwordx4 v154, s[8:11], s32 offen offset:256 lds
    v_mfma_f32_16x16x32_bf16 v[48:51], v[96:99], v[128:131], v[48:51]
    ds_read_b128 v[108:111], v148 offset:32768
    v_mfma_f32_16x16x32_bf16 v[52:55], v[88:91], v[132:135], v[52:55]
    ds_read_b128 v[112:115], v148 offset:34816
    v_mfma_f32_16x16x32_bf16 v[56:59], v[92:95], v[132:135], v[56:59]
    s_add_u32 s32, s32, 0x60000
    v_mfma_f32_16x16x32_bf16 v[60:63], v[96:99], v[132:135], v[60:63]
    s_waitcnt lgkmcnt(0)
    v_mfma_f32_16x16x32_bf16 v[16:19], v[76:79], v[100:103], v[16:19]
    ds_read_b64_tr_b16 v[88:89], v143 offset:12288
    v_mfma_f32_16x16x32_bf16 v[20:23], v[80:83], v[100:103], v[20:23]
    ds_read_b64_tr_b16 v[90:91], v143 offset:12800
    s_add_u32 m0, s34, 0xd800
    s_nop 0
    buffer_load_dwordx4 v154, s[8:11], s32 offen offset:0 lds
    v_mfma_f32_16x16x32_bf16 v[24:27], v[84:87], v[100:103], v[24:27]
    ds_read_b64_tr_b16 v[92:93], v144 offset:12288
    v_mfma_f32_16x16x32_bf16 v[28:31], v[76:79], v[104:107], v[28:31]
    ds_read_b64_tr_b16 v[94:95], v144 offset:12800
    s_add_u32 m0, s34, 0xe780
    s_nop 0
    buffer_load_dwordx4 v154, s[8:11], s32 offen offset:128 lds
    v_mfma_f32_16x16x32_bf16 v[32:35], v[80:83], v[104:107], v[32:35]
    ds_read_b64_tr_b16 v[96:97], v145 offset:12288
    v_mfma_f32_16x16x32_bf16 v[36:39], v[84:87], v[104:107], v[36:39]
    ds_read_b64_tr_b16 v[98:99], v145 offset:12800
    s_add_u32 m0, s34, 0xf700
    s_nop 0
    buffer_load_dwordx4 v154, s[8:11], s32 offen offset:256 lds
    v_mfma_f32_16x16x32_bf16 v[40:43], v[76:79], v[108:111], v[40:43]
    ds_read_b128 v[120:123], v149 offset:28672
    v_mfma_f32_16x16x32_bf16 v[44:47], v[80:83], v[108:111], v[44:47]
    ds_read_b128 v[124:127], v149 offset:30720
    v_mfma_f32_16x16x32_bf16 v[48:51], v[84:87], v[108:111], v[48:51]
    ds_read_b128 v[128:131], v149 offset:32768
    s_add_u32 s32, s32, 0x60000
    v_mfma_f32_16x16x32_bf16 v[52:55], v[76:79], v[112:115], v[52:55]
    ds_read_b128 v[132:135], v149 offset:34816
    v_mfma_f32_16x16x32_bf16 v[56:59], v[80:83], v[112:115], v[56:59]
    s_cmp_ge_u32 s32, 0x780000
    s_cselect_b32 s32, 0, s32
    v_mfma_f32_16x16x32_bf16 v[60:63], v[84:87], v[112:115], v[60:63]
    s_waitcnt vmcnt(6) lgkmcnt(0)
    s_barrier
    v_mfma_f32_16x16x32_bf16 v[16:19], v[88:91], v[120:123], v[16:19]
    ds_read_b64_tr_b16 v[76:77], v140 offset:0
    v_mfma_f32_16x16x32_bf16 v[20:23], v[92:95], v[120:123], v[20:23]
    ds_read_b64_tr_b16 v[78:79], v140 offset:512
    s_add_u32 m0, s34, 0x19800
    s_nop 0
    buffer_load_dwordx4 v154, s[8:11], s32 offen offset:0 lds
    v_mfma_f32_16x16x32_bf16 v[24:27], v[96:99], v[120:123], v[24:27]
    ds_read_b64_tr_b16 v[80:81], v141 offset:0
    v_mfma_f32_16x16x32_bf16 v[28:31], v[88:91], v[124:127], v[28:31]
    ds_read_b64_tr_b16 v[82:83], v141 offset:512
    v_mfma_f32_16x16x32_bf16 v[32:35], v[92:95], v[124:127], v[32:35]
    ds_read_b64_tr_b16 v[84:85], v142 offset:0
    s_add_u32 m0, s34, 0x1a780
    s_nop 0
    buffer_load_dwordx4 v154, s[8:11], s32 offen offset:128 lds
    v_mfma_f32_16x16x32_bf16 v[36:39], v[96:99], v[124:127], v[36:39]
    ds_read_b64_tr_b16 v[86:87], v142 offset:512
    v_mfma_f32_16x16x32_bf16 v[40:43], v[88:91], v[128:131], v[40:43]
    ds_read_b128 v[100:103], v146 offset:10240
    v_mfma_f32_16x16x32_bf16 v[44:47], v[92:95], v[128:131], v[44:47]
    ds_read_b128 v[104:107], v146 offset:12288
    s_add_u32 m0, s34, 0x1b700
    s_nop 0
    buffer_load_dwordx4 v154, s[8:11], s32 offen offset:256 lds
    v_mfma_f32_16x16x32_bf16 v[48:51], v[96:99], v[128:131], v[48:51]
    ds_read_b128 v[108:111], v146 offset:14336
    v_mfma_f32_16x16x32_bf16 v[52:55], v[88:91], v[132:135], v[52:55]
    ds_read_b128 v[112:115], v146 offset:16384
    v_mfma_f32_16x16x32_bf16 v[56:59], v[92:95], v[132:135], v[56:59]
    s_add_u32 s32, s32, 0x60000
    v_mfma_f32_16x16x32_bf16 v[60:63], v[96:99], v[132:135], v[60:63]
    s_waitcnt lgkmcnt(0)
    v_mfma_f32_16x16x32_bf16 v[16:19], v[76:79], v[100:103], v[16:19]
    ds_read_b64_tr_b16 v[88:89], v140 offset:12288
    v_mfma_f32_16x16x32_bf16 v[20:23], v[80:83], v[100:103], v[20:23]
    ds_read_b64_tr_b16 v[90:91], v140 offset:12800
    s_add_u32 m0, s34, 0x1c800
    s_nop 0
    buffer_load_dwordx4 v154, s[8:11], s32 offen offset:0 lds
    v_mfma_f32_16x16x32_bf16 v[24:27], v[84:87], v[100:103], v[24:27]
    ds_read_b64_tr_b16 v[92:93], v141 offset:12288
    v_mfma_f32_16x16x32_bf16 v[28:31], v[76:79], v[104:107], v[28:31]
    ds_read_b64_tr_b16 v[94:95], v141 offset:12800
    s_add_u32 m0, s34, 0x1d780
    s_nop 0
    buffer_load_dwordx4 v154, s[8:11], s32 offen offset:128 lds
    v_mfma_f32_16x16x32_bf16 v[32:35], v[80:83], v[104:107], v[32:35]
    ds_read_b64_tr_b16 v[96:97], v142 offset:12288
    v_mfma_f32_16x16x32_bf16 v[36:39], v[84:87], v[104:107], v[36:39]
    ds_read_b64_tr_b16 v[98:99], v142 offset:12800
    s_add_u32 m0, s34, 0x1e700
    s_nop 0
    buffer_load_dwordx4 v154, s[8:11], s32 offen offset:256 lds
    v_mfma_f32_16x16x32_bf16 v[40:43], v[76:79], v[108:111], v[40:43]
    ds_read_b128 v[120:123], v147 offset:10240
    v_mfma_f32_16x16x32_bf16 v[44:47], v[80:83], v[108:111], v[44:47]
    ds_read_b128 v[124:127], v147 offset:12288
    v_mfma_f32_16x16x32_bf16 v[48:51], v[84:87], v[108:111], v[48:51]
    ds_read_b128 v[128:131], v147 offset:14336
    s_add_u32 s32, s32, 0x60000
    v_mfma_f32_16x16x32_bf16 v[52:55], v[76:79], v[112:115], v[52:55]
    ds_read_b128 v[132:135], v147 offset:16384
    v_mfma_f32_16x16x32_bf16 v[56:59], v[80:83], v[112:115], v[56:59]
    s_cmp_ge_u32 s32, 0x780000
    s_cselect_b32 s32, 0, s32
    v_mfma_f32_16x16x32_bf16 v[60:63], v[84:87], v[112:115], v[60:63]
    s_waitcnt vmcnt(6) lgkmcnt(0)
    s_barrier
    v_mfma_f32_16x16x32_bf16 v[16:19], v[88:91], v[120:123], v[16:19]
    ds_read_b64_tr_b16 v[76:77], v140 offset:24576
    v_mfma_f32_16x16x32_bf16 v[20:23], v[92:95], v[120:123], v[20:23]
    ds_read_b64_tr_b16 v[78:79], v140 offset:25088
    s_add_u32 m0, s34, 0x4800
    s_nop 0
    buffer_load_dwordx4 v154, s[8:11], s32 offen offset:0 lds
    v_mfma_f32_16x16x32_bf16 v[24:27], v[96:99], v[120:123], v[24:27]
    ds_read_b64_tr_b16 v[80:81], v141 offset:24576
    v_mfma_f32_16x16x32_bf16 v[28:31], v[88:91], v[124:127], v[28:31]
    ds_read_b64_tr_b16 v[82:83], v141 offset:25088
    v_mfma_f32_16x16x32_bf16 v[32:35], v[92:95], v[124:127], v[32:35]
    ds_read_b64_tr_b16 v[84:85], v142 offset:24576
    s_add_u32 m0, s34, 0x5780
    s_nop 0
    buffer_load_dwordx4 v154, s[8:11], s32 offen offset:128 lds
    v_mfma_f32_16x16x32_bf16 v[36:39], v[96:99], v[124:127], v[36:39]
    ds_read_b64_tr_b16 v[86:87], v142 offset:25088
    v_mfma_f32_16x16x32_bf16 v[40:43], v[88:91], v[128:131], v[40:43]
    ds_read_b128 v[100:103], v148 offset:10240
    v_mfma_f32_16x16x32_bf16 v[44:47], v[92:95], v[128:131], v[44:47]
    ds_read_b128 v[104:107], v148 offset:12288
    s_add_u32 m0, s34, 0x6700
    s_nop 0
    buffer_load_dwordx4 v154, s[8:11], s32 offen offset:256 lds
    v_mfma_f32_16x16x32_bf16 v[48:51], v[96:99], v[128:131], v[48:51]
    ds_read_b128 v[108:111], v148 offset:14336
    v_mfma_f32_16x16x32_bf16 v[52:55], v[88:91], v[132:135], v[52:55]
    ds_read_b128 v[112:115], v148 offset:16384
    v_mfma_f32_16x16x32_bf16 v[56:59], v[92:95], v[132:135], v[56:59]
    s_add_u32 s32, s32, 0x60000
    v_mfma_f32_16x16x32_bf16 v[60:63], v[96:99], v[132:135], v[60:63]
    s_waitcnt lgkmcnt(0)
    v_mfma_f32_16x16x32_bf16 v[16:19], v[76:79], v[100:103], v[16:19]
    ds_read_b64_tr_b16 v[88:89], v140 offset:36864
    v_mfma_f32_16x16x32_bf16 v[20:23], v[80:83], v[100:103], v[20:23]
    ds_read_b64_tr_b16 v[90:91], v140 offset:37376
    s_add_u32 m0, s34, 0x7800
    s_nop 0
    buffer_load_dwordx4 v154, s[8:11], s32 offen offset:0 lds
    v_mfma_f32_16x16x32_bf16 v[24:27], v[84:87], v[100:103], v[24:27]
    ds_read_b64_tr_b16 v[92:93], v141 offset:36864
    v_mfma_f32_16x16x32_bf16 v[28:31], v[76:79], v[104:107], v[28:31]
    ds_read_b64_tr_b16 v[94:95], v141 offset:37376
    s_add_u32 m0, s34, 0x8780
    s_nop 0
    buffer_load_dwordx4 v154, s[8:11], s32 offen offset:128 lds
    v_mfma_f32_16x16x32_bf16 v[32:35], v[80:83], v[104:107], v[32:35]
    ds_read_b64_tr_b16 v[96:97], v142 offset:36864
    v_mfma_f32_16x16x32_bf16 v[36:39], v[84:87], v[104:107], v[36:39]
    ds_read_b64_tr_b16 v[98:99], v142 offset:37376
    s_add_u32 m0, s34, 0x9700
    s_nop 0
    buffer_load_dwordx4 v154, s[8:11], s32 offen offset:256 lds
    v_mfma_f32_16x16x32_bf16 v[40:43], v[76:79], v[108:111], v[40:43]
    ds_read_b128 v[120:123], v149 offset:10240
    v_mfma_f32_16x16x32_bf16 v[44:47], v[80:83], v[108:111], v[44:47]
    ds_read_b128 v[124:127], v149 offset:12288
    v_mfma_f32_16x16x32_bf16 v[48:51], v[84:87], v[108:111], v[48:51]
    ds_read_b128 v[128:131], v149 offset:14336
    s_add_u32 s32, s32, 0x60000
    v_mfma_f32_16x16x32_bf16 v[52:55], v[76:79], v[112:115], v[52:55]
    ds_read_b128 v[132:135], v149 offset:16384
    v_mfma_f32_16x16x32_bf16 v[56:59], v[80:83], v[112:115], v[56:59]
    s_cmp_ge_u32 s32, 0x780000
    s_cselect_b32 s32, 0, s32
    v_mfma_f32_16x16x32_bf16 v[60:63], v[84:87], v[112:115], v[60:63]
    s_waitcnt vmcnt(6) lgkmcnt(0)
    s_barrier
    v_mfma_f32_16x16x32_bf16 v[16:19], v[88:91], v[120:123], v[16:19]
    ds_read_b64_tr_b16 v[76:77], v143 offset:0
    v_mfma_f32_16x16x32_bf16 v[20:23], v[92:95], v[120:123], v[20:23]
    ds_read_b64_tr_b16 v[78:79], v143 offset:512
    v_mfma_f32_16x16x32_bf16 v[24:27], v[96:99], v[120:123], v[24:27]
    ds_read_b64_tr_b16 v[80:81], v144 offset:0
    v_mfma_f32_16x16x32_bf16 v[28:31], v[88:91], v[124:127], v[28:31]
    ds_read_b64_tr_b16 v[82:83], v144 offset:512
    v_mfma_f32_16x16x32_bf16 v[32:35], v[92:95], v[124:127], v[32:35]
    ds_read_b64_tr_b16 v[84:85], v145 offset:0
    v_mfma_f32_16x16x32_bf16 v[36:39], v[96:99], v[124:127], v[36:39]
    ds_read_b64_tr_b16 v[86:87], v145 offset:512
    v_mfma_f32_16x16x32_bf16 v[40:43], v[88:91], v[128:131], v[40:43]
    ds_read_b128 v[100:103], v148 offset:28672
    v_mfma_f32_16x16x32_bf16 v[44:47], v[92:95], v[128:131], v[44:47]
    ds_read_b128 v[104:107], v148 offset:30720
    v_mfma_f32_16x16x32_bf16 v[48:51], v[96:99], v[128:131], v[48:51]
    ds_read_b128 v[108:111], v148 offset:32768
    v_mfma_f32_16x16x32_bf16 v[52:55], v[88:91], v[132:135], v[52:55]
    ds_read_b128 v[112:115], v148 offset:34816
    v_mfma_f32_16x16x32_bf16 v[56:59], v[92:95], v[132:135], v[56:59]
    v_mfma_f32_16x16x32_bf16 v[60:63], v[96:99], v[132:135], v[60:63]
    s_waitcnt lgkmcnt(0)
    v_mfma_f32_16x16x32_bf16 v[16:19], v[76:79], v[100:103], v[16:19]
    ds_read_b64_tr_b16 v[88:89], v143 offset:12288
    v_mfma_f32_16x16x32_bf16 v[20:23], v[80:83], v[100:103], v[20:23]
    ds_read_b64_tr_b16 v[90:91], v143 offset:12800
    v_mfma_f32_16x16x32_bf16 v[24:27], v[84:87], v[100:103], v[24:27]
    ds_read_b64_tr_b16 v[92:93], v144 offset:12288
    v_mfma_f32_16x16x32_bf16 v[28:31], v[76:79], v[104:107], v[28:31]
    ds_read_b64_tr_b16 v[94:95], v144 offset:12800
    v_mfma_f32_16x16x32_bf16 v[32:35], v[80:83], v[104:107], v[32:35]
    ds_read_b64_tr_b16 v[96:97], v145 offset:12288
    v_mfma_f32_16x16x32_bf16 v[36:39], v[84:87], v[104:107], v[36:39]
    ds_read_b64_tr_b16 v[98:99], v145 offset:12800
    v_mfma_f32_16x16x32_bf16 v[40:43], v[76:79], v[108:111], v[40:43]
    ds_read_b128 v[120:123], v149 offset:28672
    v_mfma_f32_16x16x32_bf16 v[44:47], v[80:83], v[108:111], v[44:47]
    ds_read_b128 v[124:127], v149 offset:30720
    v_mfma_f32_16x16x32_bf16 v[48:51], v[84:87], v[108:111], v[48:51]
    ds_read_b128 v[128:131], v149 offset:32768
    v_mfma_f32_16x16x32_bf16 v[52:55], v[76:79], v[112:115], v[52:55]
    ds_read_b128 v[132:135], v149 offset:34816
    v_mfma_f32_16x16x32_bf16 v[56:59], v[80:83], v[112:115], v[56:59]
    v_mfma_f32_16x16x32_bf16 v[60:63], v[84:87], v[112:115], v[60:63]
    s_waitcnt vmcnt(0) lgkmcnt(0)
    s_barrier
    v_mfma_f32_16x16x32_bf16 v[16:19], v[88:91], v[120:123], v[16:19]
    ds_read_b64_tr_b16 v[76:77], v140 offset:0
    v_mfma_f32_16x16x32_bf16 v[20:23], v[92:95], v[120:123], v[20:23]
    ds_read_b64_tr_b16 v[78:79], v140 offset:512
    v_mfma_f32_16x16x32_bf16 v[24:27], v[96:99], v[120:123], v[24:27]
    ds_read_b64_tr_b16 v[80:81], v141 offset:0
    v_mfma_f32_16x16x32_bf16 v[28:31], v[88:91], v[124:127], v[28:31]
    ds_read_b64_tr_b16 v[82:83], v141 offset:512
    v_mfma_f32_16x16x32_bf16 v[32:35], v[92:95], v[124:127], v[32:35]
    ds_read_b64_tr_b16 v[84:85], v142 offset:0
    v_mfma_f32_16x16x32_bf16 v[36:39], v[96:99], v[124:127], v[36:39]
    ds_read_b64_tr_b16 v[86:87], v142 offset:512
    v_mfma_f32_16x16x32_bf16 v[40:43], v[88:91], v[128:131], v[40:43]
    ds_read_b128 v[100:103], v146 offset:10240
    v_mfma_f32_16x16x32_bf16 v[44:47], v[92:95], v[128:131], v[44:47]
    ds_read_b128 v[104:107], v146 offset:12288
    v_mfma_f32_16x16x32_bf16 v[48:51], v[96:99], v[128:131], v[48:51]
    ds_read_b128 v[108:111], v146 offset:14336
    v_mfma_f32_16x16x32_bf16 v[52:55], v[88:91], v[132:135], v[52:55]
    ds_read_b128 v[112:115], v146 offset:16384
    v_mfma_f32_16x16x32_bf16 v[56:59], v[92:95], v[132:135], v[56:59]
    v_mfma_f32_16x16x32_bf16 v[60:63], v[96:99], v[132:135], v[60:63]
    s_cmp_eq_u32 s35, 1
    s_cbranch_scc0 LA_ks_4
    s_mov_b32 s30, 0x3000
    s_add_u32 m0, s37, 0x1000
    s_nop 0
    buffer_load_dwordx4 v12, s[12:15], s30 offen nt lds
    s_add_u32 m0, s37, 0x1400
    s_nop 0
    buffer_load_dwordx4 v13, s[12:15], s30 offen nt lds
    s_mov_b32 s30, 0x3600
    s_add_u32 m0, s37, 0x1800
    s_nop 0
    buffer_load_dwordx4 v12, s[12:15], s30 offen nt lds
    s_add_u32 m0, s37, 0x1c00
    s_nop 0
    buffer_load_dwordx4 v13, s[12:15], s30 offen nt lds
    s_mov_b32 s30, 0x3080
    s_add_u32 m0, s37, 0x0
    s_nop 0
    buffer_load_dwordx4 v12, s[12:15], s30 offen nt lds
    s_add_u32 m0, s37, 0x400
    s_nop 0
    buffer_load_dwordx4 v13, s[12:15], s30 offen nt lds
    s_mov_b32 s30, 0x3680
    s_add_u32 m0, s37, 0x800
    s_nop 0
    buffer_load_dwordx4 v12, s[12:15], s30 offen nt lds
    s_add_u32 m0, s37, 0xc00
    s_nop 0
    buffer_load_dwordx4 v13, s[12:15], s30 offen nt lds
LA_ks_4:
    s_cmp_eq_u32 s35, 0
    s_cbranch_scc0 LA_ks_3
    s_mov_b32 s30, 0x0
    s_add_u32 m0, s37, 0x0
    s_nop 0
    buffer_load_dwordx4 v12, s[12:15], s30 offen nt lds
    s_add_u32 m0, s37, 0x400
    s_nop 0
    buffer_load_dwordx4 v13, s[12:15], s30 offen nt lds
    s_mov_b32 s30, 0x600
    s_add_u32 m0, s37, 0x800
    s_nop 0
    buffer_load_dwordx4 v12, s[12:15], s30 offen nt lds
    s_add_u32 m0, s37, 0xc00
    s_nop 0
    buffer_load_dwordx4 v13, s[12:15], s30 offen nt lds
    s_mov_b32 s30, 0x80
    s_add_u32 m0, s37, 0x1000
    s_nop 0
    buffer_load_dwordx4 v12, s[12:15], s30 offen nt lds
    s_add_u32 m0, s37, 0x1400
    s_nop 0
    buffer_load_dwordx4 v13, s[12:15], s30 offen nt lds
    s_mov_b32 s30, 0x680
    s_add_u32 m0, s37, 0x1800
    s_nop 0
    buffer_load_dwordx4 v12, s[12:15], s30 offen nt lds
    s_add_u32 m0, s37, 0x1c00
    s_nop 0
    buffer_load_dwordx4 v13, s[12:15], s30 offen nt lds
LA_ks_3:
    s_waitcnt lgkmcnt(0)
    v_mfma_f32_16x16x32_bf16 v[16:19], v[76:79], v[100:103], v[16:19]
    ds_read_b64_tr_b16 v[88:89], v140 offset:12288
    v_mfma_f32_16x16x32_bf16 v[20:23], v[80:83], v[100:103], v[20:23]
    ds_read_b64_tr_b16 v[90:91], v140 offset:12800
    v_mfma_f32_16x16x32_bf16 v[24:27], v[84:87], v[100:103], v[24:27]
    ds_read_b64_tr_b16 v[92:93], v141 offset:12288
    v_mfma_f32_16x16x32_bf16 v[28:31], v[76:79], v[104:107], v[28:31]
    ds_read_b64_tr_b16 v[94:95], v141 offset:12800
    v_mfma_f32_16x16x32_bf16 v[32:35], v[80:83], v[104:107], v[32:35]
    ds_read_b64_tr_b16 v[96:97], v142 offset:12288
    v_mfma_f32_16x16x32_bf16 v[36:39], v[84:87], v[104:107], v[36:39]
    ds_read_b64_tr_b16 v[98:99], v142 offset:12800
    v_mfma_f32_16x16x32_bf16 v[40:43], v[76:79], v[108:111], v[40:43]
    ds_read_b128 v[120:123], v147 offset:10240
    v_mfma_f32_16x16x32_bf16 v[44:47], v[80:83], v[108:111], v[44:47]
    ds_read_b128 v[124:127], v147 offset:12288
    v_mfma_f32_16x16x32_bf16 v[48:51], v[84:87], v[108:111], v[48:51]
    ds_read_b128 v[128:131], v147 offset:14336
    v_mfma_f32_16x16x32_bf16 v[52:55], v[76:79], v[112:115], v[52:55]
    ds_read_b128 v[132:135], v147 offset:16384
    v_mfma_f32_16x16x32_bf16 v[56:59], v[80:83], v[112:115], v[56:59]
    v_mfma_f32_16x16x32_bf16 v[60:63], v[84:87], v[112:115], v[60:63]
    s_waitcnt lgkmcnt(0)
    s_barrier
    v_mfma_f32_16x16x32_bf16 v[16:19], v[88:91], v[120:123], v[16:19]
    v_mfma_f32_16x16x32_bf16 v[20:23], v[92:95], v[120:123], v[20:23]
    v_mfma_f32_16x16x32_bf16 v[24:27], v[96:99], v[120:123], v[24:27]
    v_mfma_f32_16x16x32_bf16 v[28:31], v[88:91], v[124:127], v[28:31]
    v_mfma_f32_16x16x32_bf16 v[32:35], v[92:95], v[124:127], v[32:35]
    v_mfma_f32_16x16x32_bf16 v[36:39], v[96:99], v[124:127], v[36:39]
    v_mfma_f32_16x16x32_bf16 v[40:43], v[88:91], v[128:131], v[40:43]
    v_mfma_f32_16x16x32_bf16 v[44:47], v[92:95], v[128:131], v[44:47]
    v_mfma_f32_16x16x32_bf16 v[48:51], v[96:99], v[128:131], v[48:51]
    v_mfma_f32_16x16x32_bf16 v[52:55], v[88:91], v[132:135], v[52:55]
    v_mfma_f32_16x16x32_bf16 v[56:59], v[92:95], v[132:135], v[56:59]
    v_mfma_f32_16x16x32_bf16 v[60:63], v[96:99], v[132:135], v[60:63]
    s_nop 7
    v_cvt_pk_bf16_f32 v16, v16, v17
    v_cvt_pk_bf16_f32 v17, v18, v19
    ds_write_b64 v155, v[16:17] offset:5120
    v_cvt_pk_bf16_f32 v20, v20, v21
    v_cvt_pk_bf16_f32 v21, v22, v23
    ds_write_b64 v156, v[20:21] offset:5120
    v_cvt_pk_bf16_f32 v24, v24, v25
    v_cvt_pk_bf16_f32 v25, v26, v27
    ds_write_b64 v157, v[24:25] offset:5120
    v_cvt_pk_bf16_f32 v28, v28, v29
    v_cvt_pk_bf16_f32 v29, v30, v31
    ds_write_b64 v155, v[28:29] offset:6144
    v_cvt_pk_bf16_f32 v32, v32, v33
    v_cvt_pk_bf16_f32 v33, v34, v35
    ds_write_b64 v156, v[32:33] offset:6144
    v_cvt_pk_bf16_f32 v36, v36, v37
    v_cvt_pk_bf16_f32 v37, v38, v39
    ds_write_b64 v157, v[36:37] offset:6144
    v_cvt_pk_bf16_f32 v40, v40, v41
    v_cvt_pk_bf16_f32 v41, v42, v43
    ds_write_b64 v155, v[40:41] offset:7168
    v_cvt_pk_bf16_f32 v44, v44, v45
    v_cvt_pk_bf16_f32 v45, v46, v47
    ds_write_b64 v156, v[44:45] offset:7168
    v_cvt_pk_bf16_f32 v48, v48, v49
    v_cvt_pk_bf16_f32 v49, v50, v51
    ds_write_b64 v157, v[48:49] offset:7168
    v_cvt_pk_bf16_f32 v52, v52, v53
    v_cvt_pk_bf16_f32 v53, v54, v55
    ds_write_b64 v155, v[52:53] offset:8192
    v_cvt_pk_bf16_f32 v56, v56, v57
    v_cvt_pk_bf16_f32 v57, v58, v59
    ds_write_b64 v156, v[56:57] offset:8192
    v_cvt_pk_bf16_f32 v60, v60, v61
    v_cvt_pk_bf16_f32 v61, v62, v63
    ds_write_b64 v157, v[60:61] offset:8192
    s_waitcnt lgkmcnt(0)
    s_branch LA_p1_done
LA_p1_g1:
    s_add_u32 m0, s33, 0x0
    s_add_u32 s30, s31, 0x0
    buffer_load_dwordx4 v152, s[4:7], s30 offen lds
    s_add_u32 m0, s33, 0x400
    s_add_u32 s30, s31, 0x2800
    buffer_load_dwordx4 v153, s[4:7], s30 offen lds
    s_add_u32 m0, s33, 0x800
    s_add_u32 s30, s31, 0x5000
    buffer_load_dwordx4 v152, s[4:7], s30 offen lds
    s_add_u32 m0, s33, 0xc00
    s_add_u32 s30, s31, 0x7800
    buffer_load_dwordx4 v153, s[4:7], s30 offen lds
    s_add_u32 m0, s33, 0x1000
    s_add_u32 s30, s31, 0xa000
    s_mov_b32 exec_hi, 0
    buffer_load_dwordx4 v152, s[4:7], s30 offen lds
    s_mov_b32 exec_hi, -1
    s_add_u32 s31, s31, 128
    s_cmp_ge_u32 s31, 1280
    s_cselect_b32 s31, 0, s31
    s_add_u32 m0, s33, 0x10800
    s_add_u32 s30, s31, 0x0
    buffer_load_dwordx4 v152, s[4:7], s30 offen lds
    s_add_u32 m0, s33, 0x10c00
    s_add_u32 s30, s31, 0x2800
    buffer_load_dwordx4 v153, s[4:7], s30 offen lds
    s_add_u32 m0, s33, 0x11000
    s_add_u32 s30, s31, 0x5000
    buffer_load_dwordx4 v152, s[4:7], s30 offen lds
    s_add_u32 m0, s33, 0x11400
    s_add_u32 s30, s31, 0x7800
    buffer_load_dwordx4 v153, s[4:7], s30 offen lds
    s_add_u32 m0, s33, 0x11800
    s_add_u32 s30, s31, 0xa000
    s_mov_b32 exec_hi, 0
    buffer_load_dwordx4 v152, s[4:7], s30 offen lds
    s_mov_b32 exec_hi, -1
    s_add_u32 s31, s31, 128
    s_cmp_ge_u32 s31, 1280
    s_cselect_b32 s31, 0, s31
    s_waitcnt vmcnt(5)
LA_p1_re1:
    s_barrier
    ds_read_b64_tr_b16 v[76:77], v140 offset:0
    ds_read_b64_tr_b16 v[78:79], v140 offset:512
    ds_read_b64_tr_b16 v[80:81], v141 offset:0
    ds_read_b64_tr_b16 v[82:83], v141 offset:512
    ds_read_b64_tr_b16 v[84:85], v142 offset:0
    ds_read_b64_tr_b16 v[86:87], v142 offset:512
    ds_read_b128 v[100:103], v146 offset:0
    ds_read_b128 v[104:107], v146 offset:2048
    ds_read_b128 v[108:111], v146 offset:4096
    ds_read_b128 v[112:115], v146 offset:6144
    ds_read_b128 v[116:119], v146 offset:8192
    s_waitcnt lgkmcnt(0)
    v_mfma_f32_16x16x32_bf16 v[16:19], v[76:79], v[100:103], 0
    ds_read_b64_tr_b16 v[88:89], v140 offset:12288
    v_mfma_f32_16x16x32_bf16 v[20:23], v[80:83], v[100:103], 0
    ds_read_b64_tr_b16 v[90:91], v140 offset:12800
    s_add_u32 m0, s33, 0x15000
    s_add_u32 s30, s31, 0x0
    buffer_load_dwordx4 v152, s[4:7], s30 offen lds
    v_mfma_f32_16x16x32_bf16 v[24:27], v[84:87], v[100:103], 0
    ds_read_b64_tr_b16 v[92:93], v141 offset:12288
    v_mfma_f32_16x16x32_bf16 v[28:31], v[76:79], v[104:107], 0
    ds_read_b64_tr_b16 v[94:95], v141 offset:12800
    s_add_u32 m0, s33, 0x15400
    s_add_u32 s30, s31, 0x2800
    buffer_load_dwordx4 v153, s[4:7], s30 offen lds
    v_mfma_f32_16x16x32_bf16 v[32:35], v[80:83], v[104:107], 0
    ds_read_b64_tr_b16 v[96:97], v142 offset:12288
    v_mfma_f32_16x16x32_bf16 v[36:39], v[84:87], v[104:107], 0
    ds_read_b64_tr_b16 v[98:99], v142 offset:12800
    v_mfma_f32_16x16x32_bf16 v[40:43], v[76:79], v[108:111], 0
    ds_read_b128 v[120:123], v147 offset:0
    s_add_u32 m0, s33, 0x15800
    s_add_u32 s30, s31, 0x5000
    buffer_load_dwordx4 v152, s[4:7], s30 offen lds
    v_mfma_f32_16x16x32_bf16 v[44:47], v[80:83], v[108:111], 0
    ds_read_b128 v[124:127], v147 offset:2048
    v_mfma_f32_16x16x32_bf16 v[48:51], v[84:87], v[108:111], 0
    ds_read_b128 v[128:131], v147 offset:4096
    s_add_u32 m0, s33, 0x15c00
    s_add_u32 s30, s31, 0x7800
    buffer_load_dwordx4 v153, s[4:7], s30 offen lds
    v_mfma_f32_16x16x32_bf16 v[52:55], v[76:79], v[112:115], 0
    ds_read_b128 v[132:135], v147 offset:6144
    v_mfma_f32_16x16x32_bf16 v[56:59], v[80:83], v[112:115], 0
    ds_read_b128 v[136:139], v147 offset:8192
    v_mfma_f32_16x16x32_bf16 v[60:63], v[84:87], v[112:115], 0
    s_add_u32 m0, s33, 0x16000
    s_add_u32 s30, s31, 0xa000
    s_mov_b32 exec_hi, 0
    buffer_load_dwordx4 v152, s[4:7], s30 offen lds
    s_mov_b32 exec_hi, -1
    v_mfma_f32_16x16x32_bf16 v[64:67], v[76:79], v[116:119], 0
    v_mfma_f32_16x16x32_bf16 v[68:71], v[80:83], v[116:119], 0
    s_add_u32 s31, s31, 128
    s_cmp_ge_u32 s31, 1280
    s_cselect_b32 s31, 0, s31
    v_mfma_f32_16x16x32_bf16 v[72:75], v[84:87], v[116:119], 0
    s_waitcnt vmcnt(5) lgkmcnt(0)
    s_barrier
    v_mfma_f32_16x16x32_bf16 v[16:19], v[88:91], v[120:123], v[16:19]
    ds_read_b64_tr_b16 v[76:77], v140 offset:24576
    v_mfma_f32_16x16x32_bf16 v[20:23], v[92:95], v[120:123], v[20:23]
    ds_read_b64_tr_b16 v[78:79], v140 offset:25088
    v_mfma_f32_16x16x32_bf16 v[24:27], v[96:99], v[120:123], v[24:27]
    ds_read_b64_tr_b16 v[80:81], v141 offset:24576
    s_add_u32 m0, s33, 0x0
    s_add_u32 s30, s31, 0x0
    buffer_load_dwordx4 v152, s[4:7], s30 offen lds
    v_mfma_f32_16x16x32_bf16 v[28:31], v[88:91], v[124:127], v[28:31]
    ds_read_b64_tr_b16 v[82:83], v141 offset:25088
    v_mfma_f32_16x16x32_bf16 v[32:35], v[92:95], v[124:127], v[32:35]
    ds_read_b64_tr_b16 v[84:85], v142 offset:24576
    v_mfma_f32_16x16x32_bf16 v[36:39], v[96:99], v[124:127], v[36:39]
    ds_read_b64_tr_b16 v[86:87], v142 offset:25088
    v_mfma_f32_16x16x32_bf16 v[40:43], v[88:91], v[128:131], v[40:43]
    ds_read_b128 v[100:103], v148 offset:0
    v_mfma_f32_16x16x32_bf16 v[44:47], v[92:95], v[128:131], v[44:47]
    ds_read_b128 v[104:107], v148 offset:2048
    s_add_u32 m0, s33, 0x400
    s_add_u32 s30, s31, 0x2800
    buffer_load_dwordx4 v153, s[4:7], s30 offen lds
    v_mfma_f32_16x16x32_bf16 v[48:51], v[96:99], v[128:131], v[48:51]
    ds_read_b128 v[108:111], v148 offset:4096
    v_mfma_f32_16x16x32_bf16 v[52:55], v[88:91], v[132:135], v[52:55]
    ds_read_b128 v[112:115], v148 offset:6144
    v_mfma_f32_16x16x32_bf16 v[56:59], v[92:95], v[132:135], v[56:59]
    ds_read_b128 v[116:119], v148 offset:8192
    v_mfma_f32_16x16x32_bf16 v[60:63], v[96:99], v[132:135], v[60:63]
    v_mfma_f32_16x16x32_bf16 v[64:67], v[88:91], v[136:139], v[64:67]
    s_add_u32 m0, s33, 0x800
    s_add_u32 s30, s31, 0x5000
    buffer_load_dwordx4 v152, s[4:7], s30 offen lds
    v_mfma_f32_16x16x32_bf16 v[68:71], v[92:95], v[136:139], v[68:71]
    v_mfma_f32_16x16x32_bf16 v[72:75], v[96:99], v[136:139], v[72:75]
    s_waitcnt lgkmcnt(0)
    v_mfma_f32_16x16x32_bf16 v[16:19], v[76:79], v[100:103], v[16:19]
    ds_read_b64_tr_b16 v[88:89], v140 offset:36864
    v_mfma_f32_16x16x32_bf16 v[20:23], v[80:83], v[100:103], v[20:23]
    ds_read_b64_tr_b16 v[90:91], v140 offset:37376
    v_mfma_f32_16x16x32_bf16 v[24:27], v[84:87], v[100:103], v[24:27]
    ds_read_b64_tr_b16 v[92:93], v141 offset:36864
    s_add_u32 m0, s33, 0xc00
    s_add_u32 s30, s31, 0x7800
    buffer_load_dwordx4 v153, s[4:7], s30 offen lds
    v_mfma_f32_16x16x32_bf16 v[28:31], v[76:79], v[104:107], v[28:31]
    ds_read_b64_tr_b16 v[94:95], v141 offset:37376
    v_mfma_f32_16x16x32_bf16 v[32:35], v[80:83], v[104:107], v[32:35]
    ds_read_b64_tr_b16 v[96:97], v142 offset:36864
    v_mfma_f32_16x16x32_bf16 v[36:39], v[84:87], v[104:107], v[36:39]
    ds_read_b64_tr_b16 v[98:99], v142 offset:37376
    v_mfma_f32_16x16x32_bf16 v[40:43], v[76:79], v[108:111], v[40:43]
    ds_read_b128 v[120:123], v149 offset:0
    v_mfma_f32_16x16x32_bf16 v[44:47], v[80:83], v[108:111], v[44:47]
    ds_read_b128 v[124:127], v149 offset:2048
    s_add_u32 m0, s33, 0x1000
    s_add_u32 s30, s31, 0xa000
    s_mov_b32 exec_hi, 0
    buffer_load_dwordx4 v152, s[4:7], s30 offen lds
    s_mov_b32 exec_hi, -1
    v_mfma_f32_16x16x32_bf16 v[48:51], v[84:87], v[108:111], v[48:51]
    ds_read_b128 v[128:131], v149 offset:4096
    v_mfma_f32_16x16x32_bf16 v[52:55], v[76:79], v[112:115], v[52:55]
    ds_read_b128 v[132:135], v149 offset:6144
    v_mfma_f32_16x16x32_bf16 v[56:59], v[80:83], v[112:115], v[56:59]
    ds_read_b128 v[136:139], v149 offset:8192
    v_mfma_f32_16x16x32_bf16 v[60:63], v[84:87], v[112:115], v[60:63]
    v_mfma_f32_16x16x32_bf16 v[64:67], v[76:79], v[116:119], v[64:67]
    s_add_u32 s31, s31, 128
    s_cmp_ge_u32 s31, 1280
    s_cselect_b32 s31, 0, s31
    v_mfma_f32_16x16x32_bf16 v[68:71], v[80:83], v[116:119], v[68:71]
    v_mfma_f32_16x16x32_bf16 v[72:75], v[84:87], v[116:119], v[72:75]
    s_waitcnt vmcnt(5) lgkmcnt(0)
    s_barrier
    v_mfma_f32_16x16x32_bf16 v[16:19], v[88:91], v[120:123], v[16:19]
    ds_read_b64_tr_b16 v[76:77], v143 offset:0
    v_mfma_f32_16x16x32_bf16 v[20:23], v[92:95], v[120:123], v[20:23]
    ds_read_b64_tr_b16 v[78:79], v143 offset:512
    v_mfma_f32_16x16x32_bf16 v[24:27], v[96:99], v[120:123], v[24:27]
    ds_read_b64_tr_b16 v[80:81], v144 offset:0
    s_add_u32 m0, s33, 0x10800
    s_add_u32 s30, s31, 0x0
    buffer_load_dwordx4 v152, s[4:7], s30 offen lds
    v_mfma_f32_16x16x32_bf16 v[28:31], v[88:91], v[124:127], v[28:31]
    ds_read_b64_tr_b16 v[82:83], v144 offset:512
    v_mfma_f32_16x16x32_bf16 v[32:35], v[92:95], v[124:127], v[32:35]
    ds_read_b64_tr_b16 v[84:85], v145 offset:0
    v_mfma_f32_16x16x32_bf16 v[36:39], v[96:99], v[124:127], v[36:39]
    ds_read_b64_tr_b16 v[86:87], v145 offset:512
    v_mfma_f32_16x16x32_bf16 v[40:43], v[88:91], v[128:131], v[40:43]
    ds_read_b128 v[100:103], v148 offset:18432
    v_mfma_f32_16x16x32_bf16 v[44:47], v[92:95], v[128:131], v[44:47]
    ds_read_b128 v[104:107], v148 offset:20480
    s_add_u32 m0, s33, 0x10c00
    s_add_u32 s30, s31, 0x2800
    buffer_load_dwordx4 v153, s[4:7], s30 offen lds
    v_mfma_f32_16x16x32_bf16 v[48:51], v[96:99], v[128:131], v[48:51]
    ds_read_b128 v[108:111], v148 offset:22528
    v_mfma_f32_16x16x32_bf16 v[52:55], v[88:91], v[132:135], v[52:55]
    ds_read_b128 v[112:115], v148 offset:24576
    v_mfma_f32_16x16x32_bf16 v[56:59], v[92:95], v[132:135], v[56:59]
    ds_read_b128 v[116:119], v148 offset:26624
    v_mfma_f32_16x16x32_bf16 v[60:63], v[96:99], v[132:135], v[60:63]
    v_mfma_f32_16x16x32_bf16 v[64:67], v[88:91], v[136:139], v[64:67]
    s_add_u32 m0, s33, 0x11000
    s_add_u32 s30, s31, 0x5000
    buffer_load_dwordx4 v152, s[4:7], s30 offen lds
    v_mfma_f32_16x16x32_bf16 v[68:71], v[92:95], v[136:139], v[68:71]
    v_mfma_f32_16x16x32_bf16 v[72:75], v[96:99], v[136:139], v[72:75]
    s_waitcnt lgkmcnt(0)
    v_mfma_f32_16x16x32_bf16 v[16:19], v[76:79], v[100:103], v[16:19]
    ds_read_b64_tr_b16 v[88:89], v143 offset:12288
    v_mfma_f32_16x16x32_bf16 v[20:23], v[80:83], v[100:103], v[20:23]
    ds_read_b64_tr_b16 v[90:91], v143 offset:12800
    v_mfma_f32_16x16x32_bf16 v[24:27], v[84:87], v[100:103], v[24:27]
    ds_read_b64_tr_b16 v[92:93], v144 offset:12288
    s_add_u32 m0, s33, 0x11400
    s_add_u32 s30, s31, 0x7800
    buffer_load_dwordx4 v153, s[4:7], s30 offen lds
    v_mfma_f32_16x16x32_bf16 v[28:31], v[76:79], v[104:107], v[28:31]
    ds_read_b64_tr_b16 v[94:95], v144 offset:12800
    v_mfma_f32_16x16x32_bf16 v[32:35], v[80:83], v[104:107], v[32:35]
    ds_read_b64_tr_b16 v[96:97], v145 offset:12288
    v_mfma_f32_16x16x32_bf16 v[36:39], v[84:87], v[104:107], v[36:39]
    ds_read_b64_tr_b16 v[98:99], v145 offset:12800
    v_mfma_f32_16x16x32_bf16 v[40:43], v[76:79], v[108:111], v[40:43]
    ds_read_b128 v[120:123], v149 offset:18432
    v_mfma_f32_16x16x32_bf16 v[44:47], v[80:83], v[108:111], v[44:47]
    ds_read_b128 v[124:127], v149 offset:20480
    s_add_u32 m0, s33, 0x11800
    s_add_u32 s30, s31, 0xa000
    s_mov_b32 exec_hi, 0
    buffer_load_dwordx4 v152, s[4:7], s30 offen lds
    s_mov_b32 exec_hi, -1
    v_mfma_f32_16x16x32_bf16 v[48:51], v[84:87], v[108:111], v[48:51]
    ds_read_b128 v[128:131], v149 offset:22528
    v_mfma_f32_16x16x32_bf16 v[52:55], v[76:79], v[112:115], v[52:55]
    ds_read_b128 v[132:135], v149 offset:24576
    v_mfma_f32_16x16x32_bf16 v[56:59], v[80:83], v[112:115], v[56:59]
    ds_read_b128 v[136:139], v149 offset:26624
    v_mfma_f32_16x16x32_bf16 v[60:63], v[84:87], v[112:115], v[60:63]
    v_mfma_f32_16x16x32_bf16 v[64:67], v[76:79], v[116:119], v[64:67]
    s_add_u32 s31, s31, 128
    s_cmp_ge_u32 s31, 1280
    s_cselect_b32 s31, 0, s31
    v_mfma_f32_16x16x32_bf16 v[68:71], v[80:83], v[116:119], v[68:71]
    v_mfma_f32_16x16x32_bf16 v[72:75], v[84:87], v[116:119], v[72:75]
    s_waitcnt vmcnt(5) lgkmcnt(0)
    s_barrier
    v_mfma_f32_16x16x32_bf16 v[16:19], v[88:91], v[120:123], v[16:19]
    ds_read_b64_tr_b16 v[76:77], v140 offset:0
    v_mfma_f32_16x16x32_bf16 v[20:23], v[92:95], v[120:123], v[20:23]
    ds_read_b64_tr_b16 v[78:79], v140 offset:512
    v_mfma_f32_16x16x32_bf16 v[24:27], v[96:99], v[120:123], v[24:27]
    ds_read_b64_tr_b16 v[80:81], v141 offset:0
    s_add_u32 m0, s33, 0x15000
    s_add_u32 s30, s31, 0x0
    buffer_load_dwordx4 v152, s[4:7], s30 offen lds
    v_mfma_f32_16x16x32_bf16 v[28:31], v[88:91], v[124:127], v[28:31]
    ds_read_b64_tr_b16 v[82:83], v141 offset:512
    v_mfma_f32_16x16x32_bf16 v[32:35], v[92:95], v[124:127], v[32:35]
    ds_read_b64_tr_b16 v[84:85], v142 offset:0
    v_mfma_f32_16x16x32_bf16 v[36:39], v[96:99], v[124:127], v[36:39]
    ds_read_b64_tr_b16 v[86:87], v142 offset:512
    v_mfma_f32_16x16x32_bf16 v[40:43], v[88:91], v[128:131], v[40:43]
    ds_read_b128 v[100:103], v146 offset:0
    v_mfma_f32_16x16x32_bf16 v[44:47], v[92:95], v[128:131], v[44:47]
    ds_read_b128 v[104:107], v146 offset:2048
    s_add_u32 m0, s33, 0x15400
    s_add_u32 s30, s31, 0x2800
    buffer_load_dwordx4 v153, s[4:7], s30 offen lds
    v_mfma_f32_16x16x32_bf16 v[48:51], v[96:99], v[128:131], v[48:51]
    ds_read_b128 v[108:111], v146 offset:4096
    v_mfma_f32_16x16x32_bf16 v[52:55], v[88:91], v[132:135], v[52:55]
    ds_read_b128 v[112:115], v146 offset:6144
    v_mfma_f32_16x16x32_bf16 v[56:59], v[92:95], v[132:135], v[56:59]
    ds_read_b128 v[116:119], v146 offset:8192
    v_mfma_f32_16x16x32_bf16 v[60:63], v[96:99], v[132:135], v[60:63]
    v_mfma_f32_16x16x32_bf16 v[64:67], v[88:91], v[136:139], v[64:67]
    s_add_u32 m0, s33, 0x15800
    s_add_u32 s30, s31, 0x5000
    buffer_load_dwordx4 v152, s[4:7], s30 offen lds
    v_mfma_f32_16x16x32_bf16 v[68:71], v[92:95], v[136:139], v[68:71]
    v_mfma_f32_16x16x32_bf16 v[72:75], v[96:99], v[136:139], v[72:75]
    s_waitcnt lgkmcnt(0)
    v_mfma_f32_16x16x32_bf16 v[16:19], v[76:79], v[100:103], v[16:19]
    ds_read_b64_tr_b16 v[88:89], v140 offset:12288
    v_mfma_f32_16x16x32_bf16 v[20:23], v[80:83], v[100:103], v[20:23]
    ds_read_b64_tr_b16 v[90:91], v140 offset:12800
    v_mfma_f32_16x16x32_bf16 v[24:27], v[84:87], v[100:103], v[24:27]
    ds_read_b64_tr_b16 v[92:93], v141 offset:12288
    s_add_u32 m0, s33, 0x15c00
    s_add_u32 s30, s31, 0x7800
    buffer_load_dwordx4 v153, s[4:7], s30 offen lds
    v_mfma_f32_16x16x32_bf16 v[28:31], v[76:79], v[104:107], v[28:31]
    ds_read_b64_tr_b16 v[94:95], v141 offset:12800
    v_mfma_f32_16x16x32_bf16 v[32:35], v[80:83], v[104:107], v[32:35]
    ds_read_b64_tr_b16 v[96:97], v142 offset:12288
    v_mfma_f32_16x16x32_bf16 v[36:39], v[84:87], v[104:107], v[36:39]
    ds_read_b64_tr_b16 v[98:99], v142 offset:12800
    v_mfma_f32_16x16x32_bf16 v[40:43], v[76:79], v[108:111], v[40:43]
    ds_read_b128 v[120:123], v147 offset:0
    v_mfma_f32_16x16x32_bf16 v[44:47], v[80:83], v[108:111], v[44:47]
    ds_read_b128 v[124:127], v147 offset:2048
    s_add_u32 m0, s33, 0x16000
    s_add_u32 s30, s31, 0xa000
    s_mov_b32 exec_hi, 0
    buffer_load_dwordx4 v152, s[4:7], s30 offen lds
    s_mov_b32 exec_hi, -1
    v_mfma_f32_16x16x32_bf16 v[48:51], v[84:87], v[108:111], v[48:51]
    ds_read_b128 v[128:131], v147 offset:4096
    v_mfma_f32_16x16x32_bf16 v[52:55], v[76:79], v[112:115], v[52:55]
    ds_read_b128 v[132:135], v147 offset:6144
    v_mfma_f32_16x16x32_bf16 v[56:59], v[80:83], v[112:115], v[56:59]
    ds_read_b128 v[136:139], v147 offset:8192
    v_mfma_f32_16x16x32_bf16 v[60:63], v[84:87], v[112:115], v[60:63]
    v_mfma_f32_16x16x32_bf16 v[64:67], v[76:79], v[116:119], v[64:67]
    s_add_u32 s31, s31, 128
    s_cmp_ge_u32 s31, 1280
    s_cselect_b32 s31, 0, s31
    v_mfma_f32_16x16x32_bf16 v[68:71], v[80:83], v[116:119], v[68:71]
    v_mfma_f32_16x16x32_bf16 v[72:75], v[84:87], v[116:119], v[72:75]
    s_waitcnt vmcnt(5) lgkmcnt(0)
    s_barrier
    v_mfma_f32_16x16x32_bf16 v[16:19], v[88:91], v[120:123], v[16:19]
    ds_read_b64_tr_b16 v[76:77], v140 offset:24576
    v_mfma_f32_16x16x32_bf16 v[20:23], v[92:95], v[120:123], v[20:23]
    ds_read_b64_tr_b16 v[78:79], v140 offset:25088
    v_mfma_f32_16x16x32_bf16 v[24:27], v[96:99], v[120:123], v[24:27]
    ds_read_b64_tr_b16 v[80:81], v141 offset:24576
    s_add_u32 m0, s33, 0x0
    s_add_u32 s30, s31, 0x0
    buffer_load_dwordx4 v152, s[4:7], s30 offen lds
    v_mfma_f32_16x16x32_bf16 v[28:31], v[88:91], v[124:127], v[28:31]
    ds_read_b64_tr_b16 v[82:83], v141 offset:25088
    v_mfma_f32_16x16x32_bf16 v[32:35], v[92:95], v[124:127], v[32:35]
    ds_read_b64_tr_b16 v[84:85], v142 offset:24576
    v_mfma_f32_16x16x32_bf16 v[36:39], v[96:99], v[124:127], v[36:39]
    ds_read_b64_tr_b16 v[86:87], v142 offset:25088
    v_mfma_f32_16x16x32_bf16 v[40:43], v[88:91], v[128:131], v[40:43]
    ds_read_b128 v[100:103], v148 offset:0
    v_mfma_f32_16x16x32_bf16 v[44:47], v[92:95], v[128:131], v[44:47]
    ds_read_b128 v[104:107], v148 offset:2048
    s_add_u32 m0, s33, 0x400
    s_add_u32 s30, s31, 0x2800
    buffer_load_dwordx4 v153, s[4:7], s30 offen lds
    v_mfma_f32_16x16x32_bf16 v[48:51], v[96:99], v[128:131], v[48:51]
    ds_read_b128 v[108:111], v148 offset:4096
    v_mfma_f32_16x16x32_bf16 v[52:55], v[88:91], v[132:135], v[52:55]
    ds_read_b128 v[112:115], v148 offset:6144
    v_mfma_f32_16x16x32_bf16 v[56:59], v[92:95], v[132:135], v[56:59]
    ds_read_b128 v[116:119], v148 offset:8192
    v_mfma_f32_16x16x32_bf16 v[60:63], v[96:99], v[132:135], v[60:63]
    v_mfma_f32_16x16x32_bf16 v[64:67], v[88:91], v[136:139], v[64:67]
    s_add_u32 m0, s33, 0x800
    s_add_u32 s30, s31, 0x5000
    buffer_load_dwordx4 v152, s[4:7], s30 offen lds
    v_mfma_f32_16x16x32_bf16 v[68:71], v[92:95], v[136:139], v[68:71]
    v_mfma_f32_16x16x32_bf16 v[72:75], v[96:99], v[136:139], v[72:75]
    s_waitcnt lgkmcnt(0)
    v_mfma_f32_16x16x32_bf16 v[16:19], v[76:79], v[100:103], v[16:19]
    ds_read_b64_tr_b16 v[88:89], v140 offset:36864
    v_mfma_f32_16x16x32_bf16 v[20:23], v[80:83], v[100:103], v[20:23]
    ds_read_b64_tr_b16 v[90:91], v140 offset:37376
    v_mfma_f32_16x16x32_bf16 v[24:27], v[84:87], v[100:103], v[24:27]
    ds_read_b64_tr_b16 v[92:93], v141 offset:36864
    s_add_u32 m0, s33, 0xc00
    s_add_u32 s30, s31, 0x7800
    buffer_load_dwordx4 v153, s[4:7], s30 offen lds
    v_mfma_f32_16x16x32_bf16 v[28:31], v[76:79], v[104:107], v[28:31]
    ds_read_b64_tr_b16 v[94:95], v141 offset:37376
    v_mfma_f32_16x16x32_bf16 v[32:35], v[80:83], v[104:107], v[32:35]
    ds_read_b64_tr_b16 v[96:97], v142 offset:36864
    v_mfma_f32_16x16x32_bf16 v[36:39], v[84:87], v[104:107], v[36:39]
    ds_read_b64_tr_b16 v[98:99], v142 offset:37376
    v_mfma_f32_16x16x32_bf16 v[40:43], v[76:79], v[108:111], v[40:43]
    ds_read_b128 v[120:123], v149 offset:0
    v_mfma_f32_16x16x32_bf16 v[44:47], v[80:83], v[108:111], v[44:47]
    ds_read_b128 v[124:127], v149 offset:2048
    s_add_u32 m0, s33, 0x1000
    s_add_u32 s30, s31, 0xa000
    s_mov_b32 exec_hi, 0
    buffer_load_dwordx4 v152, s[4:7], s30 offen lds
    s_mov_b32 exec_hi, -1
    v_mfma_f32_16x16x32_bf16 v[48:51], v[84:87], v[108:111], v[48:51]
    ds_read_b128 v[128:131], v149 offset:4096
    v_mfma_f32_16x16x32_bf16 v[52:55], v[76:79], v[112:115], v[52:55]
    ds_read_b128 v[132:135], v149 offset:6144
    v_mfma_f32_16x16x32_bf16 v[56:59], v[80:83], v[112:115], v[56:59]
    ds_read_b128 v[136:139], v149 offset:8192
    v_mfma_f32_16x16x32_bf16 v[60:63], v[84:87], v[112:115], v[60:63]
    v_mfma_f32_16x16x32_bf16 v[64:67], v[76:79], v[116:119], v[64:67]
    s_add_u32 s31, s31, 128
    s_cmp_ge_u32 s31, 1280
    s_cselect_b32 s31, 0, s31
    v_mfma_f32_16x16x32_bf16 v[68:71], v[80:83], v[116:119], v[68:71]
    v_mfma_f32_16x16x32_bf16 v[72:75], v[84:87], v[116:119], v[72:75]
    s_waitcnt vmcnt(5) lgkmcnt(0)
    s_barrier
    v_mfma_f32_16x16x32_bf16 v[16:19], v[88:91], v[120:123], v[16:19]
    ds_read_b64_tr_b16 v[76:77], v143 offset:0
    v_mfma_f32_16x16x32_bf16 v[20:23], v[92:95], v[120:123], v[20:23]
    ds_read_b64_tr_b16 v[78:79], v143 offset:512
    v_mfma_f32_16x16x32_bf16 v[24:27], v[96:99], v[120:123], v[24:27]
    ds_read_b64_tr_b16 v[80:81], v144 offset:0
    s_add_u32 m0, s33, 0x10800
    s_add_u32 s30, s31, 0x0
    buffer_load_dwordx4 v152, s[4:7], s30 offen lds
    v_mfma_f32_16x16x32_bf16 v[28:31], v[88:91], v[124:127], v[28:31]
    ds_read_b64_tr_b16 v[82:83], v144 offset:512
    v_mfma_f32_16x16x32_bf16 v[32:35], v[92:95], v[124:127], v[32:35]
    ds_read_b64_tr_b16 v[84:85], v145 offset:0
    v_mfma_f32_16x16x32_bf16 v[36:39], v[96:99], v[124:127], v[36:39]
    ds_read_b64_tr_b16 v[86:87], v145 offset:512
    v_mfma_f32_16x16x32_bf16 v[40:43], v[88:91], v[128:131], v[40:43]
    ds_read_b128 v[100:103], v148 offset:18432
    v_mfma_f32_16x16x32_bf16 v[44:47], v[92:95], v[128:131], v[44:47]
    ds_read_b128 v[104:107], v148 offset:20480
    s_add_u32 m0, s33, 0x10c00
    s_add_u32 s30, s31, 0x2800
    buffer_load_dwordx4 v153, s[4:7], s30 offen lds
    v_mfma_f32_16x16x32_bf16 v[48:51], v[96:99], v[128:131], v[48:51]
    ds_read_b128 v[108:111], v148 offset:22528
    v_mfma_f32_16x16x32_bf16 v[52:55], v[88:91], v[132:135], v[52:55]
    ds_read_b128 v[112:115], v148 offset:24576
    v_mfma_f32_16x16x32_bf16 v[56:59], v[92:95], v[132:135], v[56:59]
    ds_read_b128 v[116:119], v148 offset:26624
    v_mfma_f32_16x16x32_bf16 v[60:63], v[96:99], v[132:135], v[60:63]
    v_mfma_f32_16x16x32_bf16 v[64:67], v[88:91], v[136:139], v[64:67]
    s_add_u32 m0, s33, 0x11000
    s_add_u32 s30, s31, 0x5000
    buffer_load_dwordx4 v152, s[4:7], s30 offen lds
    v_mfma_f32_16x16x32_bf16 v[68:71], v[92:95], v[136:139], v[68:71]
    v_mfma_f32_16x16x32_bf16 v[72:75], v[96:99], v[136:139], v[72:75]
    s_waitcnt lgkmcnt(0)
    v_mfma_f32_16x16x32_bf16 v[16:19], v[76:79], v[100:103], v[16:19]
    ds_read_b64_tr_b16 v[88:89], v143 offset:12288
    v_mfma_f32_16x16x32_bf16 v[20:23], v[80:83], v[100:103], v[20:23]
    ds_read_b64_tr_b16 v[90:91], v143 offset:12800
    v_mfma_f32_16x16x32_bf16 v[24:27], v[84:87], v[100:103], v[24:27]
    ds_read_b64_tr_b16 v[92:93], v144 offset:12288
    s_add_u32 m0, s33, 0x11400
    s_add_u32 s30, s31, 0x7800
    buffer_load_dwordx4 v153, s[4:7], s30 offen lds
    v_mfma_f32_16x16x32_bf16 v[28:31], v[76:79], v[104:107], v[28:31]
    ds_read_b64_tr_b16 v[94:95], v144 offset:12800
    v_mfma_f32_16x16x32_bf16 v[32:35], v[80:83], v[104:107], v[32:35]
    ds_read_b64_tr_b16 v[96:97], v145 offset:12288
    v_mfma_f32_16x16x32_bf16 v[36:39], v[84:87], v[104:107], v[36:39]
    ds_read_b64_tr_b16 v[98:99], v145 offset:12800
    v_mfma_f32_16x16x32_bf16 v[40:43], v[76:79], v[108:111], v[40:43]
    ds_read_b128 v[120:123], v149 offset:18432
    v_mfma_f32_16x16x32_bf16 v[44:47], v[80:83], v[108:111], v[44:47]
    ds_read_b128 v[124:127], v149 offset:20480
    s_add_u32 m0, s33, 0x11800
    s_add_u32 s30, s31, 0xa000
    s_mov_b32 exec_hi, 0
    buffer_load_dwordx4 v152, s[4:7], s30 offen lds
    s_mov_b32 exec_hi, -1
    v_mfma_f32_16x16x32_bf16 v[48:51], v[84:87], v[108:111], v[48:51]
    ds_read_b128 v[128:131], v149 offset:22528
    v_mfma_f32_16x16x32_bf16 v[52:55], v[76:79], v[112:115], v[52:55]
    ds_read_b128 v[132:135], v149 offset:24576
    v_mfma_f32_16x16x32_bf16 v[56:59], v[80:83], v[112:115], v[56:59]
    ds_read_b128 v[136:139], v149 offset:26624
    v_mfma_f32_16x16x32_bf16 v[60:63], v[84:87], v[112:115], v[60:63]
    v_mfma_f32_16x16x32_bf16 v[64:67], v[76:79], v[116:119], v[64:67]
    s_add_u32 s31, s31, 128
    s_cmp_ge_u32 s31, 1280
    s_cselect_b32 s31, 0, s31
    v_mfma_f32_16x16x32_bf16 v[68:71], v[80:83], v[116:119], v[68:71]
    v_mfma_f32_16x16x32_bf16 v[72:75], v[84:87], v[116:119], v[72:75]
    s_waitcnt vmcnt(5) lgkmcnt(0)
    s_barrier
    v_mfma_f32_16x16x32_bf16 v[16:19], v[88:91], v[120:123], v[16:19]
    ds_read_b64_tr_b16 v[76:77], v140 offset:0
    v_mfma_f32_16x16x32_bf16 v[20:23], v[92:95], v[120:123], v[20:23]
    ds_read_b64_tr_b16 v[78:79], v140 offset:512
    v_mfma_f32_16x16x32_bf16 v[24:27], v[96:99], v[120:123], v[24:27]
    ds_read_b64_tr_b16 v[80:81], v141 offset:0
    s_add_u32 m0, s33, 0x15000
    s_add_u32 s30, s31, 0x0
    buffer_load_dwordx4 v152, s[4:7], s30 offen lds
    v_mfma_f32_16x16x32_bf16 v[28:31], v[88:91], v[124:127], v[28:31]
    ds_read_b64_tr_b16 v[82:83], v141 offset:512
    v_mfma_f32_16x16x32_bf16 v[32:35], v[92:95], v[124:127], v[32:35]
    ds_read_b64_tr_b16 v[84:85], v142 offset:0
    v_mfma_f32_16x16x32_bf16 v[36:39], v[96:99], v[124:127], v[36:39]
    ds_read_b64_tr_b16 v[86:87], v142 offset:512
    v_mfma_f32_16x16x32_bf16 v[40:43], v[88:91], v[128:131], v[40:43]
    ds_read_b128 v[100:103], v146 offset:0
    v_mfma_f32_16x16x32_bf16 v[44:47], v[92:95], v[128:131], v[44:47]
    ds_read_b128 v[104:107], v146 offset:2048
    s_add_u32 m0, s33, 0x15400
    s_add_u32 s30, s31, 0x2800
    buffer_load_dwordx4 v153, s[4:7], s30 offen lds
    v_mfma_f32_16x16x32_bf16 v[48:51], v[96:99], v[128:131], v[48:51]
    ds_read_b128 v[108:111], v146 offset:4096
    v_mfma_f32_16x16x32_bf16 v[52:55], v[88:91], v[132:135], v[52:55]
    ds_read_b128 v[112:115], v146 offset:6144
    v_mfma_f32_16x16x32_bf16 v[56:59], v[92:95], v[132:135], v[56:59]
    ds_read_b128 v[116:119], v146 offset:8192
    v_mfma_f32_16x16x32_bf16 v[60:63], v[96:99], v[132:135], v[60:63]
    v_mfma_f32_16x16x32_bf16 v[64:67], v[88:91], v[136:139], v[64:67]
    s_add_u32 m0, s33, 0x15800
    s_add_u32 s30, s31, 0x5000
    buffer_load_dwordx4 v152, s[4:7], s30 offen lds
    v_mfma_f32_16x16x32_bf16 v[68:71], v[92:95], v[136:139], v[68:71]
    v_mfma_f32_16x16x32_bf16 v[72:75], v[96:99], v[136:139], v[72:75]
    s_waitcnt lgkmcnt(0)
    v_mfma_f32_16x16x32_bf16 v[16:19], v[76:79], v[100:103], v[16:19]
    ds_read_b64_tr_b16 v[88:89], v140 offset:12288
    v_mfma_f32_16x16x32_bf16 v[20:23], v[80:83], v[100:103], v[20:23]
    ds_read_b64_tr_b16 v[90:91], v140 offset:12800
    v_mfma_f32_16x16x32_bf16 v[24:27], v[84:87], v[100:103], v[24:27]
    ds_read_b64_tr_b16 v[92:93], v141 offset:12288
    s_add_u32 m0, s33, 0x15c00
    s_add_u32 s30, s31, 0x7800
    buffer_load_dwordx4 v153, s[4:7], s30 offen lds
    v_mfma_f32_16x16x32_bf16 v[28:31], v[76:79], v[104:107], v[28:31]
    ds_read_b64_tr_b16 v[94:95], v141 offset:12800
    v_mfma_f32_16x16x32_bf16 v[32:35], v[80:83], v[104:107], v[32:35]
    ds_read_b64_tr_b16 v[96:97], v142 offset:12288
    v_mfma_f32_16x16x32_bf16 v[36:39], v[84:87], v[104:107], v[36:39]
    ds_read_b64_tr_b16 v[98:99], v142 offset:12800
    v_mfma_f32_16x16x32_bf16 v[40:43], v[76:79], v[108:111], v[40:43]
    ds_read_b128 v[120:123], v147 offset:0
    v_mfma_f32_16x16x32_bf16 v[44:47], v[80:83], v[108:111], v[44:47]
    ds_read_b128 v[124:127], v147 offset:2048
    s_add_u32 m0, s33, 0x16000
    s_add_u32 s30, s31, 0xa000
    s_mov_b32 exec_hi, 0
    buffer_load_dwordx4 v152, s[4:7], s30 offen lds
    s_mov_b32 exec_hi, -1
    v_mfma_f32_16x16x32_bf16 v[48:51], v[84:87], v[108:111], v[48:51]
    ds_read_b128 v[128:131], v147 offset:4096
    v_mfma_f32_16x16x32_bf16 v[52:55], v[76:79], v[112:115], v[52:55]
    ds_read_b128 v[132:135], v147 offset:6144
    v_mfma_f32_16x16x32_bf16 v[56:59], v[80:83], v[112:115], v[56:59]
    ds_read_b128 v[136:139], v147 offset:8192
    v_mfma_f32_16x16x32_bf16 v[60:63], v[84:87], v[112:115], v[60:63]
    v_mfma_f32_16x16x32_bf16 v[64:67], v[76:79], v[116:119], v[64:67]
    s_add_u32 s31, s31, 128
    s_cmp_ge_u32 s31, 1280
    s_cselect_b32 s31, 0, s31
    v_mfma_f32_16x16x32_bf16 v[68:71], v[80:83], v[116:119], v[68:71]
    v_mfma_f32_16x16x32_bf16 v[72:75], v[84:87], v[116:119], v[72:75]
    s_waitcnt vmcnt(5) lgkmcnt(0)
    s_barrier
    v_mfma_f32_16x16x32_bf16 v[16:19], v[88:91], v[120:123], v[16:19]
    ds_read_b64_tr_b16 v[76:77], v140 offset:24576
    v_mfma_f32_16x16x32_bf16 v[20:23], v[92:95], v[120:123], v[20:23]
    ds_read_b64_tr_b16 v[78:79], v140 offset:25088
    v_mfma_f32_16x16x32_bf16 v[24:27], v[96:99], v[120:123], v[24:27]
    ds_read_b64_tr_b16 v[80:81], v141 offset:24576
    s_add_u32 m0, s33, 0x0
    s_add_u32 s30, s31, 0x0
    buffer_load_dwordx4 v152, s[4:7], s30 offen lds
    v_mfma_f32_16x16x32_bf16 v[28:31], v[88:91], v[124:127], v[28:31]
    ds_read_b64_tr_b16 v[82:83], v141 offset:25088
    v_mfma_f32_16x16x32_bf16 v[32:35], v[92:95], v[124:127], v[32:35]
    ds_read_b64_tr_b16 v[84:85], v142 offset:24576
    v_mfma_f32_16x16x32_bf16 v[36:39], v[96:99], v[124:127], v[36:39]
    ds_read_b64_tr_b16 v[86:87], v142 offset:25088
    v_mfma_f32_16x16x32_bf16 v[40:43], v[88:91], v[128:131], v[40:43]
    ds_read_b128 v[100:103], v148 offset:0
    v_mfma_f32_16x16x32_bf16 v[44:47], v[92:95], v[128:131], v[44:47]
    ds_read_b128 v[104:107], v148 offset:2048
    s_add_u32 m0, s33, 0x400
    s_add_u32 s30, s31, 0x2800
    buffer_load_dwordx4 v153, s[4:7], s30 offen lds
    v_mfma_f32_16x16x32_bf16 v[48:51], v[96:99], v[128:131], v[48:51]
    ds_read_b128 v[108:111], v148 offset:4096
    v_mfma_f32_16x16x32_bf16 v[52:55], v[88:91], v[132:135], v[52:55]
    ds_read_b128 v[112:115], v148 offset:6144
    v_mfma_f32_16x16x32_bf16 v[56:59], v[92:95], v[132:135], v[56:59]
    ds_read_b128 v[116:119], v148 offset:8192
    v_mfma_f32_16x16x32_bf16 v[60:63], v[96:99], v[132:135], v[60:63]
    v_mfma_f32_16x16x32_bf16 v[64:67], v[88:91], v[136:139], v[64:67]
    s_add_u32 m0, s33, 0x800
    s_add_u32 s30, s31, 0x5000
    buffer_load_dwordx4 v152, s[4:7], s30 offen lds
    v_mfma_f32_16x16x32_bf16 v[68:71], v[92:95], v[136:139], v[68:71]
    v_mfma_f32_16x16x32_bf16 v[72:75], v[96:99], v[136:139], v[72:75]
    s_waitcnt lgkmcnt(0)
    v_mfma_f32_16x16x32_bf16 v[16:19], v[76:79], v[100:103], v[16:19]
    ds_read_b64_tr_b16 v[88:89], v140 offset:36864
    v_mfma_f32_16x16x32_bf16 v[20:23], v[80:83], v[100:103], v[20:23]
    ds_read_b64_tr_b16 v[90:91], v140 offset:37376
    v_mfma_f32_16x16x32_bf16 v[24:27], v[84:87], v[100:103], v[24:27]
    ds_read_b64_tr_b16 v[92:93], v141 offset:36864
    s_add_u32 m0, s33, 0xc00
    s_add_u32 s30, s31, 0x7800
    buffer_load_dwordx4 v153, s[4:7], s30 offen lds
    v_mfma_f32_16x16x32_bf16 v[28:31], v[76:79], v[104:107], v[28:31]
    ds_read_b64_tr_b16 v[94:95], v141 offset:37376
    v_mfma_f32_16x16x32_bf16 v[32:35], v[80:83], v[104:107], v[32:35]
    ds_read_b64_tr_b16 v[96:97], v142 offset:36864
    v_mfma_f32_16x16x32_bf16 v[36:39], v[84:87], v[104:107], v[36:39]
    ds_read_b64_tr_b16 v[98:99], v142 offset:37376
    v_mfma_f32_16x16x32_bf16 v[40:43], v[76:79], v[108:111], v[40:43]
    ds_read_b128 v[120:123], v149 offset:0
    v_mfma_f32_16x16x32_bf16 v[44:47], v[80:83], v[108:111], v[44:47]
    ds_read_b128 v[124:127], v149 offset:2048
    s_add_u32 m0, s33, 0x1000
    s_add_u32 s30, s31, 0xa000
    s_mov_b32 exec_hi, 0
    buffer_load_dwordx4 v152, s[4:7], s30 offen lds
    s_mov_b32 exec_hi, -1
    v_mfma_f32_16x16x32_bf16 v[48:51], v[84:87], v[108:111], v[48:51]
    ds_read_b128 v[128:131], v149 offset:4096
    v_mfma_f32_16x16x32_bf16 v[52:55], v[76:79], v[112:115], v[52:55]
    ds_read_b128 v[132:135], v149 offset:6144
    v_mfma_f32_16x16x32_bf16 v[56:59], v[80:83], v[112:115], v[56:59]
    ds_read_b128 v[136:139], v149 offset:8192
    v_mfma_f32_16x16x32_bf16 v[60:63], v[84:87], v[112:115], v[60:63]
    v_mfma_f32_16x16x32_bf16 v[64:67], v[76:79], v[116:119], v[64:67]
    s_add_u32 s31, s31, 128
    s_cmp_ge_u32 s31, 1280
    s_cselect_b32 s31, 0, s31
    v_mfma_f32_16x16x32_bf16 v[68:71], v[80:83], v[116:119], v[68:71]
    v_mfma_f32_16x16x32_bf16 v[72:75], v[84:87], v[116:119], v[72:75]
    s_waitcnt vmcnt(5) lgkmcnt(0)
    s_barrier
    v_mfma_f32_16x16x32_bf16 v[16:19], v[88:91], v[120:123], v[16:19]
    ds_read_b64_tr_b16 v[76:77], v143 offset:0
    v_mfma_f32_16x16x32_bf16 v[20:23], v[92:95], v[120:123], v[20:23]
    ds_read_b64_tr_b16 v[78:79], v143 offset:512
    v_mfma_f32_16x16x32_bf16 v[24:27], v[96:99], v[120:123], v[24:27]
    ds_read_b64_tr_b16 v[80:81], v144 offset:0
    v_mfma_f32_16x16x32_bf16 v[28:31], v[88:91], v[124:127], v[28:31]
    ds_read_b64_tr_b16 v[82:83], v144 offset:512
    v_mfma_f32_16x16x32_bf16 v[32:35], v[92:95], v[124:127], v[32:35]
    ds_read_b64_tr_b16 v[84:85], v145 offset:0
    v_mfma_f32_16x16x32_bf16 v[36:39], v[96:99], v[124:127], v[36:39]
    ds_read_b64_tr_b16 v[86:87], v145 offset:512
    v_mfma_f32_16x16x32_bf16 v[40:43], v[88:91], v[128:131], v[40:43]
    ds_read_b128 v[100:103], v148 offset:18432
    v_mfma_f32_16x16x32_bf16 v[44:47], v[92:95], v[128:131], v[44:47]
    ds_read_b128 v[104:107], v148 offset:20480
    v_mfma_f32_16x16x32_bf16 v[48:51], v[96:99], v[128:131], v[48:51]
    ds_read_b128 v[108:111], v148 offset:22528
    v_mfma_f32_16x16x32_bf16 v[52:55], v[88:91], v[132:135], v[52:55]
    ds_read_b128 v[112:115], v148 offset:24576
    v_mfma_f32_16x16x32_bf16 v[56:59], v[92:95], v[132:135], v[56:59]
    ds_read_b128 v[116:119], v148 offset:26624
    v_mfma_f32_16x16x32_bf16 v[60:63], v[96:99], v[132:135], v[60:63]
    v_mfma_f32_16x16x32_bf16 v[64:67], v[88:91], v[136:139], v[64:67]
    v_mfma_f32_16x16x32_bf16 v[68:71], v[92:95], v[136:139], v[68:71]
    v_mfma_f32_16x16x32_bf16 v[72:75], v[96:99], v[136:139], v[72:75]
    s_cmp_eq_u32 s35, 1
    s_cbranch_scc0 LA_ks_6
    s_mov_b32 s30, 0x3000
    s_add_u32 m0, s37, 0x1000
    s_nop 0
    buffer_load_dwordx4 v12, s[12:15], s30 offen nt lds
    s_add_u32 m0, s37, 0x1400
    s_nop 0
    buffer_load_dwordx4 v13, s[12:15], s30 offen nt lds
    s_mov_b32 s30, 0x3600
    s_add_u32 m0, s37, 0x1800
    s_nop 0
    buffer_load_dwordx4 v12, s[12:15], s30 offen nt lds
    s_add_u32 m0, s37, 0x1c00
    s_nop 0
    buffer_load_dwordx4 v13, s[12:15], s30 offen nt lds
    s_mov_b32 s30, 0x3080
    s_add_u32 m0, s37, 0x0
    s_nop 0
    buffer_load_dwordx4 v12, s[12:15], s30 offen nt lds
    s_add_u32 m0, s37, 0x400
    s_nop 0
    buffer_load_dwordx4 v13, s[12:15], s30 offen nt lds
    s_mov_b32 s30, 0x3680
    s_add_u32 m0, s37, 0x800
    s_nop 0
    buffer_load_dwordx4 v12, s[12:15], s30 offen nt lds
    s_add_u32 m0, s37, 0xc00
    s_nop 0
    buffer_load_dwordx4 v13, s[12:15], s30 offen nt lds
LA_ks_6:
    s_cmp_eq_u32 s35, 0
    s_cbranch_scc0 LA_ks_5
    s_mov_b32 s30, 0x0
    s_add_u32 m0, s37, 0x0
    s_nop 0
    buffer_load_dwordx4 v12, s[12:15], s30 offen nt lds
    s_add_u32 m0, s37, 0x400
    s_nop 0
    buffer_load_dwordx4 v13, s[12:15], s30 offen nt lds
    s_mov_b32 s30, 0x600
    s_add_u32 m0, s37, 0x800
    s_nop 0
    buffer_load_dwordx4 v12, s[12:15], s30 offen nt lds
    s_add_u32 m0, s37, 0xc00
    s_nop 0
    buffer_load_dwordx4 v13, s[12:15], s30 offen nt lds
    s_mov_b32 s30, 0x80
    s_add_u32 m0, s37, 0x1000
    s_nop 0
    buffer_load_dwordx4 v12, s[12:15], s30 offen nt lds
    s_add_u32 m0, s37, 0x1400
    s_nop 0
    buffer_load_dwordx4 v13, s[12:15], s30 offen nt lds
    s_mov_b32 s30, 0x680
    s_add_u32 m0, s37, 0x1800
    s_nop 0
    buffer_load_dwordx4 v12, s[12:15], s30 offen nt lds
    s_add_u32 m0, s37, 0x1c00
    s_nop 0
    buffer_load_dwordx4 v13, s[12:15], s30 offen nt lds
LA_ks_5:
    s_waitcnt lgkmcnt(0)
    v_mfma_f32_16x16x32_bf16 v[16:19], v[76:79], v[100:103], v[16:19]
    ds_read_b64_tr_b16 v[88:89], v143 offset:12288
    v_mfma_f32_16x16x32_bf16 v[20:23], v[80:83], v[100:103], v[20:23]
    ds_read_b64_tr_b16 v[90:91], v143 offset:12800
    v_mfma_f32_16x16x32_bf16 v[24:27], v[84:87], v[100:103], v[24:27]
    ds_read_b64_tr_b16 v[92:93], v144 offset:12288
    v_mfma_f32_16x16x32_bf16 v[28:31], v[76:79], v[104:107], v[28:31]
    ds_read_b64_tr_b16 v[94:95], v144 offset:12800
    v_mfma_f32_16x16x32_bf16 v[32:35], v[80:83], v[104:107], v[32:35]
    ds_read_b64_tr_b16 v[96:97], v145 offset:12288
    v_mfma_f32_16x16x32_bf16 v[36:39], v[84:87], v[104:107], v[36:39]
    ds_read_b64_tr_b16 v[98:99], v145 offset:12800
    v_mfma_f32_16x16x32_bf16 v[40:43], v[76:79], v[108:111], v[40:43]
    ds_read_b128 v[120:123], v149 offset:18432
    v_mfma_f32_16x16x32_bf16 v[44:47], v[80:83], v[108:111], v[44:47]
    ds_read_b128 v[124:127], v149 offset:20480
    v_mfma_f32_16x16x32_bf16 v[48:51], v[84:87], v[108:111], v[48:51]
    ds_read_b128 v[128:131], v149 offset:22528
    v_mfma_f32_16x16x32_bf16 v[52:55], v[76:79], v[112:115], v[52:55]
    ds_read_b128 v[132:135], v149 offset:24576
    v_mfma_f32_16x16x32_bf16 v[56:59], v[80:83], v[112:115], v[56:59]
    ds_read_b128 v[136:139], v149 offset:26624
    v_mfma_f32_16x16x32_bf16 v[60:63], v[84:87], v[112:115], v[60:63]
    v_mfma_f32_16x16x32_bf16 v[64:67], v[76:79], v[116:119], v[64:67]
    v_mfma_f32_16x16x32_bf16 v[68:71], v[80:83], v[116:119], v[68:71]
    v_mfma_f32_16x16x32_bf16 v[72:75], v[84:87], v[116:119], v[72:75]
    s_cmp_eq_u32 s35, 2
    s_cbranch_scc0 LA_kw_7
    s_waitcnt vmcnt(0)
LA_kw_7:
    s_waitcnt vmcnt(8) lgkmcnt(0)
    s_barrier
    v_mfma_f32_16x16x32_bf16 v[16:19], v[88:91], v[120:123], v[16:19]
    ds_read_b64_tr_b16 v[76:77], v140 offset:0
    v_mfma_f32_16x16x32_bf16 v[20:23], v[92:95], v[120:123], v[20:23]
    ds_read_b64_tr_b16 v[78:79], v140 offset:512
    v_mfma_f32_16x16x32_bf16 v[24:27], v[96:99], v[120:123], v[24:27]
    ds_read_b64_tr_b16 v[80:81], v141 offset:0
    v_mfma_f32_16x16x32_bf16 v[28:31], v[88:91], v[124:127], v[28:31]
    ds_read_b64_tr_b16 v[82:83], v141 offset:512
    v_mfma_f32_16x16x32_bf16 v[32:35], v[92:95], v[124:127], v[32:35]
    ds_read_b64_tr_b16 v[84:85], v142 offset:0
    v_mfma_f32_16x16x32_bf16 v[36:39], v[96:99], v[124:127], v[36:39]
    ds_read_b64_tr_b16 v[86:87], v142 offset:512
    v_mfma_f32_16x16x32_bf16 v[40:43], v[88:91], v[128:131], v[40:43]
    ds_read_b128 v[100:103], v146 offset:0
    v_mfma_f32_16x16x32_bf16 v[44:47], v[92:95], v[128:131], v[44:47]
    ds_read_b128 v[104:107], v146 offset:2048
    v_mfma_f32_16x16x32_bf16 v[48:51], v[96:99], v[128:131], v[48:51]
    ds_read_b128 v[108:111], v146 offset:4096
    v_mfma_f32_16x16x32_bf16 v[52:55], v[88:91], v[132:135], v[52:55]
    ds_read_b128 v[112:115], v146 offset:6144
    v_mfma_f32_16x16x32_bf16 v[56:59], v[92:95], v[132:135], v[56:59]
    ds_read_b128 v[116:119], v146 offset:8192
    v_mfma_f32_16x16x32_bf16 v[60:63], v[96:99], v[132:135], v[60:63]
    v_mfma_f32_16x16x32_bf16 v[64:67], v[88:91], v[136:139], v[64:67]
    v_mfma_f32_16x16x32_bf16 v[68:71], v[92:95], v[136:139], v[68:71]
    v_mfma_f32_16x16x32_bf16 v[72:75], v[96:99], v[136:139], v[72:75]
    s_waitcnt lgkmcnt(0)
    v_mfma_f32_16x16x32_bf16 v[16:19], v[76:79], v[100:103], v[16:19]
    ds_read_b64_tr_b16 v[88:89], v140 offset:12288
    v_mfma_f32_16x16x32_bf16 v[20:23], v[80:83], v[100:103], v[20:23]
    ds_read_b64_tr_b16 v[90:91], v140 offset:12800
    v_mfma_f32_16x16x32_bf16 v[24:27], v[84:87], v[100:103], v[24:27]
    ds_read_b64_tr_b16 v[92:93], v141 offset:12288
    v_mfma_f32_16x16x32_bf16 v[28:31], v[76:79], v[104:107], v[28:31]
    ds_read_b64_tr_b16 v[94:95], v141 offset:12800
    v_mfma_f32_16x16x32_bf16 v[32:35], v[80:83], v[104:107], v[32:35]
    ds_read_b64_tr_b16 v[96:97], v142 offset:12288
    v_mfma_f32_16x16x32_bf16 v[36:39], v[84:87], v[104:107], v[36:39]
    ds_read_b64_tr_b16 v[98:99], v142 offset:12800
    v_mfma_f32_16x16x32_bf16 v[40:43], v[76:79], v[108:111], v[40:43]
    ds_read_b128 v[120:123], v147 offset:0
    v_mfma_f32_16x16x32_bf16 v[44:47], v[80:83], v[108:111], v[44:47]
    ds_read_b128 v[124:127], v147 offset:2048
    v_mfma_f32_16x16x32_bf16 v[48:51], v[84:87], v[108:111], v[48:51]
    ds_read_b128 v[128:131], v147 offset:4096
    v_mfma_f32_16x16x32_bf16 v[52:55], v[76:79], v[112:115], v[52:55]
    ds_read_b128 v[132:135], v147 offset:6144
    v_mfma_f32_16x16x32_bf16 v[56:59], v[80:83], v[112:115], v[56:59]
    ds_read_b128 v[136:139], v147 offset:8192
    v_mfma_f32_16x16x32_bf16 v[60:63], v[84:87], v[112:115], v[60:63]
    v_mfma_f32_16x16x32_bf16 v[64:67], v[76:79], v[116:119], v[64:67]
    v_mfma_f32_16x16x32_bf16 v[68:71], v[80:83], v[116:119], v[68:71]
    v_mfma_f32_16x16x32_bf16 v[72:75], v[84:87], v[116:119], v[72:75]
    s_waitcnt lgkmcnt(0)
    s_barrier
    v_mfma_f32_16x16x32_bf16 v[16:19], v[88:91], v[120:123], v[16:19]
    v_mfma_f32_16x16x32_bf16 v[20:23], v[92:95], v[120:123], v[20:23]
    v_mfma_f32_16x16x32_bf16 v[24:27], v[96:99], v[120:123], v[24:27]
    v_mfma_f32_16x16x32_bf16 v[28:31], v[88:91], v[124:127], v[28:31]
    v_mfma_f32_16x16x32_bf16 v[32:35], v[92:95], v[124:127], v[32:35]
    v_mfma_f32_16x16x32_bf16 v[36:39], v[96:99], v[124:127], v[36:39]
    v_mfma_f32_16x16x32_bf16 v[40:43], v[88:91], v[128:131], v[40:43]
    v_mfma_f32_16x16x32_bf16 v[44:47], v[92:95], v[128:131], v[44:47]
    v_mfma_f32_16x16x32_bf16 v[48:51], v[96:99], v[128:131], v[48:51]
    v_mfma_f32_16x16x32_bf16 v[52:55], v[88:91], v[132:135], v[52:55]
    v_mfma_f32_16x16x32_bf16 v[56:59], v[92:95], v[132:135], v[56:59]
    v_mfma_f32_16x16x32_bf16 v[60:63], v[96:99], v[132:135], v[60:63]
    v_mfma_f32_16x16x32_bf16 v[64:67], v[88:91], v[136:139], v[64:67]
    v_mfma_f32_16x16x32_bf16 v[68:71], v[92:95], v[136:139], v[68:71]
    v_mfma_f32_16x16x32_bf16 v[72:75], v[96:99], v[136:139], v[72:75]
    s_nop 7
    v_cvt_pk_bf16_f32 v16, v16, v17
    v_cvt_pk_bf16_f32 v17, v18, v19
    ds_write_b64 v155, v[16:17] offset:0
    v_cvt_pk_bf16_f32 v20, v20, v21
    v_cvt_pk_bf16_f32 v21, v22, v23
    ds_write_b64 v156, v[20:21] offset:0
    v_cvt_pk_bf16_f32 v24, v24, v25
    v_cvt_pk_bf16_f32 v25, v26, v27
    ds_write_b64 v157, v[24:25] offset:0
    v_cvt_pk_bf16_f32 v28, v28, v29
    v_cvt_pk_bf16_f32 v29, v30, v31
    ds_write_b64 v155, v[28:29] offset:1024
    v_cvt_pk_bf16_f32 v32, v32, v33
    v_cvt_pk_bf16_f32 v33, v34, v35
    ds_write_b64 v156, v[32:33] offset:1024
    v_cvt_pk_bf16_f32 v36, v36, v37
    v_cvt_pk_bf16_f32 v37, v38, v39
    ds_write_b64 v157, v[36:37] offset:1024
    v_cvt_pk_bf16_f32 v40, v40, v41
    v_cvt_pk_bf16_f32 v41, v42, v43
    ds_write_b64 v155, v[40:41] offset:2048
    v_cvt_pk_bf16_f32 v44, v44, v45
    v_cvt_pk_bf16_f32 v45, v46, v47
    ds_write_b64 v156, v[44:45] offset:2048
    v_cvt_pk_bf16_f32 v48, v48, v49
    v_cvt_pk_bf16_f32 v49, v50, v51
    ds_write_b64 v157, v[48:49] offset:2048
    v_cvt_pk_bf16_f32 v52, v52, v53
    v_cvt_pk_bf16_f32 v53, v54, v55
    ds_write_b64 v155, v[52:53] offset:3072
    v_cvt_pk_bf16_f32 v56, v56, v57
    v_cvt_pk_bf16_f32 v57, v58, v59
    ds_write_b64 v156, v[56:57] offset:3072
    v_cvt_pk_bf16_f32 v60, v60, v61
    v_cvt_pk_bf16_f32 v61, v62, v63
    ds_write_b64 v157, v[60:61] offset:3072
    v_cvt_pk_bf16_f32 v64, v64, v65
    v_cvt_pk_bf16_f32 v65, v66, v67
    ds_write_b64 v155, v[64:65] offset:4096
    v_cvt_pk_bf16_f32 v68, v68, v69
    v_cvt_pk_bf16_f32 v69, v70, v71
    ds_write_b64 v156, v[68:69] offset:4096
    v_cvt_pk_bf16_f32 v72, v72, v73
    v_cvt_pk_bf16_f32 v73, v74, v75
    ds_write_b64 v157, v[72:73] offset:4096
    s_waitcnt lgkmcnt(0)
LA_p1_done:
LA_p2_re:
    s_barrier
    s_cmp_eq_u32 s35, 2
    s_cbranch_scc0 LA_p2_go
    s_add_u32 m0, s38, 0x12000
    s_nop 0
    buffer_load_dwordx4 v2, s[16:19], s39 offen offset:0 nt lds
    s_add_u32 m0, s38, 0x12f80
    s_nop 0
    buffer_load_dwordx4 v2, s[16:19], s39 offen offset:128 nt lds
    s_add_u32 m0, s38, 0x13f00
    s_nop 0
    buffer_load_dwordx4 v2, s[16:19], s39 offen offset:256 nt lds
    s_mul_i32 s30, s25, 3072
    v_subrev_u32 v12, s30, v2
    s_and_b32 s30, s25, 1
    s_lshl_b32 s30, s30, 6
    v_xor_b32 v12, s30, v12
    v_xor_b32 v13, 64, v12
    s_add_u32 m0, s37, 0x0
    s_add_u32 s30, s0, 0
    buffer_load_dwordx4 v12, s[16:19], s30 offen nt lds
    s_add_u32 m0, s37, 0x400
    s_add_u32 s30, s0, 3072
    buffer_load_dwordx4 v13, s[16:19], s30 offen nt lds
    s_add_u32 m0, s37, 0x800
    s_add_u32 s30, s0, 6144
    buffer_load_dwordx4 v12, s[16:19], s30 offen nt lds
    s_add_u32 m0, s37, 0xc00
    s_add_u32 s30, s0, 9216
    buffer_load_dwordx4 v13, s[16:19], s30 offen nt lds
LA_p2_go:
    ds_read_b128 v[88:91], v1 offset:0
    ds_read_b128 v[92:95], v1 offset:1024
    ds_read_b128 v[96:99], v1 offset:2048
    ds_read_b128 v[100:103], v1 offset:3072
    s_setprio 2
    s_cmp_le_u32 s35, 0
    s_cbranch_scc0 LA_kt_9
    s_waitcnt vmcnt(6)
    ds_read_b128 v[160:163], v14 offset:0
    ds_read_b128 v[164:167], v15 offset:0
    s_waitcnt lgkmcnt(0)
    s_mov_b32 s30, 0x100
    s_add_u32 m0, s37, 0x0
    s_nop 0
    buffer_load_dwordx4 v12, s[12:15], s30 offen nt lds
    s_add_u32 m0, s37, 0x400
    s_nop 0
    buffer_load_dwordx4 v13, s[12:15], s30 offen nt lds
    s_waitcnt vmcnt(6)
    ds_read_b128 v[184:187], v14 offset:2048
    ds_read_b128 v[188:191], v15 offset:2048
    s_waitcnt lgkmcnt(0)
    s_mov_b32 s30, 0x700
    s_add_u32 m0, s37, 0x800
    s_nop 0
    buffer_load_dwordx4 v12, s[12:15], s30 offen nt lds
    s_add_u32 m0, s37, 0xc00
    s_nop 0
    buffer_load_dwordx4 v13, s[12:15], s30 offen nt lds
LA_kt_9:
    ds_read_b128 v[104:107], v1 offset:4096
    s_waitcnt lgkmcnt(4)
    v_mfma_f32_16x16x32_bf16 v[16:19], v[160:163], v[88:91], 0
    v_mfma_f32_16x16x32_bf16 v[52:55], v[184:187], v[88:91], 0
    ds_read_b128 v[108:111], v1 offset:5120
    s_waitcnt lgkmcnt(4)
    v_mfma_f32_16x16x32_bf16 v[20:23], v[160:163], v[92:95], 0
    v_mfma_f32_16x16x32_bf16 v[56:59], v[184:187], v[92:95], 0
    ds_read_b128 v[88:91], v1 offset:6144
    s_waitcnt lgkmcnt(4)
    v_mfma_f32_16x16x32_bf16 v[24:27], v[160:163], v[96:99], 0
    v_mfma_f32_16x16x32_bf16 v[60:63], v[184:187], v[96:99], 0
    ds_read_b128 v[92:95], v1 offset:7168
    s_waitcnt lgkmcnt(4)
    v_mfma_f32_16x16x32_bf16 v[28:31], v[160:163], v[100:103], 0
    v_mfma_f32_16x16x32_bf16 v[64:67], v[184:187], v[100:103], 0
    ds_read_b128 v[96:99], v1 offset:8192
    s_waitcnt lgkmcnt(4)
    v_mfma_f32_16x16x32_bf16 v[32:35], v[160:163], v[104:107], 0
    v_mfma_f32_16x16x32_bf16 v[68:71], v[184:187], v[104:107], 0
    ds_read_b128 v[100:103], v1 offset:9216
    s_waitcnt lgkmcnt(4)
    v_mfma_f32_16x16x32_bf16 v[36:39], v[160:163], v[108:111], 0
    v_mfma_f32_16x16x32_bf16 v[72:75], v[184:187], v[108:111], 0
    ds_read_b128 v[104:107], v1 offset:10240
    s_waitcnt lgkmcnt(4)
    v_mfma_f32_16x16x32_bf16 v[40:43], v[160:163], v[88:91], 0
    v_mfma_f32_16x16x32_bf16 v[76:79], v[184:187], v[88:91], 0
    ds_read_b128 v[108:111], v1 offset:11264
    s_waitcnt lgkmcnt(4)
    v_mfma_f32_16x16x32_bf16 v[44:47], v[160:163], v[92:95], 0
    v_mfma_f32_16x16x32_bf16 v[80:83], v[184:187], v[92:95], 0
    ds_read_b128 v[88:91], v1 offset:12288
    s_waitcnt lgkmcnt(4)
    v_mfma_f32_16x16x32_bf16 v[48:51], v[160:163], v[96:99], 0
    v_mfma_f32_16x16x32_bf16 v[84:87], v[184:187], v[96:99], 0
    ds_read_b128 v[92:95], v1 offset:13312
    s_waitcnt lgkmcnt(4)
    v_mfma_f32_16x16x32_bf16 v[16:19], v[164:167], v[100:103], v[16:19]
    v_mfma_f32_16x16x32_bf16 v[52:55], v[188:191], v[100:103], v[52:55]
    ds_read_b128 v[96:99], v1 offset:14336
    s_waitcnt lgkmcnt(4)
    v_mfma_f32_16x16x32_bf16 v[20:23], v[164:167], v[104:107], v[20:23]
    v_mfma_f32_16x16x32_bf16 v[56:59], v[188:191], v[104:107], v[56:59]
    ds_read_b128 v[100:103], v1 offset:15360
    s_waitcnt lgkmcnt(4)
    v_mfma_f32_16x16x32_bf16 v[24:27], v[164:167], v[108:111], v[24:27]
    v_mfma_f32_16x16x32_bf16 v[60:63], v[188:191], v[108:111], v[60:63]
    ds_read_b128 v[104:107], v1 offset:16384
    s_waitcnt lgkmcnt(4)
    v_mfma_f32_16x16x32_bf16 v[28:31], v[164:167], v[88:91], v[28:31]
    v_mfma_f32_16x16x32_bf16 v[64:67], v[188:191], v[88:91], v[64:67]
    ds_read_b128 v[108:111], v1 offset:17408
    s_waitcnt lgkmcnt(4)
    v_mfma_f32_16x16x32_bf16 v[32:35], v[164:167], v[92:95], v[32:35]
    v_mfma_f32_16x16x32_bf16 v[68:71], v[188:191], v[92:95], v[68:71]
    ds_read_b128 v[88:91], v1 offset:18432
    s_waitcnt lgkmcnt(4)
    v_mfma_f32_16x16x32_bf16 v[36:39], v[164:167], v[96:99], v[36:39]
    v_mfma_f32_16x16x32_bf16 v[72:75], v[188:191], v[96:99], v[72:75]
    ds_read_b128 v[92:95], v1 offset:19456
    s_waitcnt lgkmcnt(4)
    v_mfma_f32_16x16x32_bf16 v[40:43], v[164:167], v[100:103], v[40:43]
    v_mfma_f32_16x16x32_bf16 v[76:79], v[188:191], v[100:103], v[76:79]
    ds_read_b128 v[96:99], v1 offset:20480
    s_waitcnt lgkmcnt(4)
    v_mfma_f32_16x16x32_bf16 v[44:47], v[164:167], v[104:107], v[44:47]
    v_mfma_f32_16x16x32_bf16 v[80:83], v[188:191], v[104:107], v[80:83]
    ds_read_b128 v[100:103], v1 offset:21504
    s_waitcnt lgkmcnt(4)
    v_mfma_f32_16x16x32_bf16 v[48:51], v[164:167], v[108:111], v[48:51]
    v_mfma_f32_16x16x32_bf16 v[84:87], v[188:191], v[108:111], v[84:87]
    s_cmp_le_u32 s35, 0
    s_cbranch_scc0 LA_kt_10
    s_waitcnt vmcnt(6)
    ds_read_b128 v[168:171], v14 offset:4096
    ds_read_b128 v[172:175], v15 offset:4096
    s_waitcnt lgkmcnt(0)
    s_mov_b32 s30, 0x3000
    s_add_u32 m0, s37, 0x1000
    s_nop 0
    buffer_load_dwordx4 v12, s[12:15], s30 offen nt lds
    s_add_u32 m0, s37, 0x1400
    s_nop 0
    buffer_load_dwordx4 v13, s[12:15], s30 offen nt lds
    s_waitcnt vmcnt(6)
    ds_read_b128 v[192:195], v14 offset:6144
    ds_read_b128 v[196:199], v15 offset:6144
    s_waitcnt lgkmcnt(0)
    s_mov_b32 s30, 0x3600
    s_add_u32 m0, s37, 0x1800
    s_nop 0
    buffer_load_dwordx4 v12, s[12:15], s30 offen nt lds
    s_add_u32 m0, s37, 0x1c00
    s_nop 0
    buffer_load_dwordx4 v13, s[12:15], s30 offen nt lds
LA_kt_10:
    ds_read_b128 v[104:107], v1 offset:22528
    s_waitcnt lgkmcnt(4)
    v_mfma_f32_16x16x32_bf16 v[16:19], v[168:171], v[88:91], v[16:19]
    v_mfma_f32_16x16x32_bf16 v[52:55], v[192:195], v[88:91], v[52:55]
    ds_read_b128 v[108:111], v1 offset:23552
    s_waitcnt lgkmcnt(4)
    v_mfma_f32_16x16x32_bf16 v[20:23], v[168:171], v[92:95], v[20:23]
    v_mfma_f32_16x16x32_bf16 v[56:59], v[192:195], v[92:95], v[56:59]
    ds_read_b128 v[88:91], v1 offset:24576
    s_waitcnt lgkmcnt(4)
    v_mfma_f32_16x16x32_bf16 v[24:27], v[168:171], v[96:99], v[24:27]
    v_mfma_f32_16x16x32_bf16 v[60:63], v[192:195], v[96:99], v[60:63]
    ds_read_b128 v[92:95], v1 offset:25600
    s_waitcnt lgkmcnt(4)
    v_mfma_f32_16x16x32_bf16 v[28:31], v[168:171], v[100:103], v[28:31]
    v_mfma_f32_16x16x32_bf16 v[64:67], v[192:195], v[100:103], v[64:67]
    ds_read_b128 v[96:99], v1 offset:26624
    s_waitcnt lgkmcnt(4)
    v_mfma_f32_16x16x32_bf16 v[32:35], v[168:171], v[104:107], v[32:35]
    v_mfma_f32_16x16x32_bf16 v[68:71], v[192:195], v[104:107], v[68:71]
    ds_read_b128 v[100:103], v1 offset:27648
    s_waitcnt lgkmcnt(4)
    v_mfma_f32_16x16x32_bf16 v[36:39], v[168:171], v[108:111], v[36:39]
    v_mfma_f32_16x16x32_bf16 v[72:75], v[192:195], v[108:111], v[72:75]
    ds_read_b128 v[104:107], v1 offset:28672
    s_waitcnt lgkmcnt(4)
    v_mfma_f32_16x16x32_bf16 v[40:43], v[168:171], v[88:91], v[40:43]
    v_mfma_f32_16x16x32_bf16 v[76:79], v[192:195], v[88:91], v[76:79]
    ds_read_b128 v[108:111], v1 offset:29696
    s_waitcnt lgkmcnt(4)
    v_mfma_f32_16x16x32_bf16 v[44:47], v[168:171], v[92:95], v[44:47]
    v_mfma_f32_16x16x32_bf16 v[80:83], v[192:195], v[92:95], v[80:83]
    ds_read_b128 v[88:91], v1 offset:30720
    s_waitcnt lgkmcnt(4)
    v_mfma_f32_16x16x32_bf16 v[48:51], v[168:171], v[96:99], v[48:51]
    v_mfma_f32_16x16x32_bf16 v[84:87], v[192:195], v[96:99], v[84:87]
    ds_read_b128 v[92:95], v1 offset:31744
    s_waitcnt lgkmcnt(4)
    v_mfma_f32_16x16x32_bf16 v[16:19], v[172:175], v[100:103], v[16:19]
    v_mfma_f32_16x16x32_bf16 v[52:55], v[196:199], v[100:103], v[52:55]
    ds_read_b128 v[96:99], v1 offset:32768
    s_waitcnt lgkmcnt(4)
    v_mfma_f32_16x16x32_bf16 v[20:23], v[172:175], v[104:107], v[20:23]
    v_mfma_f32_16x16x32_bf16 v[56:59], v[196:199], v[104:107], v[56:59]
    ds_read_b128 v[100:103], v1 offset:33792
    s_waitcnt lgkmcnt(4)
    v_mfma_f32_16x16x32_bf16 v[24:27], v[172:175], v[108:111], v[24:27]
    v_mfma_f32_16x16x32_bf16 v[60:63], v[196:199], v[108:111], v[60:63]
    ds_read_b128 v[104:107], v1 offset:34816
    s_waitcnt lgkmcnt(4)
    v_mfma_f32_16x16x32_bf16 v[28:31], v[172:175], v[88:91], v[28:31]
    v_mfma_f32_16x16x32_bf16 v[64:67], v[196:199], v[88:91], v[64:67]
    ds_read_b128 v[108:111], v1 offset:35840
    s_waitcnt lgkmcnt(4)
    v_mfma_f32_16x16x32_bf16 v[32:35], v[172:175], v[92:95], v[32:35]
    v_mfma_f32_16x16x32_bf16 v[68:71], v[196:199], v[92:95], v[68:71]
    ds_read_b128 v[88:91], v1 offset:36864
    s_waitcnt lgkmcnt(4)
    v_mfma_f32_16x16x32_bf16 v[36:39], v[172:175], v[96:99], v[36:39]
    v_mfma_f32_16x16x32_bf16 v[72:75], v[196:199], v[96:99], v[72:75]
    ds_read_b128 v[92:95], v1 offset:37888
    s_waitcnt lgkmcnt(4)
    v_mfma_f32_16x16x32_bf16 v[40:43], v[172:175], v[100:103], v[40:43]
    v_mfma_f32_16x16x32_bf16 v[76:79], v[196:199], v[100:103], v[76:79]
    ds_read_b128 v[96:99], v1 offset:38912
    s_waitcnt lgkmcnt(4)
    v_mfma_f32_16x16x32_bf16 v[44:47], v[172:175], v[104:107], v[44:47]
    v_mfma_f32_16x16x32_bf16 v[80:83], v[196:199], v[104:107], v[80:83]
    ds_read_b128 v[100:103], v1 offset:39936
    s_waitcnt lgkmcnt(4)
    v_mfma_f32_16x16x32_bf16 v[48:51], v[172:175], v[108:111], v[48:51]
    v_mfma_f32_16x16x32_bf16 v[84:87], v[196:199], v[108:111], v[84:87]
    s_cmp_le_u32 s35, 0
    s_cbranch_scc0 LA_kt_11
    s_waitcnt vmcnt(6)
    ds_read_b128 v[176:179], v14 offset:0
    ds_read_b128 v[180:183], v15 offset:0
    s_waitcnt lgkmcnt(0)
    s_mov_b32 s30, 0x3080
    s_add_u32 m0, s37, 0x0
    s_nop 0
    buffer_load_dwordx4 v12, s[12:15], s30 offen nt lds
    s_add_u32 m0, s37, 0x400
    s_nop 0
    buffer_load_dwordx4 v13, s[12:15], s30 offen nt lds
    s_waitcnt vmcnt(6)
    ds_read_b128 v[200:203], v14 offset:2048
    ds_read_b128 v[204:207], v15 offset:2048
    s_waitcnt lgkmcnt(0)
    s_mov_b32 s30, 0x3680
    s_add_u32 m0, s37, 0x800
    s_nop 0
    buffer_load_dwordx4 v12, s[12:15], s30 offen nt lds
    s_add_u32 m0, s37, 0xc00
    s_nop 0
    buffer_load_dwordx4 v13, s[12:15], s30 offen nt lds
LA_kt_11:
    ds_read_b128 v[104:107], v1 offset:40960
    s_waitcnt lgkmcnt(4)
    v_mfma_f32_16x16x32_bf16 v[16:19], v[176:179], v[88:91], v[16:19]
    v_mfma_f32_16x16x32_bf16 v[52:55], v[200:203], v[88:91], v[52:55]
    ds_read_b128 v[108:111], v1 offset:41984
    s_waitcnt lgkmcnt(4)
    v_mfma_f32_16x16x32_bf16 v[20:23], v[176:179], v[92:95], v[20:23]
    v_mfma_f32_16x16x32_bf16 v[56:59], v[200:203], v[92:95], v[56:59]
    ds_read_b128 v[88:91], v1 offset:43008
    s_waitcnt lgkmcnt(4)
    v_mfma_f32_16x16x32_bf16 v[24:27], v[176:179], v[96:99], v[24:27]
    v_mfma_f32_16x16x32_bf16 v[60:63], v[200:203], v[96:99], v[60:63]
    ds_read_b128 v[92:95], v1 offset:44032
    s_waitcnt lgkmcnt(4)
    v_mfma_f32_16x16x32_bf16 v[28:31], v[176:179], v[100:103], v[28:31]
    v_mfma_f32_16x16x32_bf16 v[64:67], v[200:203], v[100:103], v[64:67]
    ds_read_b128 v[96:99], v1 offset:45056
    s_waitcnt lgkmcnt(4)
    v_mfma_f32_16x16x32_bf16 v[32:35], v[176:179], v[104:107], v[32:35]
    v_mfma_f32_16x16x32_bf16 v[68:71], v[200:203], v[104:107], v[68:71]
    ds_read_b128 v[100:103], v1 offset:46080
    s_waitcnt lgkmcnt(4)
    v_mfma_f32_16x16x32_bf16 v[36:39], v[176:179], v[108:111], v[36:39]
    v_mfma_f32_16x16x32_bf16 v[72:75], v[200:203], v[108:111], v[72:75]
    ds_read_b128 v[104:107], v1 offset:47104
    s_waitcnt lgkmcnt(4)
    v_mfma_f32_16x16x32_bf16 v[40:43], v[176:179], v[88:91], v[40:43]
    v_mfma_f32_16x16x32_bf16 v[76:79], v[200:203], v[88:91], v[76:79]
    ds_read_b128 v[108:111], v1 offset:48128
    s_waitcnt lgkmcnt(4)
    v_mfma_f32_16x16x32_bf16 v[44:47], v[176:179], v[92:95], v[44:47]
    v_mfma_f32_16x16x32_bf16 v[80:83], v[200:203], v[92:95], v[80:83]
    ds_read_b128 v[88:91], v1 offset:49152
    s_waitcnt lgkmcnt(4)
    v_mfma_f32_16x16x32_bf16 v[48:51], v[176:179], v[96:99], v[48:51]
    v_mfma_f32_16x16x32_bf16 v[84:87], v[200:203], v[96:99], v[84:87]
    ds_read_b128 v[92:95], v1 offset:50176
    s_waitcnt lgkmcnt(4)
    v_mfma_f32_16x16x32_bf16 v[16:19], v[180:183], v[100:103], v[16:19]
    v_mfma_f32_16x16x32_bf16 v[52:55], v[204:207], v[100:103], v[52:55]
    ds_read_b128 v[96:99], v1 offset:51200
    s_waitcnt lgkmcnt(4)
    v_mfma_f32_16x16x32_bf16 v[20:23], v[180:183], v[104:107], v[20:23]
    v_mfma_f32_16x16x32_bf16 v[56:59], v[204:207], v[104:107], v[56:59]
    ds_read_b128 v[100:103], v1 offset:52224
    s_waitcnt lgkmcnt(4)
    v_mfma_f32_16x16x32_bf16 v[24:27], v[180:183], v[108:111], v[24:27]
    v_mfma_f32_16x16x32_bf16 v[60:63], v[204:207], v[108:111], v[60:63]
    ds_read_b128 v[104:107], v1 offset:53248
    s_waitcnt lgkmcnt(4)
    v_mfma_f32_16x16x32_bf16 v[28:31], v[180:183], v[88:91], v[28:31]
    v_mfma_f32_16x16x32_bf16 v[64:67], v[204:207], v[88:91], v[64:67]
    ds_read_b128 v[108:111], v1 offset:54272
    s_waitcnt lgkmcnt(4)
    v_mfma_f32_16x16x32_bf16 v[32:35], v[180:183], v[92:95], v[32:35]
    v_mfma_f32_16x16x32_bf16 v[68:71], v[204:207], v[92:95], v[68:71]
    ds_read_b128 v[188:191], v1 offset:0
    s_waitcnt lgkmcnt(4)
    v_mfma_f32_16x16x32_bf16 v[36:39], v[180:183], v[96:99], v[36:39]
    v_mfma_f32_16x16x32_bf16 v[72:75], v[204:207], v[96:99], v[72:75]
    ds_read_b128 v[192:195], v1 offset:1024
    s_waitcnt lgkmcnt(4)
    v_mfma_f32_16x16x32_bf16 v[40:43], v[180:183], v[100:103], v[40:43]
    v_mfma_f32_16x16x32_bf16 v[76:79], v[204:207], v[100:103], v[76:79]
    ds_read_b128 v[196:199], v1 offset:2048
    s_waitcnt lgkmcnt(4)
    v_mfma_f32_16x16x32_bf16 v[44:47], v[180:183], v[104:107], v[44:47]
    v_mfma_f32_16x16x32_bf16 v[80:83], v[204:207], v[104:107], v[80:83]
    ds_read_b128 v[200:203], v1 offset:3072
    s_waitcnt lgkmcnt(4)
    v_mfma_f32_16x16x32_bf16 v[48:51], v[180:183], v[108:111], v[48:51]
    v_mfma_f32_16x16x32_bf16 v[84:87], v[204:207], v[108:111], v[84:87]
    s_setprio 0
    s_nop 4
    v_max3_f32 v160, v16, v17, v18
    v_max3_f32 v180, v19, v52, v53
    v_max3_f32 v160, v160, v54, v55
    v_max_f32 v160, v160, v180
    v_mul_f32 v160, s36, v160
    v_fma_f32 v16, v16, s36, -v160
    v_fma_f32 v17, v17, s36, -v160
    v_fma_f32 v18, v18, s36, -v160
    v_fma_f32 v19, v19, s36, -v160
    v_fma_f32 v52, v52, s36, -v160
    v_fma_f32 v53, v53, s36, -v160
    v_fma_f32 v54, v54, s36, -v160
    v_fma_f32 v55, v55, s36, -v160
    v_exp_f32 v16, v16
    v_exp_f32 v17, v17
    v_exp_f32 v18, v18
    v_exp_f32 v19, v19
    v_exp_f32 v52, v52
    v_exp_f32 v53, v53
    v_exp_f32 v54, v54
    v_exp_f32 v55, v55
    v_max3_f32 v161, v20, v21, v22
    v_max3_f32 v180, v23, v56, v57
    v_max3_f32 v161, v161, v58, v59
    v_max_f32 v161, v161, v180
    v_mul_f32 v161, s36, v161
    v_fma_f32 v20, v20, s36, -v161
    v_fma_f32 v21, v21, s36, -v161
    v_fma_f32 v22, v22, s36, -v161
    v_fma_f32 v23, v23, s36, -v161
    v_fma_f32 v56, v56, s36, -v161
    v_fma_f32 v57, v57, s36, -v161
    v_fma_f32 v58, v58, s36, -v161
    v_fma_f32 v59, v59, s36, -v161
    v_exp_f32 v20, v20
    v_exp_f32 v21, v21
    v_exp_f32 v22, v22
    v_exp_f32 v23, v23
    v_exp_f32 v56, v56
    v_exp_f32 v57, v57
    v_exp_f32 v58, v58
    v_exp_f32 v59, v59
    v_max3_f32 v162, v24, v25, v26
    v_max3_f32 v180, v27, v60, v61
    v_max3_f32 v162, v162, v62, v63
    v_max_f32 v162, v162, v180
    v_mul_f32 v162, s36, v162
    v_fma_f32 v24, v24, s36, -v162
    v_fma_f32 v25, v25, s36, -v162
    v_fma_f32 v26, v26, s36, -v162
    v_fma_f32 v27, v27, s36, -v162
    v_fma_f32 v60, v60, s36, -v162
    v_fma_f32 v61, v61, s36, -v162
    v_fma_f32 v62, v62, s36, -v162
    v_fma_f32 v63, v63, s36, -v162
    v_exp_f32 v24, v24
    v_exp_f32 v25, v25
    v_exp_f32 v26, v26
    v_exp_f32 v27, v27
    v_exp_f32 v60, v60
    v_exp_f32 v61, v61
    v_exp_f32 v62, v62
    v_exp_f32 v63, v63
    v_max3_f32 v163, v28, v29, v30
    v_max3_f32 v180, v31, v64, v65
    v_max3_f32 v163, v163, v66, v67
    v_max_f32 v163, v163, v180
    v_mul_f32 v163, s36, v163
    v_fma_f32 v28, v28, s36, -v163
    v_fma_f32 v29, v29, s36, -v163
    v_fma_f32 v30, v30, s36, -v163
    v_fma_f32 v31, v31, s36, -v163
    v_fma_f32 v64, v64, s36, -v163
    v_fma_f32 v65, v65, s36, -v163
    v_fma_f32 v66, v66, s36, -v163
    v_fma_f32 v67, v67, s36, -v163
    v_exp_f32 v28, v28
    v_exp_f32 v29, v29
    v_exp_f32 v30, v30
    v_exp_f32 v31, v31
    v_exp_f32 v64, v64
    v_exp_f32 v65, v65
    v_exp_f32 v66, v66
    v_exp_f32 v67, v67
    v_max3_f32 v164, v32, v33, v34
    v_max3_f32 v180, v35, v68, v69
    v_max3_f32 v164, v164, v70, v71
    v_max_f32 v164, v164, v180
    v_mul_f32 v164, s36, v164
    v_fma_f32 v32, v32, s36, -v164
    v_fma_f32 v33, v33, s36, -v164
    v_fma_f32 v34, v34, s36, -v164
    v_fma_f32 v35, v35, s36, -v164
    v_fma_f32 v68, v68, s36, -v164
    v_fma_f32 v69, v69, s36, -v164
    v_fma_f32 v70, v70, s36, -v164
    v_fma_f32 v71, v71, s36, -v164
    v_exp_f32 v32, v32
    v_exp_f32 v33, v33
    v_exp_f32 v34, v34
    v_exp_f32 v35, v35
    v_exp_f32 v68, v68
    v_exp_f32 v69, v69
    v_exp_f32 v70, v70
    v_exp_f32 v71, v71
    v_max3_f32 v165, v36, v37, v38
    v_max3_f32 v180, v39, v72, v73
    v_max3_f32 v165, v165, v74, v75
    v_max_f32 v165, v165, v180
    v_mul_f32 v165, s36, v165
    v_fma_f32 v36, v36, s36, -v165
    v_fma_f32 v37, v37, s36, -v165
    v_fma_f32 v38, v38, s36, -v165
    v_fma_f32 v39, v39, s36, -v165
    v_fma_f32 v72, v72, s36, -v165
    v_fma_f32 v73, v73, s36, -v165
    v_fma_f32 v74, v74, s36, -v165
    v_fma_f32 v75, v75, s36, -v165
    v_exp_f32 v36, v36
    v_exp_f32 v37, v37
    v_exp_f32 v38, v38
    v_exp_f32 v39, v39
    v_exp_f32 v72, v72
    v_exp_f32 v73, v73
    v_exp_f32 v74, v74
    v_exp_f32 v75, v75
    v_max3_f32 v166, v40, v41, v42
    v_max3_f32 v180, v43, v76, v77
    v_max3_f32 v166, v166, v78, v79
    v_max_f32 v166, v166, v180
    v_mul_f32 v166, s36, v166
    v_fma_f32 v40, v40, s36, -v166
    v_fma_f32 v41, v41, s36, -v166
    v_fma_f32 v42, v42, s36, -v166
    v_fma_f32 v43, v43, s36, -v166
    v_fma_f32 v76, v76, s36, -v166
    v_fma_f32 v77, v77, s36, -v166
    v_fma_f32 v78, v78, s36, -v166
    v_fma_f32 v79, v79, s36, -v166
    v_exp_f32 v40, v40
    v_exp_f32 v41, v41
    v_exp_f32 v42, v42
    v_exp_f32 v43, v43
    v_exp_f32 v76, v76
    v_exp_f32 v77, v77
    v_exp_f32 v78, v78
    v_exp_f32 v79, v79
    v_max3_f32 v167, v44, v45, v46
    v_max3_f32 v180, v47, v80, v81
    v_max3_f32 v167, v167, v82, v83
    v_max_f32 v167, v167, v180
    v_mul_f32 v167, s36, v167
    v_fma_f32 v44, v44, s36, -v167
    v_fma_f32 v45, v45, s36, -v167
    v_fma_f32 v46, v46, s36, -v167
    v_fma_f32 v47, v47, s36, -v167
    v_fma_f32 v80, v80, s36, -v167
    v_fma_f32 v81, v81, s36, -v167
    v_fma_f32 v82, v82, s36, -v167
    v_fma_f32 v83, v83, s36, -v167
    v_exp_f32 v44, v44
    v_exp_f32 v45, v45
    v_exp_f32 v46, v46
    v_exp_f32 v47, v47
    v_exp_f32 v80, v80
    v_exp_f32 v81, v81
    v_exp_f32 v82, v82
    v_exp_f32 v83, v83
    s_setprio 2
    s_cmp_le_u32 s35, 1
    s_cbranch_scc0 LA_kt_12
    s_waitcnt vmcnt(6)
    ds_read_b128 v[208:211], v14 offset:4096
    ds_read_b128 v[212:215], v15 offset:4096
    s_waitcnt lgkmcnt(0)
    s_mov_b32 s30, 0x3100
    s_add_u32 m0, s37, 0x1000
    s_nop 0
    buffer_load_dwordx4 v12, s[12:15], s30 offen nt lds
    s_add_u32 m0, s37, 0x1400
    s_nop 0
    buffer_load_dwordx4 v13, s[12:15], s30 offen nt lds
    s_waitcnt vmcnt(6)
    ds_read_b128 v[232:235], v14 offset:6144
    ds_read_b128 v[236:239], v15 offset:6144
    s_waitcnt lgkmcnt(0)
    s_mov_b32 s30, 0x3700
    s_add_u32 m0, s37, 0x1800
    s_nop 0
    buffer_load_dwordx4 v12, s[12:15], s30 offen nt lds
    s_add_u32 m0, s37, 0x1c00
    s_nop 0
    buffer_load_dwordx4 v13, s[12:15], s30 offen nt lds
    s_add_u32 m0, s38, 0x12000
    s_nop 0
    buffer_load_dwordx4 v2, s[16:19], s39 offen offset:0 nt lds
    s_add_u32 m0, s38, 0x12f80
    s_nop 0
    buffer_load_dwordx4 v2, s[16:19], s39 offen offset:128 nt lds
    s_add_u32 m0, s38, 0x13f00
    s_nop 0
    buffer_load_dwordx4 v2, s[16:19], s39 offen offset:256 nt lds
LA_kt_12:
    ds_read_b128 v[4:7], v1 offset:4096
    s_waitcnt lgkmcnt(4)
    v_mfma_f32_16x16x32_bf16 v[88:91], v[208:211], v[188:191], 0
    v_mfma_f32_16x16x32_bf16 v[124:127], v[232:235], v[188:191], 0
    ds_read_b128 v[8:11], v1 offset:5120
    s_waitcnt lgkmcnt(4)
    v_mfma_f32_16x16x32_bf16 v[92:95], v[208:211], v[192:195], 0
    v_mfma_f32_16x16x32_bf16 v[128:131], v[232:235], v[192:195], 0
    ds_read_b128 v[188:191], v1 offset:6144
    s_waitcnt lgkmcnt(4)
    v_mfma_f32_16x16x32_bf16 v[96:99], v[208:211], v[196:199], 0
    v_mfma_f32_16x16x32_bf16 v[132:135], v[232:235], v[196:199], 0
    ds_read_b128 v[192:195], v1 offset:7168
    s_waitcnt lgkmcnt(4)
    v_mfma_f32_16x16x32_bf16 v[100:103], v[208:211], v[200:203], 0
    v_mfma_f32_16x16x32_bf16 v[136:139], v[232:235], v[200:203], 0
    ds_read_b128 v[196:199], v1 offset:8192
    s_waitcnt lgkmcnt(4)
    v_mfma_f32_16x16x32_bf16 v[104:107], v[208:211], v[4:7], 0
    v_mfma_f32_16x16x32_bf16 v[140:143], v[232:235], v[4:7], 0
    ds_read_b128 v[200:203], v1 offset:9216
    s_waitcnt lgkmcnt(4)
    v_mfma_f32_16x16x32_bf16 v[108:111], v[208:211], v[8:11], 0
    v_mfma_f32_16x16x32_bf16 v[144:147], v[232:235], v[8:11], 0
    ds_read_b128 v[4:7], v1 offset:10240
    s_waitcnt lgkmcnt(4)
    v_mfma_f32_16x16x32_bf16 v[112:115], v[208:211], v[188:191], 0
    v_mfma_f32_16x16x32_bf16 v[148:151], v[232:235], v[188:191], 0
    ds_read_b128 v[8:11], v1 offset:11264
    s_waitcnt lgkmcnt(4)
    v_mfma_f32_16x16x32_bf16 v[116:119], v[208:211], v[192:195], 0
    v_mfma_f32_16x16x32_bf16 v[152:155], v[232:235], v[192:195], 0
    ds_read_b128 v[188:191], v1 offset:12288
    s_waitcnt lgkmcnt(4)
    v_mfma_f32_16x16x32_bf16 v[120:123], v[208:211], v[196:199], 0
    v_mfma_f32_16x16x32_bf16 v[156:159], v[232:235], v[196:199], 0
    ds_read_b128 v[192:195], v1 offset:13312
    s_waitcnt lgkmcnt(4)
    v_mfma_f32_16x16x32_bf16 v[88:91], v[212:215], v[200:203], v[88:91]
    v_mfma_f32_16x16x32_bf16 v[124:127], v[236:239], v[200:203], v[124:127]
    ds_read_b128 v[196:199], v1 offset:14336
    s_waitcnt lgkmcnt(4)
    v_mfma_f32_16x16x32_bf16 v[92:95], v[212:215], v[4:7], v[92:95]
    v_mfma_f32_16x16x32_bf16 v[128:131], v[236:239], v[4:7], v[128:131]
    ds_read_b128 v[200:203], v1 offset:15360
    s_waitcnt lgkmcnt(4)
    v_mfma_f32_16x16x32_bf16 v[96:99], v[212:215], v[8:11], v[96:99]
    v_mfma_f32_16x16x32_bf16 v[132:135], v[236:239], v[8:11], v[132:135]
    ds_read_b128 v[4:7], v1 offset:16384
    s_waitcnt lgkmcnt(4)
    v_mfma_f32_16x16x32_bf16 v[100:103], v[212:215], v[188:191], v[100:103]
    v_mfma_f32_16x16x32_bf16 v[136:139], v[236:239], v[188:191], v[136:139]
    ds_read_b128 v[8:11], v1 offset:17408
    s_waitcnt lgkmcnt(4)
    v_mfma_f32_16x16x32_bf16 v[104:107], v[212:215], v[192:195], v[104:107]
    v_mfma_f32_16x16x32_bf16 v[140:143], v[236:239], v[192:195], v[140:143]
    ds_read_b128 v[188:191], v1 offset:18432
    s_waitcnt lgkmcnt(4)
    v_mfma_f32_16x16x32_bf16 v[108:111], v[212:215], v[196:199], v[108:111]
    v_mfma_f32_16x16x32_bf16 v[144:147], v[236:239], v[196:199], v[144:147]
    ds_read_b128 v[192:195], v1 offset:19456
    s_waitcnt lgkmcnt(4)
    v_mfma_f32_16x16x32_bf16 v[112:115], v[212:215], v[200:203], v[112:115]
    v_mfma_f32_16x16x32_bf16 v[148:151], v[236:239], v[200:203], v[148:151]
    ds_read_b128 v[196:199], v1 offset:20480
    s_waitcnt lgkmcnt(4)
    v_mfma_f32_16x16x32_bf16 v[116:119], v[212:215], v[4:7], v[116:119]
    v_mfma_f32_16x16x32_bf16 v[152:155], v[236:239], v[4:7], v[152:155]
    ds_read_b128 v[200:203], v1 offset:21504
    s_waitcnt lgkmcnt(4)
    v_mfma_f32_16x16x32_bf16 v[120:123], v[212:215], v[8:11], v[120:123]
    v_mfma_f32_16x16x32_bf16 v[156:159], v[236:239], v[8:11], v[156:159]
    s_cmp_le_u32 s35, 1
    s_cbranch_scc0 LA_kt_13
    s_waitcnt vmcnt(9)
    ds_read_b128 v[216:219], v14 offset:0
    ds_read_b128 v[220:223], v15 offset:0
    s_waitcnt lgkmcnt(0)
    s_waitcnt vmcnt(7)
    ds_read_b128 v[240:243], v14 offset:2048
    ds_read_b128 v[244:247], v15 offset:2048
    s_waitcnt lgkmcnt(0)
    s_mul_i32 s30, s25, 3072
    v_subrev_u32 v12, s30, v2
    s_and_b32 s30, s25, 1
    s_lshl_b32 s30, s30, 6
    v_xor_b32 v12, s30, v12
    v_xor_b32 v13, 64, v12
    s_add_u32 m0, s37, 0x0
    s_add_u32 s30, s0, 0
    buffer_load_dwordx4 v12, s[16:19], s30 offen nt lds
    s_add_u32 m0, s37, 0x400
    s_add_u32 s30, s0, 3072
    buffer_load_dwordx4 v13, s[16:19], s30 offen nt lds
    s_add_u32 m0, s37, 0x800
    s_add_u32 s30, s0, 6144
    buffer_load_dwordx4 v12, s[16:19], s30 offen nt lds
    s_add_u32 m0, s37, 0xc00
    s_add_u32 s30, s0, 9216
    buffer_load_dwordx4 v13, s[16:19], s30 offen nt lds
LA_kt_13:
    ds_read_b128 v[4:7], v1 offset:22528
    s_waitcnt lgkmcnt(4)
    v_mfma_f32_16x16x32_bf16 v[88:91], v[216:219], v[188:191], v[88:91]
    v_mfma_f32_16x16x32_bf16 v[124:127], v[240:243], v[188:191], v[124:127]
    ds_read_b128 v[8:11], v1 offset:23552
    s_waitcnt lgkmcnt(4)
    v_mfma_f32_16x16x32_bf16 v[92:95], v[216:219], v[192:195], v[92:95]
    v_mfma_f32_16x16x32_bf16 v[128:131], v[240:243], v[192:195], v[128:131]
    ds_read_b128 v[188:191], v1 offset:24576
    s_waitcnt lgkmcnt(4)
    v_mfma_f32_16x16x32_bf16 v[96:99], v[216:219], v[196:199], v[96:99]
    v_mfma_f32_16x16x32_bf16 v[132:135], v[240:243], v[196:199], v[132:135]
    ds_read_b128 v[192:195], v1 offset:25600
    s_waitcnt lgkmcnt(4)
    v_mfma_f32_16x16x32_bf16 v[100:103], v[216:219], v[200:203], v[100:103]
    v_mfma_f32_16x16x32_bf16 v[136:139], v[240:243], v[200:203], v[136:139]
    ds_read_b128 v[196:199], v1 offset:26624
    s_waitcnt lgkmcnt(4)
    v_mfma_f32_16x16x32_bf16 v[104:107], v[216:219], v[4:7], v[104:107]
    v_mfma_f32_16x16x32_bf16 v[140:143], v[240:243], v[4:7], v[140:143]
    ds_read_b128 v[200:203], v1 offset:27648
    s_waitcnt lgkmcnt(4)
    v_mfma_f32_16x16x32_bf16 v[108:111], v[216:219], v[8:11], v[108:111]
    v_mfma_f32_16x16x32_bf16 v[144:147], v[240:243], v[8:11], v[144:147]
    ds_read_b128 v[4:7], v1 offset:28672
    s_waitcnt lgkmcnt(4)
    v_mfma_f32_16x16x32_bf16 v[112:115], v[216:219], v[188:191], v[112:115]
    v_mfma_f32_16x16x32_bf16 v[148:151], v[240:243], v[188:191], v[148:151]
    ds_read_b128 v[8:11], v1 offset:29696
    s_waitcnt lgkmcnt(4)
    v_mfma_f32_16x16x32_bf16 v[116:119], v[216:219], v[192:195], v[116:119]
    v_mfma_f32_16x16x32_bf16 v[152:155], v[240:243], v[192:195], v[152:155]
    ds_read_b128 v[188:191], v1 offset:30720
    s_waitcnt lgkmcnt(4)
    v_mfma_f32_16x16x32_bf16 v[120:123], v[216:219], v[196:199], v[120:123]
    v_mfma_f32_16x16x32_bf16 v[156:159], v[240:243], v[196:199], v[156:159]
    ds_read_b128 v[192:195], v1 offset:31744
    s_waitcnt lgkmcnt(4)
    v_mfma_f32_16x16x32_bf16 v[88:91], v[220:223], v[200:203], v[88:91]
    v_mfma_f32_16x16x32_bf16 v[124:127], v[244:247], v[200:203], v[124:127]
    ds_read_b128 v[196:199], v1 offset:32768
    s_waitcnt lgkmcnt(4)
    v_mfma_f32_16x16x32_bf16 v[92:95], v[220:223], v[4:7], v[92:95]
    v_mfma_f32_16x16x32_bf16 v[128:131], v[244:247], v[4:7], v[128:131]
    ds_read_b128 v[200:203], v1 offset:33792
    s_waitcnt lgkmcnt(4)
    v_mfma_f32_16x16x32_bf16 v[96:99], v[220:223], v[8:11], v[96:99]
    v_mfma_f32_16x16x32_bf16 v[132:135], v[244:247], v[8:11], v[132:135]
    ds_read_b128 v[4:7], v1 offset:34816
    s_waitcnt lgkmcnt(4)
    v_mfma_f32_16x16x32_bf16 v[100:103], v[220:223], v[188:191], v[100:103]
    v_mfma_f32_16x16x32_bf16 v[136:139], v[244:247], v[188:191], v[136:139]
    ds_read_b128 v[8:11], v1 offset:35840
    s_waitcnt lgkmcnt(4)
    v_mfma_f32_16x16x32_bf16 v[104:107], v[220:223], v[192:195], v[104:107]
    v_mfma_f32_16x16x32_bf16 v[140:143], v[244:247], v[192:195], v[140:143]
    ds_read_b128 v[188:191], v1 offset:36864
    s_waitcnt lgkmcnt(4)
    v_mfma_f32_16x16x32_bf16 v[108:111], v[220:223], v[196:199], v[108:111]
    v_mfma_f32_16x16x32_bf16 v[144:147], v[244:247], v[196:199], v[144:147]
    ds_read_b128 v[192:195], v1 offset:37888
    s_waitcnt lgkmcnt(4)
    v_mfma_f32_16x16x32_bf16 v[112:115], v[220:223], v[200:203], v[112:115]
    v_mfma_f32_16x16x32_bf16 v[148:151], v[244:247], v[200:203], v[148:151]
    ds_read_b128 v[196:199], v1 offset:38912
    s_waitcnt lgkmcnt(4)
    v_mfma_f32_16x16x32_bf16 v[116:119], v[220:223], v[4:7], v[116:119]
    v_mfma_f32_16x16x32_bf16 v[152:155], v[244:247], v[4:7], v[152:155]
    ds_read_b128 v[200:203], v1 offset:39936
    s_waitcnt lgkmcnt(4)
    v_mfma_f32_16x16x32_bf16 v[120:123], v[220:223], v[8:11], v[120:123]
    v_mfma_f32_16x16x32_bf16 v[156:159], v[244:247], v[8:11], v[156:159]
    s_cmp_le_u32 s35, 1
    s_cbranch_scc0 LA_kt_14
    s_waitcnt vmcnt(9)
    ds_read_b128 v[224:227], v14 offset:4096
    ds_read_b128 v[228:231], v15 offset:4096
    s_waitcnt lgkmcnt(0)
    s_waitcnt vmcnt(7)
    ds_read_b128 v[248:251], v14 offset:6144
    ds_read_b128 v[252:255], v15 offset:6144
    s_waitcnt lgkmcnt(0)
LA_kt_14:
    ds_read_b128 v[4:7], v1 offset:40960
    s_waitcnt lgkmcnt(4)
    v_mfma_f32_16x16x32_bf16 v[88:91], v[224:227], v[188:191], v[88:91]
    v_mfma_f32_16x16x32_bf16 v[124:127], v[248:251], v[188:191], v[124:127]
    ds_read_b128 v[8:11], v1 offset:41984
    s_waitcnt lgkmcnt(4)
    v_mfma_f32_16x16x32_bf16 v[92:95], v[224:227], v[192:195], v[92:95]
    v_mfma_f32_16x16x32_bf16 v[128:131], v[248:251], v[192:195], v[128:131]
    ds_read_b128 v[188:191], v1 offset:43008
    s_waitcnt lgkmcnt(4)
    v_mfma_f32_16x16x32_bf16 v[96:99], v[224:227], v[196:199], v[96:99]
    v_mfma_f32_16x16x32_bf16 v[132:135], v[248:251], v[196:199], v[132:135]
    ds_read_b128 v[192:195], v1 offset:44032
    s_waitcnt lgkmcnt(4)
    v_mfma_f32_16x16x32_bf16 v[100:103], v[224:227], v[200:203], v[100:103]
    v_mfma_f32_16x16x32_bf16 v[136:139], v[248:251], v[200:203], v[136:139]
    ds_read_b128 v[196:199], v1 offset:45056
    s_waitcnt lgkmcnt(4)
    v_mfma_f32_16x16x32_bf16 v[104:107], v[224:227], v[4:7], v[104:107]
    v_mfma_f32_16x16x32_bf16 v[140:143], v[248:251], v[4:7], v[140:143]
    ds_read_b128 v[200:203], v1 offset:46080
    s_waitcnt lgkmcnt(4)
    v_mfma_f32_16x16x32_bf16 v[108:111], v[224:227], v[8:11], v[108:111]
    v_mfma_f32_16x16x32_bf16 v[144:147], v[248:251], v[8:11], v[144:147]
    ds_read_b128 v[4:7], v1 offset:47104
    s_waitcnt lgkmcnt(4)
    v_mfma_f32_16x16x32_bf16 v[112:115], v[224:227], v[188:191], v[112:115]
    v_mfma_f32_16x16x32_bf16 v[148:151], v[248:251], v[188:191], v[148:151]
    ds_read_b128 v[8:11], v1 offset:48128
    s_waitcnt lgkmcnt(4)
    v_mfma_f32_16x16x32_bf16 v[116:119], v[224:227], v[192:195], v[116:119]
    v_mfma_f32_16x16x32_bf16 v[152:155], v[248:251], v[192:195], v[152:155]
    ds_read_b128 v[188:191], v1 offset:49152
    s_waitcnt lgkmcnt(4)
    v_mfma_f32_16x16x32_bf16 v[120:123], v[224:227], v[196:199], v[120:123]
    v_mfma_f32_16x16x32_bf16 v[156:159], v[248:251], v[196:199], v[156:159]
    ds_read_b128 v[192:195], v1 offset:50176
    s_waitcnt lgkmcnt(4)
    v_mfma_f32_16x16x32_bf16 v[88:91], v[228:231], v[200:203], v[88:91]
    v_mfma_f32_16x16x32_bf16 v[124:127], v[252:255], v[200:203], v[124:127]
    ds_read_b128 v[196:199], v1 offset:51200
    s_waitcnt lgkmcnt(4)
    v_mfma_f32_16x16x32_bf16 v[92:95], v[228:231], v[4:7], v[92:95]
    v_mfma_f32_16x16x32_bf16 v[128:131], v[252:255], v[4:7], v[128:131]
    ds_read_b128 v[200:203], v1 offset:52224
    s_waitcnt lgkmcnt(4)
    v_mfma_f32_16x16x32_bf16 v[96:99], v[228:231], v[8:11], v[96:99]
    v_mfma_f32_16x16x32_bf16 v[132:135], v[252:255], v[8:11], v[132:135]
    ds_read_b128 v[4:7], v1 offset:53248
    s_waitcnt lgkmcnt(4)
    v_mfma_f32_16x16x32_bf16 v[100:103], v[228:231], v[188:191], v[100:103]
    v_mfma_f32_16x16x32_bf16 v[136:139], v[252:255], v[188:191], v[136:139]
    ds_read_b128 v[8:11], v1 offset:54272
    s_waitcnt lgkmcnt(4)
    v_mfma_f32_16x16x32_bf16 v[104:107], v[228:231], v[192:195], v[104:107]
    v_mfma_f32_16x16x32_bf16 v[140:143], v[252:255], v[192:195], v[140:143]
    s_waitcnt lgkmcnt(3)
    v_mfma_f32_16x16x32_bf16 v[108:111], v[228:231], v[196:199], v[108:111]
    v_mfma_f32_16x16x32_bf16 v[144:147], v[252:255], v[196:199], v[144:147]
    s_waitcnt lgkmcnt(2)
    v_mfma_f32_16x16x32_bf16 v[112:115], v[228:231], v[200:203], v[112:115]
    v_mfma_f32_16x16x32_bf16 v[148:151], v[252:255], v[200:203], v[148:151]
    s_waitcnt lgkmcnt(1)
    v_mfma_f32_16x16x32_bf16 v[116:119], v[228:231], v[4:7], v[116:119]
    v_mfma_f32_16x16x32_bf16 v[152:155], v[252:255], v[4:7], v[152:155]
    s_waitcnt lgkmcnt(0)
    v_mfma_f32_16x16x32_bf16 v[120:123], v[228:231], v[8:11], v[120:123]
    v_mfma_f32_16x16x32_bf16 v[156:159], v[252:255], v[8:11], v[156:159]
    s_setprio 0
    v_max3_f32 v168, v48, v49, v50
    v_max3_f32 v180, v51, v84, v85
    v_max3_f32 v168, v168, v86, v87
    v_max_f32 v168, v168, v180
    v_mul_f32 v168, s36, v168
    v_fma_f32 v48, v48, s36, -v168
    v_fma_f32 v49, v49, s36, -v168
    v_fma_f32 v50, v50, s36, -v168
    v_fma_f32 v51, v51, s36, -v168
    v_fma_f32 v84, v84, s36, -v168
    v_fma_f32 v85, v85, s36, -v168
    v_fma_f32 v86, v86, s36, -v168
    v_fma_f32 v87, v87, s36, -v168
    v_exp_f32 v48, v48
    v_exp_f32 v49, v49
    v_exp_f32 v50, v50
    v_exp_f32 v51, v51
    v_exp_f32 v84, v84
    v_exp_f32 v85, v85
    v_exp_f32 v86, v86
    v_exp_f32 v87, v87
    s_add_u32 m0, s37, 0x1000
    s_add_u32 s30, s1, 0
    buffer_load_dwordx4 v12, s[16:19], s30 offen nt lds
    s_add_u32 m0, s37, 0x1400
    s_add_u32 s30, s1, 3072
    buffer_load_dwordx4 v13, s[16:19], s30 offen nt lds
    s_add_u32 m0, s37, 0x1800
    s_add_u32 s30, s1, 6144
    buffer_load_dwordx4 v12, s[16:19], s30 offen nt lds
    s_add_u32 m0, s37, 0x1c00
    s_add_u32 s30, s1, 9216
    buffer_load_dwordx4 v13, s[16:19], s30 offen nt lds
    v_and_b32 v10, 15, v0
    v_mul_u32_u24 v10, 48, v10
    s_lshl_b32 s30, s24, 2
    v_add_u32 v11, s30, v10
    s_nop 4
    v_max3_f32 v240, v88, v89, v90
    v_max3_f32 v241, v92, v93, v94
    v_max3_f32 v242, v96, v97, v98
    v_max3_f32 v243, v100, v101, v102
    v_max3_f32 v244, v104, v105, v106
    v_max3_f32 v245, v108, v109, v110
    v_max3_f32 v246, v112, v113, v114
    v_max3_f32 v247, v116, v117, v118
    v_max3_f32 v248, v120, v121, v122
    v_max3_f32 v240, v240, v91, v124
    v_max3_f32 v241, v241, v95, v128
    v_max3_f32 v242, v242, v99, v132
    v_max3_f32 v243, v243, v103, v136
    v_max3_f32 v244, v244, v107, v140
    v_max3_f32 v245, v245, v111, v144
    v_max3_f32 v246, v246, v115, v148
    v_max3_f32 v247, v247, v119, v152
    v_max3_f32 v248, v248, v123, v156
    v_max3_f32 v240, v240, v125, v126
    v_max3_f32 v241, v241, v129, v130
    v_max3_f32 v242, v242, v133, v134
    v_max3_f32 v243, v243, v137, v138
    v_max3_f32 v244, v244, v141, v142
    v_max3_f32 v245, v245, v145, v146
    v_max3_f32 v246, v246, v149, v150
    v_max3_f32 v247, v247, v153, v154
    v_max3_f32 v248, v248, v157, v158
    v_max_f32 v240, v240, v127
    v_max_f32 v241, v241, v131
    v_max_f32 v242, v242, v135
    v_max_f32 v243, v243, v139
    v_max_f32 v244, v244, v143
    v_max_f32 v245, v245, v147
    v_max_f32 v246, v246, v151
    v_max_f32 v247, v247, v155
    v_max_f32 v248, v248, v159
    v_mul_f32 v240, s36, v240
    v_mul_f32 v241, s36, v241
    v_mul_f32 v242, s36, v242
    v_mul_f32 v243, s36, v243
    v_mul_f32 v244, s36, v244
    v_mul_f32 v245, s36, v245
    v_mul_f32 v246, s36, v246
    v_mul_f32 v247, s36, v247
    v_mul_f32 v248, s36, v248
    v_max_f32 v240, v240, v160
    v_max_f32 v241, v241, v161
    v_max_f32 v242, v242, v162
    v_max_f32 v243, v243, v163
    v_max_f32 v244, v244, v164
    v_max_f32 v245, v245, v165
    v_max_f32 v246, v246, v166
    v_max_f32 v247, v247, v167
    v_max_f32 v248, v248, v168
    v_mov_b32 v180, v240
    v_mov_b32 v181, v241
    v_mov_b32 v182, v242
    v_mov_b32 v183, v243
    v_mov_b32 v184, v244
    v_mov_b32 v185, v245
    v_mov_b32 v186, v246
    v_mov_b32 v187, v247
    v_mov_b32 v188, v248
    s_nop 1
    v_permlane32_swap_b32 v240, v180
    v_permlane32_swap_b32 v241, v181
    v_permlane32_swap_b32 v242, v182
    v_permlane32_swap_b32 v243, v183
    v_permlane32_swap_b32 v244, v184
    v_permlane32_swap_b32 v245, v185
    v_permlane32_swap_b32 v246, v186
    v_permlane32_swap_b32 v247, v187
    v_permlane32_swap_b32 v248, v188
    s_nop 1
    v_max_f32 v240, v240, v180
    v_max_f32 v241, v241, v181
    v_max_f32 v242, v242, v182
    v_max_f32 v243, v243, v183
    v_max_f32 v244, v244, v184
    v_max_f32 v245, v245, v185
    v_max_f32 v246, v246, v186
    v_max_f32 v247, v247, v187
    v_max_f32 v248, v248, v188
    v_mov_b32 v180, v240
    v_mov_b32 v181, v241
    v_mov_b32 v182, v242
    v_mov_b32 v183, v243
    v_mov_b32 v184, v244
    v_mov_b32 v185, v245
    v_mov_b32 v186, v246
    v_mov_b32 v187, v247
    v_mov_b32 v188, v248
    s_nop 1
    v_permlane16_swap_b32 v240, v180
    v_permlane16_swap_b32 v241, v181
    v_permlane16_swap_b32 v242, v182
    v_permlane16_swap_b32 v243, v183
    v_permlane16_swap_b32 v244, v184
    v_permlane16_swap_b32 v245, v185
    v_permlane16_swap_b32 v246, v186
    v_permlane16_swap_b32 v247, v187
    v_permlane16_swap_b32 v248, v188
    s_nop 1
    v_max_f32 v240, v240, v180
    v_max_f32 v241, v241, v181
    v_max_f32 v242, v242, v182
    v_max_f32 v243, v243, v183
    v_max_f32 v244, v244, v184
    v_max_f32 v245, v245, v185
    v_max_f32 v246, v246, v186
    v_max_f32 v247, v247, v187
    v_max_f32 v248, v248, v188
    s_mov_b64 exec, 0xffff
    ds_write_b32 v11, v240 offset:55296
    ds_write_b32 v11, v241 offset:56064
    ds_write_b32 v11, v242 offset:56832
    ds_write_b32 v11, v243 offset:57600
    ds_write_b32 v11, v244 offset:58368
    ds_write_b32 v11, v245 offset:59136
    ds_write_b32 v11, v246 offset:59904
    ds_write_b32 v11, v247 offset:60672
    ds_write_b32 v11, v248 offset:61440
    s_mov_b64 exec, -1
    s_waitcnt lgkmcnt(0)
    s_barrier
    ds_read_b128 v[180:183], v10 offset:55296
    ds_read_b128 v[184:187], v10 offset:55312
    ds_read_b128 v[188:191], v10 offset:56064
    ds_read_b128 v[192:195], v10 offset:56080
    ds_read_b128 v[196:199], v10 offset:56832
    ds_read_b128 v[200:203], v10 offset:56848
    ds_read_b128 v[204:207], v10 offset:57600
    ds_read_b128 v[208:211], v10 offset:57616
    ds_read_b128 v[212:215], v10 offset:58368
    ds_read_b128 v[216:219], v10 offset:58384
    ds_read_b128 v[220:223], v10 offset:59136
    ds_read_b128 v[224:227], v10 offset:59152
    ds_read_b128 v[228:231], v10 offset:59904
    ds_read_b128 v[232:235], v10 offset:59920
    ds_read_b128 v[236:239], v10 offset:60672
    ds_read_b128 v[240:243], v10 offset:60688
    ds_read_b128 v[244:247], v10 offset:61440
    ds_read_b128 v[248:251], v10 offset:61456
    v_lshrrev_b32 v8, 4, v0
    v_bfe_u32 v9, v0, 2, 2
    v_lshl_add_u32 v8, v8, 3, v9
    v_and_b32 v9, 3, v0
    v_lshlrev_b32 v9, 3, v9
    v_lshl_add_u32 v8, v8, 7, v9
    v_bfe_u32 v9, v0, 3, 2
    v_xor_b32 v4, s96, v9
    v_lshl_add_u32 v4, v4, 5, v8
    s_add_u32 s30, s99, 0x12000
    v_add_u32 v4, s30, v4
    v_xor_b32 v5, s97, v9
    v_lshl_add_u32 v5, v5, 5, v8
    s_add_u32 s30, s100, 0x12000
    v_add_u32 v5, s30, v5
    v_xor_b32 v6, s98, v9
    v_lshl_add_u32 v6, v6, 5, v8
    s_add_u32 s30, s101, 0x12000
    v_add_u32 v6, s30, v6
    v_add_u32 v8, 0x9000, v1
    s_mul_i32 s30, s24, 9216
    v_add_u32 v9, s30, v1
    s_waitcnt lgkmcnt(0)
    s_barrier
    v_max3_f32 v180, v180, v181, v182
    v_max3_f32 v183, v183, v184, v185
    v_max3_f32 v180, v180, v186, v187
    v_max3_f32 v188, v188, v189, v190
    v_max3_f32 v191, v191, v192, v193
    v_max3_f32 v188, v188, v194, v195
    v_max3_f32 v196, v196, v197, v198
    v_max3_f32 v199, v199, v200, v201
    v_max3_f32 v196, v196, v202, v203
    v_max3_f32 v204, v204, v205, v206
    v_max3_f32 v207, v207, v208, v209
    v_max3_f32 v204, v204, v210, v211
    v_max3_f32 v212, v212, v213, v214
    v_max3_f32 v215, v215, v216, v217
    v_max3_f32 v212, v212, v218, v219
    v_max3_f32 v220, v220, v221, v222
    v_max3_f32 v223, v223, v224, v225
    v_max3_f32 v220, v220, v226, v227
    v_max3_f32 v228, v228, v229, v230
    v_max3_f32 v231, v231, v232, v233
    v_max3_f32 v228, v228, v234, v235
    v_max3_f32 v236, v236, v237, v238
    v_max3_f32 v239, v239, v240, v241
    v_max3_f32 v236, v236, v242, v243
    v_max3_f32 v244, v244, v245, v246
    v_max3_f32 v247, v247, v248, v249
    v_max3_f32 v244, v244, v250, v251
    v_max_f32 v180, v180, v183
    v_max_f32 v188, v188, v191
    v_max_f32 v196, v196, v199
    v_max_f32 v204, v204, v207
    v_max_f32 v212, v212, v215
    v_max_f32 v220, v220, v223
    v_max_f32 v228, v228, v231
    v_max_f32 v236, v236, v239
    v_max_f32 v244, v244, v247
    v_sub_f32 v182, v160, v180
    v_sub_f32 v190, v161, v188
    v_sub_f32 v198, v162, v196
    v_sub_f32 v206, v163, v204
    v_sub_f32 v214, v164, v212
    v_sub_f32 v222, v165, v220
    v_sub_f32 v230, v166, v228
    v_sub_f32 v238, v167, v236
    v_sub_f32 v246, v168, v244
    v_exp_f32 v182, v182
    v_mov_b32 v160, v180
    v_exp_f32 v190, v190
    v_mov_b32 v161, v188
    v_exp_f32 v198, v198
    v_mov_b32 v162, v196
    v_exp_f32 v206, v206
    v_mov_b32 v163, v204
    v_exp_f32 v214, v214
    v_mov_b32 v164, v212
    v_exp_f32 v222, v222
    v_mov_b32 v165, v220
    v_exp_f32 v230, v230
    v_mov_b32 v166, v228
    v_exp_f32 v238, v238
    v_mov_b32 v167, v236
    v_exp_f32 v246, v246
    v_mov_b32 v168, v244
    v_mov_b32 v252, 0x3f803f80
    v_mov_b32 v253, 0x3f803f80
    v_mov_b32 v254, 0x3f803f80
    v_mov_b32 v255, 0x3f803f80
    v_pk_mul_f32 v[16:17], v[16:17], v[182:183] op_sel_hi:[1,0]
    v_pk_mul_f32 v[18:19], v[18:19], v[182:183] op_sel_hi:[1,0]
    v_pk_mul_f32 v[52:53], v[52:53], v[182:183] op_sel_hi:[1,0]
    v_pk_mul_f32 v[54:55], v[54:55], v[182:183] op_sel_hi:[1,0]
    v_cvt_pk_bf16_f32 v16, v16, v17
    v_cvt_pk_bf16_f32 v17, v18, v19
    v_cvt_pk_bf16_f32 v18, v52, v53
    v_cvt_pk_bf16_f32 v19, v54, v55
    ds_write_b128 v9, v[16:19] offset:0
    v_pk_mul_f32 v[20:21], v[20:21], v[190:191] op_sel_hi:[1,0]
    v_pk_mul_f32 v[22:23], v[22:23], v[190:191] op_sel_hi:[1,0]
    v_pk_mul_f32 v[56:57], v[56:57], v[190:191] op_sel_hi:[1,0]
    v_pk_mul_f32 v[58:59], v[58:59], v[190:191] op_sel_hi:[1,0]
    v_cvt_pk_bf16_f32 v20, v20, v21
    v_cvt_pk_bf16_f32 v21, v22, v23
    v_cvt_pk_bf16_f32 v22, v56, v57
    v_cvt_pk_bf16_f32 v23, v58, v59
    ds_write_b128 v9, v[20:23] offset:1024
    v_mfma_f32_16x16x32_bf16 v[52:55], v[252:255], v[16:19], 0
    v_pk_mul_f32 v[24:25], v[24:25], v[198:199] op_sel_hi:[1,0]
    v_pk_mul_f32 v[26:27], v[26:27], v[198:199] op_sel_hi:[1,0]
    v_pk_mul_f32 v[60:61], v[60:61], v[198:199] op_sel_hi:[1,0]
    v_pk_mul_f32 v[62:63], v[62:63], v[198:199] op_sel_hi:[1,0]
    v_cvt_pk_bf16_f32 v24, v24, v25
    v_cvt_pk_bf16_f32 v25, v26, v27
    v_cvt_pk_bf16_f32 v26, v60, v61
    v_cvt_pk_bf16_f32 v27, v62, v63
    ds_write_b128 v9, v[24:27] offset:2048
    v_mfma_f32_16x16x32_bf16 v[56:59], v[252:255], v[20:23], 0
    v_mov_b32 v169, v52
    v_pk_mul_f32 v[28:29], v[28:29], v[206:207] op_sel_hi:[1,0]
    v_pk_mul_f32 v[30:31], v[30:31], v[206:207] op_sel_hi:[1,0]
    v_pk_mul_f32 v[64:65], v[64:65], v[206:207] op_sel_hi:[1,0]
    v_pk_mul_f32 v[66:67], v[66:67], v[206:207] op_sel_hi:[1,0]
    v_cvt_pk_bf16_f32 v28, v28, v29
    v_cvt_pk_bf16_f32 v29, v30, v31
    v_cvt_pk_bf16_f32 v30, v64, v65
    v_cvt_pk_bf16_f32 v31, v66, v67
    ds_write_b128 v9, v[28:31] offset:3072
    v_mfma_f32_16x16x32_bf16 v[60:63], v[252:255], v[24:27], 0
    v_mov_b32 v170, v56
    v_pk_mul_f32 v[32:33], v[32:33], v[214:215] op_sel_hi:[1,0]
    v_pk_mul_f32 v[34:35], v[34:35], v[214:215] op_sel_hi:[1,0]
    v_pk_mul_f32 v[68:69], v[68:69], v[214:215] op_sel_hi:[1,0]
    v_pk_mul_f32 v[70:71], v[70:71], v[214:215] op_sel_hi:[1,0]
    v_cvt_pk_bf16_f32 v32, v32, v33
    v_cvt_pk_bf16_f32 v33, v34, v35
    v_cvt_pk_bf16_f32 v34, v68, v69
    v_cvt_pk_bf16_f32 v35, v70, v71
    ds_write_b128 v9, v[32:35] offset:4096
    v_mfma_f32_16x16x32_bf16 v[64:67], v[252:255], v[28:31], 0
    v_mov_b32 v171, v60
    v_pk_mul_f32 v[36:37], v[36:37], v[222:223] op_sel_hi:[1,0]
    v_pk_mul_f32 v[38:39], v[38:39], v[222:223] op_sel_hi:[1,0]
    v_pk_mul_f32 v[72:73], v[72:73], v[222:223] op_sel_hi:[1,0]
    v_pk_mul_f32 v[74:75], v[74:75], v[222:223] op_sel_hi:[1,0]
    v_cvt_pk_bf16_f32 v36, v36, v37
    v_cvt_pk_bf16_f32 v37, v38, v39
    v_cvt_pk_bf16_f32 v38, v72, v73
    v_cvt_pk_bf16_f32 v39, v74, v75
    ds_write_b128 v9, v[36:39] offset:5120
    v_mfma_f32_16x16x32_bf16 v[68:71], v[252:255], v[32:35], 0
    v_mov_b32 v172, v64
    v_pk_mul_f32 v[40:41], v[40:41], v[230:231] op_sel_hi:[1,0]
    v_pk_mul_f32 v[42:43], v[42:43], v[230:231] op_sel_hi:[1,0]
    v_pk_mul_f32 v[76:77], v[76:77], v[230:231] op_sel_hi:[1,0]
    v_pk_mul_f32 v[78:79], v[78:79], v[230:231] op_sel_hi:[1,0]
    v_cvt_pk_bf16_f32 v40, v40, v41
    v_cvt_pk_bf16_f32 v41, v42, v43
    v_cvt_pk_bf16_f32 v42, v76, v77
    v_cvt_pk_bf16_f32 v43, v78, v79
    ds_write_b128 v9, v[40:43] offset:6144
    v_mfma_f32_16x16x32_bf16 v[72:75], v[252:255], v[36:39], 0
    v_mov_b32 v173, v68
    v_pk_mul_f32 v[44:45], v[44:45], v[238:239] op_sel_hi:[1,0]
    v_pk_mul_f32 v[46:47], v[46:47], v[238:239] op_sel_hi:[1,0]
    v_pk_mul_f32 v[80:81], v[80:81], v[238:239] op_sel_hi:[1,0]
    v_pk_mul_f32 v[82:83], v[82:83], v[238:239] op_sel_hi:[1,0]
    v_cvt_pk_bf16_f32 v44, v44, v45
    v_cvt_pk_bf16_f32 v45, v46, v47
    v_cvt_pk_bf16_f32 v46, v80, v81
    v_cvt_pk_bf16_f32 v47, v82, v83
    ds_write_b128 v9, v[44:47] offset:7168
    v_mfma_f32_16x16x32_bf16 v[76:79], v[252:255], v[40:43], 0
    v_mov_b32 v174, v72
    v_pk_mul_f32 v[48:49], v[48:49], v[246:247] op_sel_hi:[1,0]
    v_pk_mul_f32 v[50:51], v[50:51], v[246:247] op_sel_hi:[1,0]
    v_pk_mul_f32 v[84:85], v[84:85], v[246:247] op_sel_hi:[1,0]
    v_pk_mul_f32 v[86:87], v[86:87], v[246:247] op_sel_hi:[1,0]
    v_cvt_pk_bf16_f32 v48, v48, v49
    v_cvt_pk_bf16_f32 v49, v50, v51
    v_cvt_pk_bf16_f32 v50, v84, v85
    v_cvt_pk_bf16_f32 v51, v86, v87
    ds_write_b128 v9, v[48:51] offset:8192
    v_mfma_f32_16x16x32_bf16 v[80:83], v[252:255], v[44:47], 0
    v_mov_b32 v175, v76
    s_nop 0
    v_mfma_f32_16x16x32_bf16 v[84:87], v[252:255], v[48:51], 0
    s_nop 7
    v_mov_b32 v176, v80
    v_mov_b32 v177, v84
    v_add_u32 v84, 0xc000, v4
    v_add_u32 v85, 0xc000, v5
    v_add_u32 v86, 0xc000, v6
    s_cmp_eq_u32 s26, 0
    s_cbranch_scc0 LA_p3_g1
    s_waitcnt vmcnt(8) lgkmcnt(0)
    s_barrier
    ds_read_b64_tr_b16 v[240:241], v4 offset:0
    ds_read_b64_tr_b16 v[242:243], v4 offset:512
    ds_read_b64_tr_b16 v[244:245], v5 offset:0
    ds_read_b64_tr_b16 v[246:247], v5 offset:512
    ds_read_b64_tr_b16 v[248:249], v6 offset:0
    ds_read_b64_tr_b16 v[250:251], v6 offset:512
    ds_read_b128 v[16:19], v8 offset:0
    ds_read_b128 v[20:23], v8 offset:1024
    ds_read_b128 v[24:27], v8 offset:2048
    ds_read_b128 v[28:31], v8 offset:3072
    ds_read_b128 v[32:35], v8 offset:4096
    s_waitcnt lgkmcnt(0)
    s_barrier
    v_mfma_f32_16x16x32_bf16 v[180:183], v[240:243], v[16:19], 0
    ds_read_b64_tr_b16 v[72:73], v4 offset:12288
    ds_read_b64_tr_b16 v[74:75], v4 offset:12800
    v_fma_f32 v88, v88, s36, -v160
    v_fma_f32 v89, v89, s36, -v160
    v_mfma_f32_16x16x32_bf16 v[184:187], v[244:247], v[16:19], 0
    ds_read_b64_tr_b16 v[76:77], v5 offset:12288
    v_fma_f32 v90, v90, s36, -v160
    v_fma_f32 v91, v91, s36, -v160
    v_mfma_f32_16x16x32_bf16 v[188:191], v[248:251], v[16:19], 0
    ds_read_b64_tr_b16 v[78:79], v5 offset:12800
    v_fma_f32 v124, v124, s36, -v160
    v_fma_f32 v125, v125, s36, -v160
    v_mfma_f32_16x16x32_bf16 v[192:195], v[240:243], v[20:23], 0
    ds_read_b64_tr_b16 v[80:81], v6 offset:12288
    v_fma_f32 v126, v126, s36, -v160
    v_fma_f32 v127, v127, s36, -v160
    v_mfma_f32_16x16x32_bf16 v[196:199], v[244:247], v[20:23], 0
    ds_read_b64_tr_b16 v[82:83], v6 offset:12800
    v_exp_f32 v88, v88
    v_exp_f32 v89, v89
    v_mfma_f32_16x16x32_bf16 v[200:203], v[248:251], v[20:23], 0
    ds_read_b128 v[52:55], v8 offset:9216
    v_exp_f32 v90, v90
    v_exp_f32 v91, v91
    v_mfma_f32_16x16x32_bf16 v[204:207], v[240:243], v[24:27], 0
    ds_read_b128 v[56:59], v8 offset:10240
    v_exp_f32 v124, v124
    v_exp_f32 v125, v125
    v_mfma_f32_16x16x32_bf16 v[208:211], v[244:247], v[24:27], 0
    ds_read_b128 v[60:63], v8 offset:11264
    v_exp_f32 v126, v126
    v_mfma_f32_16x16x32_bf16 v[212:215], v[248:251], v[24:27], 0
    ds_read_b128 v[64:67], v8 offset:12288
    v_exp_f32 v127, v127
    v_mfma_f32_16x16x32_bf16 v[216:219], v[240:243], v[28:31], 0
    ds_read_b128 v[68:71], v8 offset:13312
    v_cvt_pk_bf16_f32 v88, v88, v89
    v_mfma_f32_16x16x32_bf16 v[220:223], v[244:247], v[28:31], 0
    v_cvt_pk_bf16_f32 v89, v90, v91
    v_mfma_f32_16x16x32_bf16 v[224:227], v[248:251], v[28:31], 0
    v_cvt_pk_bf16_f32 v90, v124, v125
    v_mfma_f32_16x16x32_bf16 v[228:231], v[240:243], v[32:35], 0
    v_cvt_pk_bf16_f32 v91, v126, v127
    v_mfma_f32_16x16x32_bf16 v[232:235], v[244:247], v[32:35], 0
    v_fma_f32 v92, v92, s36, -v161
    v_mfma_f32_16x16x32_bf16 v[236:239], v[248:251], v[32:35], 0
    v_fma_f32 v93, v93, s36, -v161
    s_cmp_le_u32 s2, 2
    s_cbranch_scc0 LA_wb_16
    s_waitcnt vmcnt(4)
    s_cmp_le_u32 s3, 2
    s_cbranch_scc0 LA_wb_16
    s_waitcnt vmcnt(0)
LA_wb_16:
    s_waitcnt lgkmcnt(0)
    s_barrier
    v_mfma_f32_16x16x32_bf16 v[180:183], v[72:75], v[52:55], v[180:183]
    ds_read_b64_tr_b16 v[240:241], v4 offset:24576
    ds_read_b64_tr_b16 v[242:243], v4 offset:25088
    v_fma_f32 v94, v94, s36, -v161
    v_fma_f32 v95, v95, s36, -v161
    v_mfma_f32_16x16x32_bf16 v[184:187], v[76:79], v[52:55], v[184:187]
    ds_read_b64_tr_b16 v[244:245], v5 offset:24576
    v_mfma_f32_16x16x32_bf16 v[124:127], v[252:255], v[88:91], 0
    v_fma_f32 v128, v128, s36, -v161
    v_mfma_f32_16x16x32_bf16 v[188:191], v[80:83], v[52:55], v[188:191]
    ds_read_b64_tr_b16 v[246:247], v5 offset:25088
    v_fma_f32 v129, v129, s36, -v161
    v_fma_f32 v130, v130, s36, -v161
    v_mfma_f32_16x16x32_bf16 v[192:195], v[72:75], v[56:59], v[192:195]
    ds_read_b64_tr_b16 v[248:249], v6 offset:24576
    v_fma_f32 v131, v131, s36, -v161
    v_exp_f32 v92, v92
    v_mfma_f32_16x16x32_bf16 v[196:199], v[76:79], v[56:59], v[196:199]
    ds_read_b64_tr_b16 v[250:251], v6 offset:25088
    v_exp_f32 v93, v93
    v_exp_f32 v94, v94
    v_mfma_f32_16x16x32_bf16 v[200:203], v[80:83], v[56:59], v[200:203]
    ds_read_b128 v[16:19], v8 offset:18432
    v_exp_f32 v95, v95
    v_exp_f32 v128, v128
    v_mfma_f32_16x16x32_bf16 v[204:207], v[72:75], v[60:63], v[204:207]
    ds_read_b128 v[20:23], v8 offset:19456
    v_exp_f32 v129, v129
    v_exp_f32 v130, v130
    v_mfma_f32_16x16x32_bf16 v[208:211], v[76:79], v[60:63], v[208:211]
    ds_read_b128 v[24:27], v8 offset:20480
    v_exp_f32 v131, v131
    v_mfma_f32_16x16x32_bf16 v[212:215], v[80:83], v[60:63], v[212:215]
    ds_read_b128 v[28:31], v8 offset:21504
    v_cvt_pk_bf16_f32 v92, v92, v93
    v_mfma_f32_16x16x32_bf16 v[216:219], v[72:75], v[64:67], v[216:219]
    ds_read_b128 v[32:35], v8 offset:22528
    v_cvt_pk_bf16_f32 v93, v94, v95
    v_mfma_f32_16x16x32_bf16 v[220:223], v[76:79], v[64:67], v[220:223]
    v_cvt_pk_bf16_f32 v94, v128, v129
    v_mfma_f32_16x16x32_bf16 v[224:227], v[80:83], v[64:67], v[224:227]
    v_cvt_pk_bf16_f32 v95, v130, v131
    v_mfma_f32_16x16x32_bf16 v[228:231], v[72:75], v[68:71], v[228:231]
    v_fma_f32 v96, v96, s36, -v162
    v_mfma_f32_16x16x32_bf16 v[232:235], v[76:79], v[68:71], v[232:235]
    v_fma_f32 v97, v97, s36, -v162
    v_mfma_f32_16x16x32_bf16 v[236:239], v[80:83], v[68:71], v[236:239]
    v_add_f32 v169, v169, v124
    s_cmp_le_u32 s2, 3
    s_cbranch_scc0 LA_wb_18
    s_waitcnt vmcnt(4)
    s_cmp_le_u32 s3, 3
    s_cbranch_scc0 LA_wb_18
    s_waitcnt vmcnt(0)
LA_wb_18:
    s_waitcnt lgkmcnt(0)
    s_barrier
    v_mfma_f32_16x16x32_bf16 v[180:183], v[240:243], v[16:19], v[180:183]
    ds_read_b64_tr_b16 v[72:73], v4 offset:36864
    ds_read_b64_tr_b16 v[74:75], v4 offset:37376
    v_fma_f32 v98, v98, s36, -v162
    v_fma_f32 v99, v99, s36, -v162
    v_mfma_f32_16x16x32_bf16 v[184:187], v[244:247], v[16:19], v[184:187]
    ds_read_b64_tr_b16 v[76:77], v5 offset:36864
    v_mfma_f32_16x16x32_bf16 v[128:131], v[252:255], v[92:95], 0
    v_fma_f32 v132, v132, s36, -v162
    v_mfma_f32_16x16x32_bf16 v[188:191], v[248:251], v[16:19], v[188:191]
    ds_read_b64_tr_b16 v[78:79], v5 offset:37376
    v_fma_f32 v133, v133, s36, -v162
    v_fma_f32 v134, v134, s36, -v162
    v_mfma_f32_16x16x32_bf16 v[192:195], v[240:243], v[20:23], v[192:195]
    ds_read_b64_tr_b16 v[80:81], v6 offset:36864
    v_fma_f32 v135, v135, s36, -v162
    v_exp_f32 v96, v96
    v_mfma_f32_16x16x32_bf16 v[196:199], v[244:247], v[20:23], v[196:199]
    ds_read_b64_tr_b16 v[82:83], v6 offset:37376
    v_exp_f32 v97, v97
    v_exp_f32 v98, v98
    v_mfma_f32_16x16x32_bf16 v[200:203], v[248:251], v[20:23], v[200:203]
    ds_read_b128 v[52:55], v8 offset:27648
    v_exp_f32 v99, v99
    v_exp_f32 v132, v132
    v_mfma_f32_16x16x32_bf16 v[204:207], v[240:243], v[24:27], v[204:207]
    ds_read_b128 v[56:59], v8 offset:28672
    v_exp_f32 v133, v133
    v_exp_f32 v134, v134
    v_mfma_f32_16x16x32_bf16 v[208:211], v[244:247], v[24:27], v[208:211]
    ds_read_b128 v[60:63], v8 offset:29696
    v_exp_f32 v135, v135
    v_mfma_f32_16x16x32_bf16 v[212:215], v[248:251], v[24:27], v[212:215]
    ds_read_b128 v[64:67], v8 offset:30720
    v_cvt_pk_bf16_f32 v96, v96, v97
    v_mfma_f32_16x16x32_bf16 v[216:219], v[240:243], v[28:31], v[216:219]
    ds_read_b128 v[68:71], v8 offset:31744
    v_cvt_pk_bf16_f32 v97, v98, v99
    v_mfma_f32_16x16x32_bf16 v[220:223], v[244:247], v[28:31], v[220:223]
    v_cvt_pk_bf16_f32 v98, v132, v133
    v_mfma_f32_16x16x32_bf16 v[224:227], v[248:251], v[28:31], v[224:227]
    v_cvt_pk_bf16_f32 v99, v134, v135
    v_mfma_f32_16x16x32_bf16 v[228:231], v[240:243], v[32:35], v[228:231]
    v_fma_f32 v100, v100, s36, -v163
    v_mfma_f32_16x16x32_bf16 v[232:235], v[244:247], v[32:35], v[232:235]
    v_fma_f32 v101, v101, s36, -v163
    v_mfma_f32_16x16x32_bf16 v[236:239], v[248:251], v[32:35], v[236:239]
    v_add_f32 v170, v170, v128
    s_cmp_le_u32 s2, 4
    s_cbranch_scc0 LA_wb_20
    s_waitcnt vmcnt(4)
    s_cmp_le_u32 s3, 4
    s_cbranch_scc0 LA_wb_20
    s_waitcnt vmcnt(0)
LA_wb_20:
    s_waitcnt lgkmcnt(0)
    s_barrier
    v_mfma_f32_16x16x32_bf16 v[180:183], v[72:75], v[52:55], v[180:183]
    ds_read_b64_tr_b16 v[240:241], v84 offset:0
    ds_read_b64_tr_b16 v[242:243], v84 offset:512
    v_fma_f32 v102, v102, s36, -v163
    v_fma_f32 v103, v103, s36, -v163
    v_mfma_f32_16x16x32_bf16 v[184:187], v[76:79], v[52:55], v[184:187]
    ds_read_b64_tr_b16 v[244:245], v85 offset:0
    v_mfma_f32_16x16x32_bf16 v[132:135], v[252:255], v[96:99], 0
    v_fma_f32 v136, v136, s36, -v163
    v_mfma_f32_16x16x32_bf16 v[188:191], v[80:83], v[52:55], v[188:191]
    ds_read_b64_tr_b16 v[246:247], v85 offset:512
    v_fma_f32 v137, v137, s36, -v163
    v_fma_f32 v138, v138, s36, -v163
    v_mfma_f32_16x16x32_bf16 v[192:195], v[72:75], v[56:59], v[192:195]
    ds_read_b64_tr_b16 v[248:249], v86 offset:0
    v_fma_f32 v139, v139, s36, -v163
    v_exp_f32 v100, v100
    v_mfma_f32_16x16x32_bf16 v[196:199], v[76:79], v[56:59], v[196:199]
    ds_read_b64_tr_b16 v[250:251], v86 offset:512
    v_exp_f32 v101, v101
    v_exp_f32 v102, v102
    v_mfma_f32_16x16x32_bf16 v[200:203], v[80:83], v[56:59], v[200:203]
    ds_read_b128 v[16:19], v1 offset:0
    v_exp_f32 v103, v103
    v_exp_f32 v136, v136
    v_mfma_f32_16x16x32_bf16 v[204:207], v[72:75], v[60:63], v[204:207]
    ds_read_b128 v[20:23], v1 offset:1024
    v_exp_f32 v137, v137
    v_exp_f32 v138, v138
    v_mfma_f32_16x16x32_bf16 v[208:211], v[76:79], v[60:63], v[208:211]
    ds_read_b128 v[24:27], v1 offset:2048
    v_exp_f32 v139, v139
    v_mfma_f32_16x16x32_bf16 v[212:215], v[80:83], v[60:63], v[212:215]
    ds_read_b128 v[28:31], v1 offset:3072
    v_cvt_pk_bf16_f32 v100, v100, v101
    v_mfma_f32_16x16x32_bf16 v[216:219], v[72:75], v[64:67], v[216:219]
    ds_read_b128 v[32:35], v1 offset:4096
    v_cvt_pk_bf16_f32 v101, v102, v103
    v_mfma_f32_16x16x32_bf16 v[220:223], v[76:79], v[64:67], v[220:223]
    v_cvt_pk_bf16_f32 v102, v136, v137
    v_mfma_f32_16x16x32_bf16 v[224:227], v[80:83], v[64:67], v[224:227]
    v_cvt_pk_bf16_f32 v103, v138, v139
    v_mfma_f32_16x16x32_bf16 v[228:231], v[72:75], v[68:71], v[228:231]
    v_fma_f32 v104, v104, s36, -v164
    v_mfma_f32_16x16x32_bf16 v[232:235], v[76:79], v[68:71], v[232:235]
    v_fma_f32 v105, v105, s36, -v164
    v_mfma_f32_16x16x32_bf16 v[236:239], v[80:83], v[68:71], v[236:239]
    v_add_f32 v171, v171, v132
    s_cmp_le_u32 s2, 5
    s_cbranch_scc0 LA_wb_22
    s_waitcnt vmcnt(4)
    s_cmp_le_u32 s3, 5
    s_cbranch_scc0 LA_wb_22
    s_waitcnt vmcnt(0)
LA_wb_22:
    s_waitcnt lgkmcnt(0)
    s_barrier
    v_mfma_f32_16x16x32_bf16 v[180:183], v[240:243], v[16:19], v[180:183]
    ds_read_b64_tr_b16 v[72:73], v84 offset:12288
    ds_read_b64_tr_b16 v[74:75], v84 offset:12800
    v_fma_f32 v106, v106, s36, -v164
    v_fma_f32 v107, v107, s36, -v164
    v_mfma_f32_16x16x32_bf16 v[184:187], v[244:247], v[16:19], v[184:187]
    ds_read_b64_tr_b16 v[76:77], v85 offset:12288
    v_mfma_f32_16x16x32_bf16 v[136:139], v[252:255], v[100:103], 0
    v_fma_f32 v140, v140, s36, -v164
    v_mfma_f32_16x16x32_bf16 v[188:191], v[248:251], v[16:19], v[188:191]
    ds_read_b64_tr_b16 v[78:79], v85 offset:12800
    v_fma_f32 v141, v141, s36, -v164
    v_fma_f32 v142, v142, s36, -v164
    v_mfma_f32_16x16x32_bf16 v[192:195], v[240:243], v[20:23], v[192:195]
    ds_read_b64_tr_b16 v[80:81], v86 offset:12288
    v_fma_f32 v143, v143, s36, -v164
    v_exp_f32 v104, v104
    v_mfma_f32_16x16x32_bf16 v[196:199], v[244:247], v[20:23], v[196:199]
    ds_read_b64_tr_b16 v[82:83], v86 offset:12800
    v_exp_f32 v105, v105
    v_exp_f32 v106, v106
    v_mfma_f32_16x16x32_bf16 v[200:203], v[248:251], v[20:23], v[200:203]
    ds_read_b128 v[52:55], v1 offset:9216
    v_exp_f32 v107, v107
    v_exp_f32 v140, v140
    v_mfma_f32_16x16x32_bf16 v[204:207], v[240:243], v[24:27], v[204:207]
    ds_read_b128 v[56:59], v1 offset:10240
    v_exp_f32 v141, v141
    v_exp_f32 v142, v142
    v_mfma_f32_16x16x32_bf16 v[208:211], v[244:247], v[24:27], v[208:211]
    ds_read_b128 v[60:63], v1 offset:11264
    v_exp_f32 v143, v143
    v_mfma_f32_16x16x32_bf16 v[212:215], v[248:251], v[24:27], v[212:215]
    ds_read_b128 v[64:67], v1 offset:12288
    v_cvt_pk_bf16_f32 v104, v104, v105
    v_mfma_f32_16x16x32_bf16 v[216:219], v[240:243], v[28:31], v[216:219]
    ds_read_b128 v[68:71], v1 offset:13312
    v_cvt_pk_bf16_f32 v105, v106, v107
    v_mfma_f32_16x16x32_bf16 v[220:223], v[244:247], v[28:31], v[220:223]
    v_cvt_pk_bf16_f32 v106, v140, v141
    v_mfma_f32_16x16x32_bf16 v[224:227], v[248:251], v[28:31], v[224:227]
    v_cvt_pk_bf16_f32 v107, v142, v143
    v_mfma_f32_16x16x32_bf16 v[228:231], v[240:243], v[32:35], v[228:231]
    v_fma_f32 v108, v108, s36, -v165
    v_mfma_f32_16x16x32_bf16 v[232:235], v[244:247], v[32:35], v[232:235]
    v_fma_f32 v109, v109, s36, -v165
    v_mfma_f32_16x16x32_bf16 v[236:239], v[248:251], v[32:35], v[236:239]
    v_add_f32 v172, v172, v136
    s_cmp_le_u32 s2, 6
    s_cbranch_scc0 LA_wb_24
    s_waitcnt vmcnt(4)
    s_cmp_le_u32 s3, 6
    s_cbranch_scc0 LA_wb_24
    s_waitcnt vmcnt(0)
LA_wb_24:
    s_waitcnt lgkmcnt(0)
    s_barrier
    v_mfma_f32_16x16x32_bf16 v[180:183], v[72:75], v[52:55], v[180:183]
    ds_read_b64_tr_b16 v[240:241], v84 offset:24576
    ds_read_b64_tr_b16 v[242:243], v84 offset:25088
    v_fma_f32 v110, v110, s36, -v165
    v_fma_f32 v111, v111, s36, -v165
    v_mfma_f32_16x16x32_bf16 v[184:187], v[76:79], v[52:55], v[184:187]
    ds_read_b64_tr_b16 v[244:245], v85 offset:24576
    v_mfma_f32_16x16x32_bf16 v[140:143], v[252:255], v[104:107], 0
    v_fma_f32 v144, v144, s36, -v165
    v_mfma_f32_16x16x32_bf16 v[188:191], v[80:83], v[52:55], v[188:191]
    ds_read_b64_tr_b16 v[246:247], v85 offset:25088
    v_fma_f32 v145, v145, s36, -v165
    v_fma_f32 v146, v146, s36, -v165
    v_mfma_f32_16x16x32_bf16 v[192:195], v[72:75], v[56:59], v[192:195]
    ds_read_b64_tr_b16 v[248:249], v86 offset:24576
    v_fma_f32 v147, v147, s36, -v165
    v_exp_f32 v108, v108
    v_mfma_f32_16x16x32_bf16 v[196:199], v[76:79], v[56:59], v[196:199]
    ds_read_b64_tr_b16 v[250:251], v86 offset:25088
    v_exp_f32 v109, v109
    v_exp_f32 v110, v110
    v_mfma_f32_16x16x32_bf16 v[200:203], v[80:83], v[56:59], v[200:203]
    ds_read_b128 v[16:19], v1 offset:18432
    v_exp_f32 v111, v111
    v_exp_f32 v144, v144
    v_mfma_f32_16x16x32_bf16 v[204:207], v[72:75], v[60:63], v[204:207]
    ds_read_b128 v[20:23], v1 offset:19456
    v_exp_f32 v145, v145
    v_exp_f32 v146, v146
    v_mfma_f32_16x16x32_bf16 v[208:211], v[76:79], v[60:63], v[208:211]
    ds_read_b128 v[24:27], v1 offset:20480
    v_exp_f32 v147, v147
    v_mfma_f32_16x16x32_bf16 v[212:215], v[80:83], v[60:63], v[212:215]
    ds_read_b128 v[28:31], v1 offset:21504
    v_cvt_pk_bf16_f32 v108, v108, v109
    v_mfma_f32_16x16x32_bf16 v[216:219], v[72:75], v[64:67], v[216:219]
    ds_read_b128 v[32:35], v1 offset:22528
    v_cvt_pk_bf16_f32 v109, v110, v111
    v_mfma_f32_16x16x32_bf16 v[220:223], v[76:79], v[64:67], v[220:223]
    v_cvt_pk_bf16_f32 v110, v144, v145
    v_mfma_f32_16x16x32_bf16 v[224:227], v[80:83], v[64:67], v[224:227]
    v_cvt_pk_bf16_f32 v111, v146, v147
    v_mfma_f32_16x16x32_bf16 v[228:231], v[72:75], v[68:71], v[228:231]
    v_fma_f32 v112, v112, s36, -v166
    v_mfma_f32_16x16x32_bf16 v[232:235], v[76:79], v[68:71], v[232:235]
    v_fma_f32 v113, v113, s36, -v166
    v_mfma_f32_16x16x32_bf16 v[236:239], v[80:83], v[68:71], v[236:239]
    v_add_f32 v173, v173, v140
    s_waitcnt lgkmcnt(0)
    s_barrier
    v_mfma_f32_16x16x32_bf16 v[180:183], v[240:243], v[16:19], v[180:183]
    ds_read_b64_tr_b16 v[72:73], v4 offset:0
    ds_read_b64_tr_b16 v[74:75], v4 offset:512
    v_fma_f32 v114, v114, s36, -v166
    v_fma_f32 v115, v115, s36, -v166
    v_mfma_f32_16x16x32_bf16 v[184:187], v[244:247], v[16:19], v[184:187]
    ds_read_b64_tr_b16 v[76:77], v5 offset:0
    v_mfma_f32_16x16x32_bf16 v[144:147], v[252:255], v[108:111], 0
    v_fma_f32 v148, v148, s36, -v166
    v_mfma_f32_16x16x32_bf16 v[188:191], v[248:251], v[16:19], v[188:191]
    ds_read_b64_tr_b16 v[78:79], v5 offset:512
    v_fma_f32 v149, v149, s36, -v166
    v_fma_f32 v150, v150, s36, -v166
    v_mfma_f32_16x16x32_bf16 v[192:195], v[240:243], v[20:23], v[192:195]
    ds_read_b64_tr_b16 v[80:81], v6 offset:0
    v_fma_f32 v151, v151, s36, -v166
    v_exp_f32 v112, v112
    v_mfma_f32_16x16x32_bf16 v[196:199], v[244:247], v[20:23], v[196:199]
    ds_read_b64_tr_b16 v[82:83], v6 offset:512
    v_exp_f32 v113, v113
    v_exp_f32 v114, v114
    v_mfma_f32_16x16x32_bf16 v[200:203], v[248:251], v[20:23], v[200:203]
    ds_read_b128 v[52:55], v1 offset:27648
    v_exp_f32 v115, v115
    v_exp_f32 v148, v148
    v_mfma_f32_16x16x32_bf16 v[204:207], v[240:243], v[24:27], v[204:207]
    ds_read_b128 v[56:59], v1 offset:28672
    v_exp_f32 v149, v149
    v_mfma_f32_16x16x32_bf16 v[208:211], v[244:247], v[24:27], v[208:211]
    ds_read_b128 v[60:63], v1 offset:29696
    v_exp_f32 v150, v150
    v_mfma_f32_16x16x32_bf16 v[212:215], v[248:251], v[24:27], v[212:215]
    ds_read_b128 v[64:67], v1 offset:30720
    v_exp_f32 v151, v151
    v_mfma_f32_16x16x32_bf16 v[216:219], v[240:243], v[28:31], v[216:219]
    ds_read_b128 v[68:71], v1 offset:31744
    v_cvt_pk_bf16_f32 v112, v112, v113
    v_mfma_f32_16x16x32_bf16 v[220:223], v[244:247], v[28:31], v[220:223]
    v_cvt_pk_bf16_f32 v113, v114, v115
    v_mfma_f32_16x16x32_bf16 v[224:227], v[248:251], v[28:31], v[224:227]
    v_cvt_pk_bf16_f32 v114, v148, v149
    v_mfma_f32_16x16x32_bf16 v[228:231], v[240:243], v[32:35], v[228:231]
    v_cvt_pk_bf16_f32 v115, v150, v151
    v_mfma_f32_16x16x32_bf16 v[232:235], v[244:247], v[32:35], v[232:235]
    v_fma_f32 v116, v116, s36, -v167
    v_mfma_f32_16x16x32_bf16 v[236:239], v[248:251], v[32:35], v[236:239]
    v_fma_f32 v117, v117, s36, -v167
    s_waitcnt lgkmcnt(0)
    s_barrier
    v_mfma_f32_16x16x32_bf16 v[180:183], v[72:75], v[52:55], v[180:183]
    ds_read_b64_tr_b16 v[240:241], v4 offset:12288
    ds_read_b64_tr_b16 v[242:243], v4 offset:12800
    v_add_f32 v174, v174, v144
    v_fma_f32 v118, v118, s36, -v167
    v_mfma_f32_16x16x32_bf16 v[184:187], v[76:79], v[52:55], v[184:187]
    ds_read_b64_tr_b16 v[244:245], v5 offset:12288
    ds_read_b64_tr_b16 v[246:247], v5 offset:12800
    v_fma_f32 v119, v119, s36, -v167
    v_mfma_f32_16x16x32_bf16 v[148:151], v[252:255], v[112:115], 0
    v_mfma_f32_16x16x32_bf16 v[188:191], v[80:83], v[52:55], v[188:191]
    ds_read_b64_tr_b16 v[248:249], v6 offset:12288
    ds_read_b64_tr_b16 v[250:251], v6 offset:12800
    v_fma_f32 v152, v152, s36, -v167
    v_fma_f32 v153, v153, s36, -v167
    v_mfma_f32_16x16x32_bf16 v[192:195], v[72:75], v[56:59], v[192:195]
    ds_read_b128 v[16:19], v8 offset:0
    v_fma_f32 v154, v154, s36, -v167
    v_fma_f32 v155, v155, s36, -v167
    v_mfma_f32_16x16x32_bf16 v[196:199], v[76:79], v[56:59], v[196:199]
    ds_read_b128 v[20:23], v8 offset:1024
    v_exp_f32 v116, v116
    v_exp_f32 v117, v117
    v_mfma_f32_16x16x32_bf16 v[200:203], v[80:83], v[56:59], v[200:203]
    ds_read_b128 v[24:27], v8 offset:2048
    v_exp_f32 v118, v118
    v_exp_f32 v119, v119
    v_mfma_f32_16x16x32_bf16 v[204:207], v[72:75], v[60:63], v[204:207]
    ds_read_b128 v[28:31], v8 offset:3072
    v_exp_f32 v152, v152
    v_mfma_f32_16x16x32_bf16 v[208:211], v[76:79], v[60:63], v[208:211]
    ds_read_b128 v[32:35], v8 offset:4096
    v_exp_f32 v153, v153
    v_mfma_f32_16x16x32_bf16 v[212:215], v[80:83], v[60:63], v[212:215]
    ds_write_b128 v9, v[88:91] offset:0
    v_exp_f32 v154, v154
    v_mfma_f32_16x16x32_bf16 v[216:219], v[72:75], v[64:67], v[216:219]
    ds_write_b128 v9, v[92:95] offset:1024
    v_exp_f32 v155, v155
    v_mfma_f32_16x16x32_bf16 v[220:223], v[76:79], v[64:67], v[220:223]
    v_cvt_pk_bf16_f32 v116, v116, v117
    v_mfma_f32_16x16x32_bf16 v[224:227], v[80:83], v[64:67], v[224:227]
    v_cvt_pk_bf16_f32 v117, v118, v119
    v_mfma_f32_16x16x32_bf16 v[228:231], v[72:75], v[68:71], v[228:231]
    v_cvt_pk_bf16_f32 v118, v152, v153
    v_mfma_f32_16x16x32_bf16 v[232:235], v[76:79], v[68:71], v[232:235]
    v_cvt_pk_bf16_f32 v119, v154, v155
    v_mfma_f32_16x16x32_bf16 v[236:239], v[80:83], v[68:71], v[236:239]
    v_fma_f32 v120, v120, s36, -v168
    s_waitcnt lgkmcnt(0)
    s_barrier
    v_mfma_f32_16x16x32_bf16 v[180:183], v[240:243], v[16:19], v[180:183]
    ds_read_b64_tr_b16 v[72:73], v4 offset:24576
    ds_read_b64_tr_b16 v[74:75], v4 offset:25088
    v_fma_f32 v121, v121, s36, -v168
    v_add_f32 v175, v175, v148
    v_mfma_f32_16x16x32_bf16 v[184:187], v[244:247], v[16:19], v[184:187]
    ds_read_b64_tr_b16 v[76:77], v5 offset:24576
    ds_read_b64_tr_b16 v[78:79], v5 offset:25088
    v_fma_f32 v122, v122, s36, -v168
    v_fma_f32 v123, v123, s36, -v168
    v_mfma_f32_16x16x32_bf16 v[188:191], v[248:251], v[16:19], v[188:191]
    ds_read_b64_tr_b16 v[80:81], v6 offset:24576
    ds_read_b64_tr_b16 v[82:83], v6 offset:25088
    v_mfma_f32_16x16x32_bf16 v[152:155], v[252:255], v[116:119], 0
    v_fma_f32 v156, v156, s36, -v168
    v_mfma_f32_16x16x32_bf16 v[192:195], v[240:243], v[20:23], v[192:195]
    ds_read_b128 v[52:55], v8 offset:9216
    ds_read_b128 v[56:59], v8 offset:10240
    v_fma_f32 v157, v157, s36, -v168
    v_fma_f32 v158, v158, s36, -v168
    v_mfma_f32_16x16x32_bf16 v[196:199], v[244:247], v[20:23], v[196:199]
    ds_read_b128 v[60:63], v8 offset:11264
    v_fma_f32 v159, v159, s36, -v168
    v_exp_f32 v120, v120
    v_mfma_f32_16x16x32_bf16 v[200:203], v[248:251], v[20:23], v[200:203]
    ds_read_b128 v[64:67], v8 offset:12288
    v_exp_f32 v121, v121
    v_exp_f32 v122, v122
    v_mfma_f32_16x16x32_bf16 v[204:207], v[240:243], v[24:27], v[204:207]
    ds_read_b128 v[68:71], v8 offset:13312
    v_exp_f32 v123, v123
    v_mfma_f32_16x16x32_bf16 v[208:211], v[244:247], v[24:27], v[208:211]
    ds_write_b128 v9, v[96:99] offset:2048
    v_exp_f32 v156, v156
    v_mfma_f32_16x16x32_bf16 v[212:215], v[248:251], v[24:27], v[212:215]
    ds_write_b128 v9, v[100:103] offset:3072
    v_exp_f32 v157, v157
    v_mfma_f32_16x16x32_bf16 v[216:219], v[240:243], v[28:31], v[216:219]
    ds_write_b128 v9, v[104:107] offset:4096
    v_exp_f32 v158, v158
    v_mfma_f32_16x16x32_bf16 v[220:223], v[244:247], v[28:31], v[220:223]
    v_exp_f32 v159, v159
    v_mfma_f32_16x16x32_bf16 v[224:227], v[248:251], v[28:31], v[224:227]
    v_cvt_pk_bf16_f32 v120, v120, v121
    v_mfma_f32_16x16x32_bf16 v[228:231], v[240:243], v[32:35], v[228:231]
    v_cvt_pk_bf16_f32 v121, v122, v123
    v_mfma_f32_16x16x32_bf16 v[232:235], v[244:247], v[32:35], v[232:235]
    v_cvt_pk_bf16_f32 v122, v156, v157
    v_mfma_f32_16x16x32_bf16 v[236:239], v[248:251], v[32:35], v[236:239]
    v_cvt_pk_bf16_f32 v123, v158, v159
    s_waitcnt lgkmcnt(0)
    s_barrier
    s_cmp_eq_u32 s59, 0
    s_cbranch_scc0 LA_t2_25
    s_lshr_b32 s30, s58, 1
    s_mul_i32 s30, s30, 360
    s_mul_i32 s57, s24, 45
    s_add_u32 s30, s30, s57
    v_min_u32 v46, 44, v0
    v_add_u32 v46, s30, v46
    v_lshlrev_b32 v46, 7, v46
    buffer_load_dword v47, v46, s[44:47], 0 offen
    s_branch LA_t3_26
LA_t2_25:
    s_mul_i32 s30, s24, 7680
    v_min_u32 v46, 59, v0
    v_lshlrev_b32 v46, 7, v46
    buffer_load_dword v47, v46, s[48:51], s30 offen
LA_t3_26:
    v_mfma_f32_16x16x32_bf16 v[180:183], v[72:75], v[52:55], v[180:183]
    ds_read_b64_tr_b16 v[240:241], v4 offset:36864
    ds_read_b64_tr_b16 v[242:243], v4 offset:37376
    v_mfma_f32_16x16x32_bf16 v[156:159], v[252:255], v[120:123], 0
    v_mfma_f32_16x16x32_bf16 v[184:187], v[76:79], v[52:55], v[184:187]
    ds_read_b64_tr_b16 v[244:245], v5 offset:36864
    ds_read_b64_tr_b16 v[246:247], v5 offset:37376
    v_add_f32 v176, v176, v152
    v_mfma_f32_16x16x32_bf16 v[188:191], v[80:83], v[52:55], v[188:191]
    ds_read_b64_tr_b16 v[248:249], v6 offset:36864
    ds_read_b64_tr_b16 v[250:251], v6 offset:37376
    v_mfma_f32_16x16x32_bf16 v[192:195], v[72:75], v[56:59], v[192:195]
    ds_read_b128 v[16:19], v8 offset:18432
    v_mfma_f32_16x16x32_bf16 v[196:199], v[76:79], v[56:59], v[196:199]
    ds_read_b128 v[20:23], v8 offset:19456
    v_mfma_f32_16x16x32_bf16 v[200:203], v[80:83], v[56:59], v[200:203]
    ds_read_b128 v[24:27], v8 offset:20480
    v_mfma_f32_16x16x32_bf16 v[204:207], v[72:75], v[60:63], v[204:207]
    ds_read_b128 v[28:31], v8 offset:21504
    v_mfma_f32_16x16x32_bf16 v[208:211], v[76:79], v[60:63], v[208:211]
    ds_read_b128 v[32:35], v8 offset:22528
    v_mfma_f32_16x16x32_bf16 v[212:215], v[80:83], v[60:63], v[212:215]
    ds_write_b128 v9, v[108:111] offset:5120
    v_mfma_f32_16x16x32_bf16 v[216:219], v[72:75], v[64:67], v[216:219]
    ds_write_b128 v9, v[112:115] offset:6144
    v_mfma_f32_16x16x32_bf16 v[220:223], v[76:79], v[64:67], v[220:223]
    v_mfma_f32_16x16x32_bf16 v[224:227], v[80:83], v[64:67], v[224:227]
    v_mfma_f32_16x16x32_bf16 v[228:231], v[72:75], v[68:71], v[228:231]
    v_mfma_f32_16x16x32_bf16 v[232:235], v[76:79], v[68:71], v[232:235]
    v_mfma_f32_16x16x32_bf16 v[236:239], v[80:83], v[68:71], v[236:239]
    s_waitcnt lgkmcnt(0)
    s_barrier
    v_mfma_f32_16x16x32_bf16 v[180:183], v[240:243], v[16:19], v[180:183]
    ds_read_b64_tr_b16 v[72:73], v84 offset:0
    ds_read_b64_tr_b16 v[74:75], v84 offset:512
    v_add_f32 v177, v177, v156
    v_mfma_f32_16x16x32_bf16 v[184:187], v[244:247], v[16:19], v[184:187]
    ds_read_b64_tr_b16 v[76:77], v85 offset:0
    ds_read_b64_tr_b16 v[78:79], v85 offset:512
    v_mfma_f32_16x16x32_bf16 v[188:191], v[248:251], v[16:19], v[188:191]
    ds_read_b64_tr_b16 v[80:81], v86 offset:0
    ds_read_b64_tr_b16 v[82:83], v86 offset:512
    v_mfma_f32_16x16x32_bf16 v[192:195], v[240:243], v[20:23], v[192:195]
    ds_read_b128 v[52:55], v8 offset:27648
    v_mfma_f32_16x16x32_bf16 v[196:199], v[244:247], v[20:23], v[196:199]
    ds_read_b128 v[56:59], v8 offset:28672
    v_mfma_f32_16x16x32_bf16 v[200:203], v[248:251], v[20:23], v[200:203]
    ds_read_b128 v[60:63], v8 offset:29696
    v_mfma_f32_16x16x32_bf16 v[204:207], v[240:243], v[24:27], v[204:207]
    ds_read_b128 v[64:67], v8 offset:30720
    v_mfma_f32_16x16x32_bf16 v[208:211], v[244:247], v[24:27], v[208:211]
    ds_read_b128 v[68:71], v8 offset:31744
    v_mfma_f32_16x16x32_bf16 v[212:215], v[248:251], v[24:27], v[212:215]
    ds_write_b128 v9, v[116:119] offset:7168
    v_mfma_f32_16x16x32_bf16 v[216:219], v[240:243], v[28:31], v[216:219]
    ds_write_b128 v9, v[120:123] offset:8192
    v_mfma_f32_16x16x32_bf16 v[220:223], v[244:247], v[28:31], v[220:223]
    v_mfma_f32_16x16x32_bf16 v[224:227], v[248:251], v[28:31], v[224:227]
    v_mfma_f32_16x16x32_bf16 v[228:231], v[240:243], v[32:35], v[228:231]
    v_mfma_f32_16x16x32_bf16 v[232:235], v[244:247], v[32:35], v[232:235]
    v_mfma_f32_16x16x32_bf16 v[236:239], v[248:251], v[32:35], v[236:239]
    s_waitcnt lgkmcnt(0)
    s_barrier
    v_mfma_f32_16x16x32_bf16 v[180:183], v[72:75], v[52:55], v[180:183]
    ds_read_b64_tr_b16 v[240:241], v84 offset:12288
    ds_read_b64_tr_b16 v[242:243], v84 offset:12800
    v_mfma_f32_16x16x32_bf16 v[184:187], v[76:79], v[52:55], v[184:187]
    ds_read_b64_tr_b16 v[244:245], v85 offset:12288
    v_mfma_f32_16x16x32_bf16 v[188:191], v[80:83], v[52:55], v[188:191]
    ds_read_b64_tr_b16 v[246:247], v85 offset:12800
    v_mfma_f32_16x16x32_bf16 v[192:195], v[72:75], v[56:59], v[192:195]
    ds_read_b64_tr_b16 v[248:249], v86 offset:12288
    v_mfma_f32_16x16x32_bf16 v[196:199], v[76:79], v[56:59], v[196:199]
    ds_read_b64_tr_b16 v[250:251], v86 offset:12800
    v_mfma_f32_16x16x32_bf16 v[200:203], v[80:83], v[56:59], v[200:203]
    ds_read_b128 v[16:19], v1 offset:0
    v_mfma_f32_16x16x32_bf16 v[204:207], v[72:75], v[60:63], v[204:207]
    ds_read_b128 v[20:23], v1 offset:1024
    v_mfma_f32_16x16x32_bf16 v[208:211], v[76:79], v[60:63], v[208:211]
    ds_read_b128 v[24:27], v1 offset:2048
    v_mfma_f32_16x16x32_bf16 v[212:215], v[80:83], v[60:63], v[212:215]
    ds_read_b128 v[28:31], v1 offset:3072
    v_mfma_f32_16x16x32_bf16 v[216:219], v[72:75], v[64:67], v[216:219]
    ds_read_b128 v[32:35], v1 offset:4096
    v_mfma_f32_16x16x32_bf16 v[220:223], v[76:79], v[64:67], v[220:223]
    v_mfma_f32_16x16x32_bf16 v[224:227], v[80:83], v[64:67], v[224:227]
    v_mfma_f32_16x16x32_bf16 v[228:231], v[72:75], v[68:71], v[228:231]
    v_mfma_f32_16x16x32_bf16 v[232:235], v[76:79], v[68:71], v[232:235]
    v_mfma_f32_16x16x32_bf16 v[236:239], v[80:83], v[68:71], v[236:239]
    s_waitcnt lgkmcnt(0)
    s_barrier
    v_mfma_f32_16x16x32_bf16 v[180:183], v[240:243], v[16:19], v[180:183]
    ds_read_b64_tr_b16 v[72:73], v84 offset:24576
    ds_read_b64_tr_b16 v[74:75], v84 offset:25088
    v_add_u32 v10, 0x24000, v10
    v_mfma_f32_16x16x32_bf16 v[184:187], v[244:247], v[16:19], v[184:187]
    ds_read_b64_tr_b16 v[76:77], v85 offset:24576
    v_add_u32 v11, 0x24000, v11
    v_mfma_f32_16x16x32_bf16 v[188:191], v[248:251], v[16:19], v[188:191]
    ds_read_b64_tr_b16 v[78:79], v85 offset:25088
    v_mfma_f32_16x16x32_bf16 v[192:195], v[240:243], v[20:23], v[192:195]
    ds_read_b64_tr_b16 v[80:81], v86 offset:24576
    v_mfma_f32_16x16x32_bf16 v[196:199], v[244:247], v[20:23], v[196:199]
    ds_read_b64_tr_b16 v[82:83], v86 offset:25088
    v_mfma_f32_16x16x32_bf16 v[200:203], v[248:251], v[20:23], v[200:203]
    ds_read_b128 v[52:55], v1 offset:9216
    v_mfma_f32_16x16x32_bf16 v[204:207], v[240:243], v[24:27], v[204:207]
    ds_read_b128 v[56:59], v1 offset:10240
    v_mfma_f32_16x16x32_bf16 v[208:211], v[244:247], v[24:27], v[208:211]
    ds_read_b128 v[60:63], v1 offset:11264
    v_mfma_f32_16x16x32_bf16 v[212:215], v[248:251], v[24:27], v[212:215]
    ds_read_b128 v[64:67], v1 offset:12288
    v_mfma_f32_16x16x32_bf16 v[216:219], v[240:243], v[28:31], v[216:219]
    ds_read_b128 v[68:71], v1 offset:13312
    v_mfma_f32_16x16x32_bf16 v[220:223], v[244:247], v[28:31], v[220:223]
    v_mfma_f32_16x16x32_bf16 v[224:227], v[248:251], v[28:31], v[224:227]
    v_mfma_f32_16x16x32_bf16 v[228:231], v[240:243], v[32:35], v[228:231]
    v_mfma_f32_16x16x32_bf16 v[232:235], v[244:247], v[32:35], v[232:235]
    v_mfma_f32_16x16x32_bf16 v[236:239], v[248:251], v[32:35], v[236:239]
    s_waitcnt lgkmcnt(0)
    s_barrier
    v_mfma_f32_16x16x32_bf16 v[180:183], v[72:75], v[52:55], v[180:183]
    ds_read_b64_tr_b16 v[240:241], v4 offset:0
    ds_read_b64_tr_b16 v[242:243], v4 offset:512
    v_mfma_f32_16x16x32_bf16 v[184:187], v[76:79], v[52:55], v[184:187]
    ds_read_b64_tr_b16 v[244:245], v5 offset:0
    ds_read_b64_tr_b16 v[246:247], v5 offset:512
    v_mfma_f32_16x16x32_bf16 v[188:191], v[80:83], v[52:55], v[188:191]
    ds_read_b64_tr_b16 v[248:249], v6 offset:0
    v_mfma_f32_16x16x32_bf16 v[192:195], v[72:75], v[56:59], v[192:195]
    ds_read_b64_tr_b16 v[250:251], v6 offset:512
    v_mfma_f32_16x16x32_bf16 v[196:199], v[76:79], v[56:59], v[196:199]
    ds_read_b128 v[16:19], v1 offset:18432
    v_mfma_f32_16x16x32_bf16 v[200:203], v[80:83], v[56:59], v[200:203]
    ds_read_b128 v[20:23], v1 offset:19456
    v_mfma_f32_16x16x32_bf16 v[204:207], v[72:75], v[60:63], v[204:207]
    ds_read_b128 v[24:27], v1 offset:20480
    v_mfma_f32_16x16x32_bf16 v[208:211], v[76:79], v[60:63], v[208:211]
    ds_read_b128 v[28:31], v1 offset:21504
    v_mfma_f32_16x16x32_bf16 v[212:215], v[80:83], v[60:63], v[212:215]
    ds_read_b128 v[32:35], v1 offset:22528
    v_mfma_f32_16x16x32_bf16 v[216:219], v[72:75], v[64:67], v[216:219]
    s_mov_b64 exec, 0xffff
    ds_write_b32 v11, v169 offset:0
    ds_write_b32 v11, v170 offset:768
    ds_write_b32 v11, v171 offset:1536
    ds_write_b32 v11, v172 offset:2304
    ds_write_b32 v11, v173 offset:3072
    ds_write_b32 v11, v174 offset:3840
    ds_write_b32 v11, v175 offset:4608
    ds_write_b32 v11, v176 offset:5376
    ds_write_b32 v11, v177 offset:6144
    s_mov_b64 exec, -1
    v_mfma_f32_16x16x32_bf16 v[220:223], v[76:79], v[64:67], v[220:223]
    v_mfma_f32_16x16x32_bf16 v[224:227], v[80:83], v[64:67], v[224:227]
    v_mfma_f32_16x16x32_bf16 v[228:231], v[72:75], v[68:71], v[228:231]
    v_mfma_f32_16x16x32_bf16 v[232:235], v[76:79], v[68:71], v[232:235]
    v_mfma_f32_16x16x32_bf16 v[236:239], v[80:83], v[68:71], v[236:239]
    s_waitcnt lgkmcnt(0)
    s_barrier
    v_mfma_f32_16x16x32_bf16 v[180:183], v[240:243], v[16:19], v[180:183]
    ds_read_b64_tr_b16 v[72:73], v4 offset:12288
    ds_read_b64_tr_b16 v[74:75], v4 offset:12800
    v_lshrrev_b32 v88, 4, v0
    v_lshrrev_b32 v89, 3, v0
    v_mfma_f32_16x16x32_bf16 v[184:187], v[244:247], v[16:19], v[184:187]
    ds_read_b64_tr_b16 v[76:77], v5 offset:12288
    s_lshl_b32 s30, s25, 3
    v_add_u32 v89, s30, v89
    v_mfma_f32_16x16x32_bf16 v[188:191], v[248:251], v[16:19], v[188:191]
    ds_read_b64_tr_b16 v[78:79], v5 offset:12800
    v_bfe_u32 v90, v0, 1, 2
    v_and_b32 v91, 1, v88
    v_mfma_f32_16x16x32_bf16 v[192:195], v[240:243], v[20:23], v[192:195]
    ds_read_b64_tr_b16 v[80:81], v6 offset:12288
    v_xor_b32 v90, v90, v91
    s_and_b32 s30, s25, 1
    v_mfma_f32_16x16x32_bf16 v[196:199], v[244:247], v[20:23], v[196:199]
    ds_read_b64_tr_b16 v[82:83], v6 offset:12800
    s_lshl_b32 s30, s30, 1
    v_xor_b32 v90, s30, v90
    v_mfma_f32_16x16x32_bf16 v[200:203], v[248:251], v[20:23], v[200:203]
    ds_read_b128 v[52:55], v1 offset:27648
    v_and_b32 v91, 1, v0
    v_lshlrev_b32 v91, 4, v91
    v_mfma_f32_16x16x32_bf16 v[204:207], v[240:243], v[24:27], v[204:207]
    ds_read_b128 v[56:59], v1 offset:28672
    v_lshl_add_u32 v90, v90, 5, v91
    v_mul_u32_u24 v154, 0x3000, v89
    v_mfma_f32_16x16x32_bf16 v[208:211], v[244:247], v[24:27], v[208:211]
    ds_read_b128 v[60:63], v1 offset:29696
    v_add_u32 v154, v154, v90
    v_mul_u32_u24 v2, 0x180, v89
    v_mfma_f32_16x16x32_bf16 v[212:215], v[248:251], v[24:27], v[212:215]
    ds_read_b128 v[64:67], v1 offset:30720
    v_add_u32 v2, v2, v90
    s_mul_i32 s30, s25, 36
    v_mfma_f32_16x16x32_bf16 v[216:219], v[240:243], v[28:31], v[216:219]
    ds_read_b128 v[68:71], v1 offset:31744
    v_lshrrev_b32 v89, 3, v0
    v_add_u32 v89, s30, v89
    v_mfma_f32_16x16x32_bf16 v[220:223], v[244:247], v[28:31], v[220:223]
    v_bfe_u32 v90, v89, 1, 3
    v_and_b32 v91, 7, v0
    v_mfma_f32_16x16x32_bf16 v[224:227], v[248:251], v[28:31], v[224:227]
    v_xor_b32 v90, v90, v91
    v_lshlrev_b32 v90, 4, v90
    v_mfma_f32_16x16x32_bf16 v[228:231], v[240:243], v[32:35], v[228:231]
    v_mul_u32_u24 v89, 0x500, v89
    v_add_u32 v152, v89, v90
    v_mfma_f32_16x16x32_bf16 v[232:235], v[244:247], v[32:35], v[232:235]
    v_xor_b32 v90, 64, v90
    v_mfma_f32_16x16x32_bf16 v[236:239], v[248:251], v[32:35], v[236:239]
    v_add_u32 v153, v89, v90
    s_waitcnt lgkmcnt(0)
    s_barrier
    s_cmp_eq_u32 s59, 0
    s_cbranch_scc0 LA_nx_27
    s_mov_b32 s4, s44
    s_mov_b32 s5, s45
    s_add_u32 m0, s34, 0x4800
    s_nop 0
    buffer_load_dwordx4 v154, s[8:11], s32 offen offset:0 lds
    s_add_u32 m0, s34, 0x5780
    s_nop 0
    buffer_load_dwordx4 v154, s[8:11], s32 offen offset:128 lds
    s_add_u32 m0, s34, 0x6700
    s_nop 0
    buffer_load_dwordx4 v154, s[8:11], s32 offen offset:256 lds
    s_add_u32 s32, s32, 0x60000
    s_add_u32 m0, s34, 0x7800
    s_nop 0
    buffer_load_dwordx4 v154, s[8:11], s32 offen offset:0 lds
    s_add_u32 m0, s34, 0x8780
    s_nop 0
    buffer_load_dwordx4 v154, s[8:11], s32 offen offset:128 lds
    s_add_u32 m0, s34, 0x9700
    s_nop 0
    buffer_load_dwordx4 v154, s[8:11], s32 offen offset:256 lds
    s_add_u32 s32, s32, 0x60000
    s_cmp_ge_u32 s32, 0x780000
    s_cselect_b32 s32, 0, s32
LA_nx_27:
    v_mfma_f32_16x16x32_bf16 v[180:183], v[72:75], v[52:55], v[180:183]
    v_mfma_f32_16x16x32_bf16 v[184:187], v[76:79], v[52:55], v[184:187]
    v_mfma_f32_16x16x32_bf16 v[188:191], v[80:83], v[52:55], v[188:191]
    v_mfma_f32_16x16x32_bf16 v[192:195], v[72:75], v[56:59], v[192:195]
    v_mfma_f32_16x16x32_bf16 v[196:199], v[76:79], v[56:59], v[196:199]
    v_mfma_f32_16x16x32_bf16 v[200:203], v[80:83], v[56:59], v[200:203]
    v_mfma_f32_16x16x32_bf16 v[204:207], v[72:75], v[60:63], v[204:207]
    v_mfma_f32_16x16x32_bf16 v[208:211], v[76:79], v[60:63], v[208:211]
    v_mfma_f32_16x16x32_bf16 v[212:215], v[80:83], v[60:63], v[212:215]
    v_mfma_f32_16x16x32_bf16 v[216:219], v[72:75], v[64:67], v[216:219]
    v_mfma_f32_16x16x32_bf16 v[220:223], v[76:79], v[64:67], v[220:223]
    v_mfma_f32_16x16x32_bf16 v[224:227], v[80:83], v[64:67], v[224:227]
    v_mfma_f32_16x16x32_bf16 v[228:231], v[72:75], v[68:71], v[228:231]
    v_mfma_f32_16x16x32_bf16 v[232:235], v[76:79], v[68:71], v[232:235]
    v_mfma_f32_16x16x32_bf16 v[236:239], v[80:83], v[68:71], v[236:239]
    s_cmp_eq_u32 s59, 0
    s_cbranch_scc0 LA_nx_28
    s_add_u32 m0, s34, 0xa800
    s_nop 0
    buffer_load_dwordx4 v154, s[8:11], s32 offen offset:0 lds
    s_add_u32 m0, s34, 0xb780
    s_nop 0
    buffer_load_dwordx4 v154, s[8:11], s32 offen offset:128 lds
    s_add_u32 m0, s34, 0xc700
    s_nop 0
    buffer_load_dwordx4 v154, s[8:11], s32 offen offset:256 lds
    s_add_u32 s32, s32, 0x60000
    s_add_u32 m0, s34, 0xd800
    s_nop 0
    buffer_load_dwordx4 v154, s[8:11], s32 offen offset:0 lds
    s_add_u32 m0, s34, 0xe780
    s_nop 0
    buffer_load_dwordx4 v154, s[8:11], s32 offen offset:128 lds
    s_add_u32 m0, s34, 0xf700
    s_nop 0
    buffer_load_dwordx4 v154, s[8:11], s32 offen offset:256 lds
    s_add_u32 s32, s32, 0x60000
    s_cmp_ge_u32 s32, 0x780000
    s_cselect_b32 s32, 0, s32
LA_nx_28:
    ds_read_b128 v[88:91], v10 offset:0
    ds_read_b128 v[92:95], v10 offset:16
    ds_read_b128 v[96:99], v10 offset:768
    ds_read_b128 v[100:103], v10 offset:784
    ds_read_b128 v[104:107], v10 offset:1536
    ds_read_b128 v[108:111], v10 offset:1552
    ds_read_b128 v[112:115], v10 offset:2304
    ds_read_b128 v[116:119], v10 offset:2320
    ds_read_b128 v[120:123], v10 offset:3072
    ds_read_b128 v[124:127], v10 offset:3088
    v_and_b32 v14, 15, v0
    v_lshlrev_b32 v14, 4, v14
    v_lshrrev_b32 v12, 5, v0
    v_lshl_add_u32 v14, v12, 8, v14
    v_bfe_u32 v12, v0, 4, 1
    v_lshl_add_u32 v14, v12, 3, v14
    v_add_u32 v12, s40, v14
    v_add_u32 v13, s41, v14
    v_add_u32 v14, s42, v14
    v_add_u32 v12, 0x15000, v12
    v_add_u32 v13, 0x15000, v13
    v_add_u32 v14, 0x15000, v14
    s_waitcnt lgkmcnt(0)
    v_add_f32 v88, v88, v92
    v_add_f32 v89, v89, v93
    v_add_f32 v90, v90, v94
    v_add_f32 v91, v91, v95
    v_add_f32 v96, v96, v100
    v_add_f32 v97, v97, v101
    v_add_f32 v98, v98, v102
    v_add_f32 v99, v99, v103
    v_add_f32 v104, v104, v108
    v_add_f32 v105, v105, v109
    v_add_f32 v106, v106, v110
    v_add_f32 v107, v107, v111
    v_add_f32 v112, v112, v116
    v_add_f32 v113, v113, v117
    v_add_f32 v114, v114, v118
    v_add_f32 v115, v115, v119
    v_add_f32 v120, v120, v124
    v_add_f32 v121, v121, v125
    v_add_f32 v122, v122, v126
    v_add_f32 v123, v123, v127
    v_add_f32 v88, v88, v89
    v_add_f32 v90, v90, v91
    v_add_f32 v96, v96, v97
    v_add_f32 v98, v98, v99
    v_add_f32 v104, v104, v105
    v_add_f32 v106, v106, v107
    v_add_f32 v112, v112, v113
    v_add_f32 v114, v114, v115
    v_add_f32 v120, v120, v121
    v_add_f32 v122, v122, v123
    v_add_f32 v88, v88, v90
    v_add_f32 v96, v96, v98
    v_add_f32 v104, v104, v106
    v_add_f32 v112, v112, v114
    v_add_f32 v120, v120, v122
    v_rcp_f32 v88, v88
    v_rcp_f32 v96, v96
    v_rcp_f32 v104, v104
    v_rcp_f32 v112, v112
    v_rcp_f32 v120, v120
    s_nop 0
    v_pk_mul_f32 v[180:181], v[180:181], v[88:89] op_sel_hi:[1,0]
    v_pk_mul_f32 v[182:183], v[182:183], v[88:89] op_sel_hi:[1,0]
    v_cvt_pk_bf16_f32 v180, v180, v181
    v_cvt_pk_bf16_f32 v181, v182, v183
    ds_write_b64 v12, v[180:181] offset:0
    v_pk_mul_f32 v[184:185], v[184:185], v[88:89] op_sel_hi:[1,0]
    v_pk_mul_f32 v[186:187], v[186:187], v[88:89] op_sel_hi:[1,0]
    v_cvt_pk_bf16_f32 v184, v184, v185
    v_cvt_pk_bf16_f32 v185, v186, v187
    ds_write_b64 v13, v[184:185] offset:0
    v_pk_mul_f32 v[188:189], v[188:189], v[88:89] op_sel_hi:[1,0]
    v_pk_mul_f32 v[190:191], v[190:191], v[88:89] op_sel_hi:[1,0]
    v_cvt_pk_bf16_f32 v188, v188, v189
    v_cvt_pk_bf16_f32 v189, v190, v191
    ds_write_b64 v14, v[188:189] offset:0
    v_pk_mul_f32 v[192:193], v[192:193], v[96:97] op_sel_hi:[1,0]
    v_pk_mul_f32 v[194:195], v[194:195], v[96:97] op_sel_hi:[1,0]
    v_cvt_pk_bf16_f32 v192, v192, v193
    v_cvt_pk_bf16_f32 v193, v194, v195
    ds_write_b64 v12, v[192:193] offset:1024
    v_pk_mul_f32 v[196:197], v[196:197], v[96:97] op_sel_hi:[1,0]
    v_pk_mul_f32 v[198:199], v[198:199], v[96:97] op_sel_hi:[1,0]
    v_cvt_pk_bf16_f32 v196, v196, v197
    v_cvt_pk_bf16_f32 v197, v198, v199
    ds_write_b64 v13, v[196:197] offset:1024
    v_pk_mul_f32 v[200:201], v[200:201], v[96:97] op_sel_hi:[1,0]
    v_pk_mul_f32 v[202:203], v[202:203], v[96:97] op_sel_hi:[1,0]
    v_cvt_pk_bf16_f32 v200, v200, v201
    v_cvt_pk_bf16_f32 v201, v202, v203
    ds_write_b64 v14, v[200:201] offset:1024
    v_pk_mul_f32 v[204:205], v[204:205], v[104:105] op_sel_hi:[1,0]
    v_pk_mul_f32 v[206:207], v[206:207], v[104:105] op_sel_hi:[1,0]
    v_cvt_pk_bf16_f32 v204, v204, v205
    v_cvt_pk_bf16_f32 v205, v206, v207
    ds_write_b64 v12, v[204:205] offset:2048
    v_pk_mul_f32 v[208:209], v[208:209], v[104:105] op_sel_hi:[1,0]
    v_pk_mul_f32 v[210:211], v[210:211], v[104:105] op_sel_hi:[1,0]
    v_cvt_pk_bf16_f32 v208, v208, v209
    v_cvt_pk_bf16_f32 v209, v210, v211
    ds_write_b64 v13, v[208:209] offset:2048
    v_pk_mul_f32 v[212:213], v[212:213], v[104:105] op_sel_hi:[1,0]
    v_pk_mul_f32 v[214:215], v[214:215], v[104:105] op_sel_hi:[1,0]
    v_cvt_pk_bf16_f32 v212, v212, v213
    v_cvt_pk_bf16_f32 v213, v214, v215
    ds_write_b64 v14, v[212:213] offset:2048
    v_pk_mul_f32 v[216:217], v[216:217], v[112:113] op_sel_hi:[1,0]
    v_pk_mul_f32 v[218:219], v[218:219], v[112:113] op_sel_hi:[1,0]
    v_cvt_pk_bf16_f32 v216, v216, v217
    v_cvt_pk_bf16_f32 v217, v218, v219
    ds_write_b64 v12, v[216:217] offset:3072
    v_pk_mul_f32 v[220:221], v[220:221], v[112:113] op_sel_hi:[1,0]
    v_pk_mul_f32 v[222:223], v[222:223], v[112:113] op_sel_hi:[1,0]
    v_cvt_pk_bf16_f32 v220, v220, v221
    v_cvt_pk_bf16_f32 v221, v222, v223
    ds_write_b64 v13, v[220:221] offset:3072
    v_pk_mul_f32 v[224:225], v[224:225], v[112:113] op_sel_hi:[1,0]
    v_pk_mul_f32 v[226:227], v[226:227], v[112:113] op_sel_hi:[1,0]
    v_cvt_pk_bf16_f32 v224, v224, v225
    v_cvt_pk_bf16_f32 v225, v226, v227
    ds_write_b64 v14, v[224:225] offset:3072
    v_pk_mul_f32 v[228:229], v[228:229], v[120:121] op_sel_hi:[1,0]
    v_pk_mul_f32 v[230:231], v[230:231], v[120:121] op_sel_hi:[1,0]
    v_cvt_pk_bf16_f32 v228, v228, v229
    v_cvt_pk_bf16_f32 v229, v230, v231
    ds_write_b64 v12, v[228:229] offset:4096
    v_pk_mul_f32 v[232:233], v[232:233], v[120:121] op_sel_hi:[1,0]
    v_pk_mul_f32 v[234:235], v[234:235], v[120:121] op_sel_hi:[1,0]
    v_cvt_pk_bf16_f32 v232, v232, v233
    v_cvt_pk_bf16_f32 v233, v234, v235
    ds_write_b64 v13, v[232:233] offset:4096
    v_pk_mul_f32 v[236:237], v[236:237], v[120:121] op_sel_hi:[1,0]
    v_pk_mul_f32 v[238:239], v[238:239], v[120:121] op_sel_hi:[1,0]
    v_cvt_pk_bf16_f32 v236, v236, v237
    v_cvt_pk_bf16_f32 v237, v238, v239
    ds_write_b64 v14, v[236:237] offset:4096
    s_mul_i32 s30, s24, 7168
    v_add_u32 v11, s30, v1
    v_add_u32 v10, 0x15000, v11
    s_waitcnt lgkmcnt(0)
    s_barrier
    ds_read_b128 v[160:163], v10 offset:0
    ds_read_b128 v[164:167], v10 offset:1024
    ds_read_b128 v[168:171], v10 offset:2048
    ds_read_b128 v[172:175], v10 offset:3072
    ds_read_b128 v[176:179], v10 offset:4096
    ds_read_b128 v[180:183], v10 offset:5120
    ds_read_b128 v[184:187], v10 offset:6144
    s_waitcnt lgkmcnt(6)
    s_mov_b32 s30, 0
    buffer_store_dwordx4 v[160:163], v11, s[20:23], s30 offen sc0 sc1
    s_waitcnt lgkmcnt(5)
    s_mov_b32 s30, 1024
    buffer_store_dwordx4 v[164:167], v11, s[20:23], s30 offen sc0 sc1
    s_waitcnt lgkmcnt(4)
    s_mov_b32 s30, 2048
    buffer_store_dwordx4 v[168:171], v11, s[20:23], s30 offen sc0 sc1
    s_waitcnt lgkmcnt(3)
    s_mov_b32 s30, 3072
    buffer_store_dwordx4 v[172:175], v11, s[20:23], s30 offen sc0 sc1
    s_waitcnt lgkmcnt(2)
    s_mov_b32 s30, 4096
    buffer_store_dwordx4 v[176:179], v11, s[20:23], s30 offen sc0 sc1
    s_waitcnt lgkmcnt(1)
    s_mov_b32 s30, 5120
    buffer_store_dwordx4 v[180:183], v11, s[20:23], s30 offen sc0 sc1
    s_waitcnt lgkmcnt(0)
    s_mov_b32 s30, 6144
    buffer_store_dwordx4 v[184:187], v11, s[20:23], s30 offen sc0 sc1
LA_st_29:
    s_cmp_eq_u32 s59, 0
    s_cbranch_scc0 LA_end
    s_mov_b32 s59, 1
    s_mov_b32 s35, 0
    s_add_u32 s12, s12, 25165824
    s_addc_u32 s13, s13, 0
    s_add_u32 s16, s16, 25165824
    s_addc_u32 s17, s17, 0
    s_add_u32 s20, s20, 7077888
    s_addc_u32 s21, s21, 0
    v_lshrrev_b32 v4, 4, v0
    v_and_b32 v5, 15, v0
    v_lshrrev_b32 v6, 4, v0
    v_bfe_u32 v7, v0, 2, 2
    v_lshl_add_u32 v6, v6, 3, v7
    v_and_b32 v7, 3, v0
    v_lshlrev_b32 v7, 3, v7
    v_lshl_add_u32 v6, v6, 7, v7
    v_bfe_u32 v7, v0, 3, 2
    v_xor_b32 v140, s96, v7
    v_lshl_add_u32 v140, v140, 5, v6
    s_add_u32 s30, s99, 0x4800
    v_add_u32 v140, s30, v140
    v_xor_b32 v141, s97, v7
    v_lshl_add_u32 v141, v141, 5, v6
    s_add_u32 s30, s100, 0x4800
    v_add_u32 v141, s30, v141
    v_xor_b32 v142, s98, v7
    v_lshl_add_u32 v142, v142, 5, v6
    s_add_u32 s30, s101, 0x4800
    v_add_u32 v142, s30, v142
    v_add_u32 v143, 0x15000, v140
    v_add_u32 v144, 0x15000, v141
    v_add_u32 v145, 0x15000, v142
    v_lshrrev_b32 v6, 1, v5
    v_xor_b32 v6, v6, v4
    v_lshlrev_b32 v6, 4, v6
    v_lshl_add_u32 v146, v5, 7, v6
    v_xor_b32 v147, 64, v146
    v_add_u32 v148, 0x10800, v146
    v_add_u32 v149, 0x10800, v147
    v_add_u32 v14, s37, v146
    v_add_u32 v15, s37, v147
    v_bfe_u32 v5, v0, 5, 1
    v_bfe_u32 v6, v0, 3, 2
    v_lshl_add_u32 v5, v5, 3, v6
    v_mul_u32_u24 v5, 0x180, v5
    s_mul_i32 s30, s24, 24576
    v_add_u32 v5, s30, v5
    v_and_b32 v7, 7, v0
    v_xor_b32 v6, v7, v4
    v_lshlrev_b32 v6, 4, v6
    v_add_u32 v12, v5, v6
    v_xor_b32 v6, 64, v6
    v_add_u32 v13, v5, v6
    v_add_u32 v13, 0x1800, v13
    v_and_b32 v157, 15, v0
    v_lshlrev_b32 v157, 4, v157
    v_lshrrev_b32 v155, 5, v0
    v_lshl_add_u32 v157, v155, 8, v157
    v_bfe_u32 v155, v0, 4, 1
    v_lshl_add_u32 v157, v155, 3, v157
    v_add_u32 v155, s40, v157
    v_add_u32 v156, s41, v157
    v_add_u32 v157, s42, v157
    s_waitcnt vmcnt(13) lgkmcnt(0)
    s_branch LA_p1_re0
LA_p3_g1:
    s_waitcnt vmcnt(8) lgkmcnt(0)
    s_barrier
    ds_read_b64_tr_b16 v[240:241], v4 offset:0
    ds_read_b64_tr_b16 v[242:243], v4 offset:512
    ds_read_b64_tr_b16 v[244:245], v5 offset:0
    ds_read_b64_tr_b16 v[246:247], v5 offset:512
    ds_read_b64_tr_b16 v[248:249], v6 offset:0
    ds_read_b64_tr_b16 v[250:251], v6 offset:512
    ds_read_b128 v[16:19], v8 offset:5120
    ds_read_b128 v[20:23], v8 offset:6144
    ds_read_b128 v[24:27], v8 offset:7168
    ds_read_b128 v[28:31], v8 offset:8192
    s_waitcnt lgkmcnt(0)
    s_barrier
    v_mfma_f32_16x16x32_bf16 v[180:183], v[240:243], v[16:19], 0
    ds_read_b64_tr_b16 v[72:73], v4 offset:12288
    ds_read_b64_tr_b16 v[74:75], v4 offset:12800
    v_fma_f32 v88, v88, s36, -v160
    v_fma_f32 v89, v89, s36, -v160
    v_fma_f32 v90, v90, s36, -v160
    v_mfma_f32_16x16x32_bf16 v[184:187], v[244:247], v[16:19], 0
    ds_read_b64_tr_b16 v[76:77], v5 offset:12288
    ds_read_b64_tr_b16 v[78:79], v5 offset:12800
    v_fma_f32 v91, v91, s36, -v160
    v_fma_f32 v124, v124, s36, -v160
    v_fma_f32 v125, v125, s36, -v160
    v_mfma_f32_16x16x32_bf16 v[188:191], v[248:251], v[16:19], 0
    ds_read_b64_tr_b16 v[80:81], v6 offset:12288
    ds_read_b64_tr_b16 v[82:83], v6 offset:12800
    v_fma_f32 v126, v126, s36, -v160
    v_fma_f32 v127, v127, s36, -v160
    v_exp_f32 v88, v88
    v_mfma_f32_16x16x32_bf16 v[192:195], v[240:243], v[20:23], 0
    ds_read_b128 v[52:55], v8 offset:14336
    ds_read_b128 v[56:59], v8 offset:15360
    v_exp_f32 v89, v89
    v_exp_f32 v90, v90
    v_exp_f32 v91, v91
    v_mfma_f32_16x16x32_bf16 v[196:199], v[244:247], v[20:23], 0
    ds_read_b128 v[60:63], v8 offset:16384
    ds_read_b128 v[64:67], v8 offset:17408
    v_exp_f32 v124, v124
    v_exp_f32 v125, v125
    v_exp_f32 v126, v126
    v_mfma_f32_16x16x32_bf16 v[200:203], v[248:251], v[20:23], 0
    s_add_u32 m0, s34, 0x12000
    s_mov_b32 s30, 0x12000
    buffer_load_dwordx4 v2, s[16:19], s30 offen offset:0 nt lds
    v_exp_f32 v127, v127
    v_cvt_pk_bf16_f32 v88, v88, v89
    v_cvt_pk_bf16_f32 v89, v90, v91
    v_mfma_f32_16x16x32_bf16 v[204:207], v[240:243], v[24:27], 0
    s_add_u32 m0, s34, 0x12f80
    s_mov_b32 s30, 0x12000
    buffer_load_dwordx4 v2, s[16:19], s30 offen offset:128 nt lds
    v_cvt_pk_bf16_f32 v90, v124, v125
    v_cvt_pk_bf16_f32 v91, v126, v127
    v_fma_f32 v92, v92, s36, -v161
    v_mfma_f32_16x16x32_bf16 v[208:211], v[244:247], v[24:27], 0
    s_add_u32 m0, s34, 0x13f00
    s_mov_b32 s30, 0x12000
    buffer_load_dwordx4 v2, s[16:19], s30 offen offset:256 nt lds
    v_fma_f32 v93, v93, s36, -v161
    v_fma_f32 v94, v94, s36, -v161
    v_fma_f32 v95, v95, s36, -v161
    v_mfma_f32_16x16x32_bf16 v[212:215], v[248:251], v[24:27], 0
    v_mfma_f32_16x16x32_bf16 v[124:127], v[252:255], v[88:91], 0
    v_fma_f32 v128, v128, s36, -v161
    v_fma_f32 v129, v129, s36, -v161
    v_mfma_f32_16x16x32_bf16 v[216:219], v[240:243], v[28:31], 0
    v_fma_f32 v130, v130, s36, -v161
    v_fma_f32 v131, v131, s36, -v161
    v_mfma_f32_16x16x32_bf16 v[220:223], v[244:247], v[28:31], 0
    v_exp_f32 v92, v92
    v_exp_f32 v93, v93
    v_mfma_f32_16x16x32_bf16 v[224:227], v[248:251], v[28:31], 0
    v_exp_f32 v94, v94
    v_exp_f32 v95, v95
    s_cmp_le_u32 s2, 2
    s_cbranch_scc0 LA_wb_31
    s_waitcnt vmcnt(7)
    s_cmp_le_u32 s3, 2
    s_cbranch_scc0 LA_wb_31
    s_waitcnt vmcnt(3)
LA_wb_31:
    s_waitcnt lgkmcnt(0)
    s_barrier
    v_mfma_f32_16x16x32_bf16 v[180:183], v[72:75], v[52:55], v[180:183]
    ds_read_b64_tr_b16 v[240:241], v4 offset:24576
    ds_read_b64_tr_b16 v[242:243], v4 offset:25088
    v_exp_f32 v128, v128
    v_exp_f32 v129, v129
    v_exp_f32 v130, v130
    v_mfma_f32_16x16x32_bf16 v[184:187], v[76:79], v[52:55], v[184:187]
    ds_read_b64_tr_b16 v[244:245], v5 offset:24576
    ds_read_b64_tr_b16 v[246:247], v5 offset:25088
    v_exp_f32 v131, v131
    v_cvt_pk_bf16_f32 v92, v92, v93
    v_cvt_pk_bf16_f32 v93, v94, v95
    v_mfma_f32_16x16x32_bf16 v[188:191], v[80:83], v[52:55], v[188:191]
    ds_read_b64_tr_b16 v[248:249], v6 offset:24576
    ds_read_b64_tr_b16 v[250:251], v6 offset:25088
    v_cvt_pk_bf16_f32 v94, v128, v129
    v_cvt_pk_bf16_f32 v95, v130, v131
    v_fma_f32 v96, v96, s36, -v162
    v_mfma_f32_16x16x32_bf16 v[192:195], v[72:75], v[56:59], v[192:195]
    ds_read_b128 v[16:19], v8 offset:23552
    ds_read_b128 v[20:23], v8 offset:24576
    v_fma_f32 v97, v97, s36, -v162
    v_add_f32 v169, v169, v124
    v_fma_f32 v98, v98, s36, -v162
    v_mfma_f32_16x16x32_bf16 v[196:199], v[76:79], v[56:59], v[196:199]
    ds_read_b128 v[24:27], v8 offset:25600
    ds_read_b128 v[28:31], v8 offset:26624
    v_fma_f32 v99, v99, s36, -v162
    v_mfma_f32_16x16x32_bf16 v[128:131], v[252:255], v[92:95], 0
    v_fma_f32 v132, v132, s36, -v162
    v_mfma_f32_16x16x32_bf16 v[200:203], v[80:83], v[56:59], v[200:203]
    s_add_u32 m0, s34, 0x15000
    s_mov_b32 s30, 0x1b000
    buffer_load_dwordx4 v2, s[16:19], s30 offen offset:0 nt lds
    v_fma_f32 v133, v133, s36, -v162
    v_fma_f32 v134, v134, s36, -v162
    v_fma_f32 v135, v135, s36, -v162
    v_mfma_f32_16x16x32_bf16 v[204:207], v[72:75], v[60:63], v[204:207]
    s_add_u32 m0, s34, 0x15f80
    s_mov_b32 s30, 0x1b000
    buffer_load_dwordx4 v2, s[16:19], s30 offen offset:128 nt lds
    v_exp_f32 v96, v96
    v_exp_f32 v97, v97
    v_exp_f32 v98, v98
    v_mfma_f32_16x16x32_bf16 v[208:211], v[76:79], v[60:63], v[208:211]
    s_add_u32 m0, s34, 0x16f00
    s_mov_b32 s30, 0x1b000
    buffer_load_dwordx4 v2, s[16:19], s30 offen offset:256 nt lds
    v_exp_f32 v99, v99
    v_exp_f32 v132, v132
    v_exp_f32 v133, v133
    v_mfma_f32_16x16x32_bf16 v[212:215], v[80:83], v[60:63], v[212:215]
    v_exp_f32 v134, v134
    v_exp_f32 v135, v135
    v_cvt_pk_bf16_f32 v96, v96, v97
    v_mfma_f32_16x16x32_bf16 v[216:219], v[72:75], v[64:67], v[216:219]
    v_cvt_pk_bf16_f32 v97, v98, v99
    v_cvt_pk_bf16_f32 v98, v132, v133
    v_mfma_f32_16x16x32_bf16 v[220:223], v[76:79], v[64:67], v[220:223]
    v_cvt_pk_bf16_f32 v99, v134, v135
    v_fma_f32 v100, v100, s36, -v163
    v_mfma_f32_16x16x32_bf16 v[224:227], v[80:83], v[64:67], v[224:227]
    v_fma_f32 v101, v101, s36, -v163
    v_add_f32 v170, v170, v128
    s_cmp_le_u32 s2, 3
    s_cbranch_scc0 LA_wb_33
    s_waitcnt vmcnt(10)
    s_cmp_le_u32 s3, 3
    s_cbranch_scc0 LA_wb_33
    s_waitcnt vmcnt(6)
LA_wb_33:
    s_waitcnt lgkmcnt(0)
    s_barrier
    v_mfma_f32_16x16x32_bf16 v[180:183], v[240:243], v[16:19], v[180:183]
    ds_read_b64_tr_b16 v[72:73], v4 offset:36864
    ds_read_b64_tr_b16 v[74:75], v4 offset:37376
    v_fma_f32 v102, v102, s36, -v163
    v_fma_f32 v103, v103, s36, -v163
    v_mfma_f32_16x16x32_bf16 v[132:135], v[252:255], v[96:99], 0
    v_mfma_f32_16x16x32_bf16 v[184:187], v[244:247], v[16:19], v[184:187]
    ds_read_b64_tr_b16 v[76:77], v5 offset:36864
    ds_read_b64_tr_b16 v[78:79], v5 offset:37376
    v_fma_f32 v136, v136, s36, -v163
    v_fma_f32 v137, v137, s36, -v163
    v_fma_f32 v138, v138, s36, -v163
    v_mfma_f32_16x16x32_bf16 v[188:191], v[248:251], v[16:19], v[188:191]
    ds_read_b64_tr_b16 v[80:81], v6 offset:36864
    ds_read_b64_tr_b16 v[82:83], v6 offset:37376
    v_fma_f32 v139, v139, s36, -v163
    v_exp_f32 v100, v100
    v_exp_f32 v101, v101
    v_mfma_f32_16x16x32_bf16 v[192:195], v[240:243], v[20:23], v[192:195]
    ds_read_b128 v[52:55], v8 offset:32768
    ds_read_b128 v[56:59], v8 offset:33792
    v_exp_f32 v102, v102
    v_exp_f32 v103, v103
    v_exp_f32 v136, v136
    v_mfma_f32_16x16x32_bf16 v[196:199], v[244:247], v[20:23], v[196:199]
    ds_read_b128 v[60:63], v8 offset:34816
    ds_read_b128 v[64:67], v8 offset:35840
    v_exp_f32 v137, v137
    v_exp_f32 v138, v138
    v_exp_f32 v139, v139
    v_mfma_f32_16x16x32_bf16 v[200:203], v[248:251], v[20:23], v[200:203]
    s_add_u32 m0, s34, 0x18000
    s_mov_b32 s30, 0x21000
    buffer_load_dwordx4 v2, s[16:19], s30 offen offset:0 nt lds
    v_cvt_pk_bf16_f32 v100, v100, v101
    v_cvt_pk_bf16_f32 v101, v102, v103
    v_cvt_pk_bf16_f32 v102, v136, v137
    v_mfma_f32_16x16x32_bf16 v[204:207], v[240:243], v[24:27], v[204:207]
    s_add_u32 m0, s34, 0x18f80
    s_mov_b32 s30, 0x21000
    buffer_load_dwordx4 v2, s[16:19], s30 offen offset:128 nt lds
    v_cvt_pk_bf16_f32 v103, v138, v139
    v_fma_f32 v104, v104, s36, -v164
    v_fma_f32 v105, v105, s36, -v164
    v_mfma_f32_16x16x32_bf16 v[208:211], v[244:247], v[24:27], v[208:211]
    s_add_u32 m0, s34, 0x19f00
    s_mov_b32 s30, 0x21000
    buffer_load_dwordx4 v2, s[16:19], s30 offen offset:256 nt lds
    v_add_f32 v171, v171, v132
    v_fma_f32 v106, v106, s36, -v164
    v_fma_f32 v107, v107, s36, -v164
    v_mfma_f32_16x16x32_bf16 v[212:215], v[248:251], v[24:27], v[212:215]
    v_mfma_f32_16x16x32_bf16 v[136:139], v[252:255], v[100:103], 0
    v_fma_f32 v140, v140, s36, -v164
    v_fma_f32 v141, v141, s36, -v164
    v_mfma_f32_16x16x32_bf16 v[216:219], v[240:243], v[28:31], v[216:219]
    v_fma_f32 v142, v142, s36, -v164
    v_fma_f32 v143, v143, s36, -v164
    v_mfma_f32_16x16x32_bf16 v[220:223], v[244:247], v[28:31], v[220:223]
    v_exp_f32 v104, v104
    v_exp_f32 v105, v105
    v_mfma_f32_16x16x32_bf16 v[224:227], v[248:251], v[28:31], v[224:227]
    v_exp_f32 v106, v106
    v_exp_f32 v107, v107
    s_cmp_le_u32 s2, 4
    s_cbranch_scc0 LA_wb_35
    s_waitcnt vmcnt(13)
    s_cmp_le_u32 s3, 4
    s_cbranch_scc0 LA_wb_35
    s_waitcnt vmcnt(9)
LA_wb_35:
    s_waitcnt lgkmcnt(0)
    s_barrier
    v_mfma_f32_16x16x32_bf16 v[180:183], v[72:75], v[52:55], v[180:183]
    ds_read_b64_tr_b16 v[240:241], v84 offset:0
    ds_read_b64_tr_b16 v[242:243], v84 offset:512
    v_exp_f32 v140, v140
    v_exp_f32 v141, v141
    v_exp_f32 v142, v142
    v_mfma_f32_16x16x32_bf16 v[184:187], v[76:79], v[52:55], v[184:187]
    ds_read_b64_tr_b16 v[244:245], v85 offset:0
    ds_read_b64_tr_b16 v[246:247], v85 offset:512
    v_exp_f32 v143, v143
    v_cvt_pk_bf16_f32 v104, v104, v105
    v_cvt_pk_bf16_f32 v105, v106, v107
    v_mfma_f32_16x16x32_bf16 v[188:191], v[80:83], v[52:55], v[188:191]
    ds_read_b64_tr_b16 v[248:249], v86 offset:0
    ds_read_b64_tr_b16 v[250:251], v86 offset:512
    v_cvt_pk_bf16_f32 v106, v140, v141
    v_cvt_pk_bf16_f32 v107, v142, v143
    v_fma_f32 v108, v108, s36, -v165
    v_mfma_f32_16x16x32_bf16 v[192:195], v[72:75], v[56:59], v[192:195]
    ds_read_b128 v[16:19], v1 offset:5120
    ds_read_b128 v[20:23], v1 offset:6144
    v_fma_f32 v109, v109, s36, -v165
    v_add_f32 v172, v172, v136
    v_fma_f32 v110, v110, s36, -v165
    v_mfma_f32_16x16x32_bf16 v[196:199], v[76:79], v[56:59], v[196:199]
    ds_read_b128 v[24:27], v1 offset:7168
    ds_read_b128 v[28:31], v1 offset:8192
    v_fma_f32 v111, v111, s36, -v165
    v_mfma_f32_16x16x32_bf16 v[140:143], v[252:255], v[104:107], 0
    v_fma_f32 v144, v144, s36, -v165
    v_mfma_f32_16x16x32_bf16 v[200:203], v[80:83], v[56:59], v[200:203]
    ds_write_b128 v9, v[88:91] offset:0
    ds_write_b128 v9, v[92:95] offset:1024
    v_fma_f32 v145, v145, s36, -v165
    v_fma_f32 v146, v146, s36, -v165
    v_fma_f32 v147, v147, s36, -v165
    v_mfma_f32_16x16x32_bf16 v[204:207], v[72:75], v[60:63], v[204:207]
    s_add_u32 m0, s34, 0x1b000
    s_mov_b32 s30, 0x27000
    buffer_load_dwordx4 v2, s[16:19], s30 offen offset:0 nt lds
    s_add_u32 m0, s34, 0x1bf80
    s_mov_b32 s30, 0x27000
    buffer_load_dwordx4 v2, s[16:19], s30 offen offset:128 nt lds
    v_exp_f32 v108, v108
    v_exp_f32 v109, v109
    v_exp_f32 v110, v110
    v_mfma_f32_16x16x32_bf16 v[208:211], v[76:79], v[60:63], v[208:211]
    s_add_u32 m0, s34, 0x1cf00
    s_mov_b32 s30, 0x27000
    buffer_load_dwordx4 v2, s[16:19], s30 offen offset:256 nt lds
    v_exp_f32 v111, v111
    v_exp_f32 v144, v144
    v_exp_f32 v145, v145
    v_mfma_f32_16x16x32_bf16 v[212:215], v[80:83], v[60:63], v[212:215]
    v_exp_f32 v146, v146
    v_exp_f32 v147, v147
    v_mfma_f32_16x16x32_bf16 v[216:219], v[72:75], v[64:67], v[216:219]
    v_cvt_pk_bf16_f32 v108, v108, v109
    v_cvt_pk_bf16_f32 v109, v110, v111
    v_mfma_f32_16x16x32_bf16 v[220:223], v[76:79], v[64:67], v[220:223]
    v_cvt_pk_bf16_f32 v110, v144, v145
    v_cvt_pk_bf16_f32 v111, v146, v147
    v_mfma_f32_16x16x32_bf16 v[224:227], v[80:83], v[64:67], v[224:227]
    v_fma_f32 v112, v112, s36, -v166
    v_fma_f32 v113, v113, s36, -v166
    s_cmp_le_u32 s2, 5
    s_cbranch_scc0 LA_wb_37
    s_waitcnt vmcnt(16)
    s_cmp_le_u32 s3, 5
    s_cbranch_scc0 LA_wb_37
    s_waitcnt vmcnt(12)
LA_wb_37:
    s_waitcnt lgkmcnt(0)
    s_barrier
    v_mfma_f32_16x16x32_bf16 v[180:183], v[240:243], v[16:19], v[180:183]
    ds_read_b64_tr_b16 v[72:73], v84 offset:12288
    ds_read_b64_tr_b16 v[74:75], v84 offset:12800
    v_add_f32 v173, v173, v140
    v_fma_f32 v114, v114, s36, -v166
    v_fma_f32 v115, v115, s36, -v166
    v_mfma_f32_16x16x32_bf16 v[184:187], v[244:247], v[16:19], v[184:187]
    ds_read_b64_tr_b16 v[76:77], v85 offset:12288
    ds_read_b64_tr_b16 v[78:79], v85 offset:12800
    v_mfma_f32_16x16x32_bf16 v[144:147], v[252:255], v[108:111], 0
    v_fma_f32 v148, v148, s36, -v166
    v_fma_f32 v149, v149, s36, -v166
    v_mfma_f32_16x16x32_bf16 v[188:191], v[248:251], v[16:19], v[188:191]
    ds_read_b64_tr_b16 v[80:81], v86 offset:12288
    ds_read_b64_tr_b16 v[82:83], v86 offset:12800
    v_fma_f32 v150, v150, s36, -v166
    v_fma_f32 v151, v151, s36, -v166
    v_exp_f32 v112, v112
    v_mfma_f32_16x16x32_bf16 v[192:195], v[240:243], v[20:23], v[192:195]
    ds_read_b128 v[52:55], v1 offset:14336
    ds_read_b128 v[56:59], v1 offset:15360
    v_exp_f32 v113, v113
    v_exp_f32 v114, v114
    v_exp_f32 v115, v115
    v_mfma_f32_16x16x32_bf16 v[196:199], v[244:247], v[20:23], v[196:199]
    ds_read_b128 v[60:63], v1 offset:16384
    ds_read_b128 v[64:67], v1 offset:17408
    v_exp_f32 v148, v148
    v_exp_f32 v149, v149
    v_exp_f32 v150, v150
    v_mfma_f32_16x16x32_bf16 v[200:203], v[248:251], v[20:23], v[200:203]
    ds_write_b128 v9, v[96:99] offset:2048
    ds_write_b128 v9, v[100:103] offset:3072
    v_exp_f32 v151, v151
    v_cvt_pk_bf16_f32 v112, v112, v113
    v_cvt_pk_bf16_f32 v113, v114, v115
    v_mfma_f32_16x16x32_bf16 v[204:207], v[240:243], v[24:27], v[204:207]
    ds_write_b128 v9, v[104:107] offset:4096
    s_add_u32 m0, s34, 0x1e000
    s_mov_b32 s30, 0x2d000
    buffer_load_dwordx4 v2, s[16:19], s30 offen offset:0 nt lds
    v_cvt_pk_bf16_f32 v114, v148, v149
    v_cvt_pk_bf16_f32 v115, v150, v151
    v_fma_f32 v116, v116, s36, -v167
    v_mfma_f32_16x16x32_bf16 v[208:211], v[244:247], v[24:27], v[208:211]
    s_add_u32 m0, s34, 0x1ef80
    s_mov_b32 s30, 0x2d000
    buffer_load_dwordx4 v2, s[16:19], s30 offen offset:128 nt lds
    s_add_u32 m0, s34, 0x1ff00
    s_mov_b32 s30, 0x2d000
    buffer_load_dwordx4 v2, s[16:19], s30 offen offset:256 nt lds
    v_fma_f32 v117, v117, s36, -v167
    v_add_f32 v174, v174, v144
    v_fma_f32 v118, v118, s36, -v167
    v_mfma_f32_16x16x32_bf16 v[212:215], v[248:251], v[24:27], v[212:215]
    v_fma_f32 v119, v119, s36, -v167
    v_mfma_f32_16x16x32_bf16 v[148:151], v[252:255], v[112:115], 0
    v_mfma_f32_16x16x32_bf16 v[216:219], v[240:243], v[28:31], v[216:219]
    v_fma_f32 v152, v152, s36, -v167
    v_fma_f32 v153, v153, s36, -v167
    v_mfma_f32_16x16x32_bf16 v[220:223], v[244:247], v[28:31], v[220:223]
    v_fma_f32 v154, v154, s36, -v167
    v_fma_f32 v155, v155, s36, -v167
    v_mfma_f32_16x16x32_bf16 v[224:227], v[248:251], v[28:31], v[224:227]
    v_exp_f32 v116, v116
    v_exp_f32 v117, v117
    s_cmp_le_u32 s2, 6
    s_cbranch_scc0 LA_wb_39
    s_waitcnt vmcnt(19)
    s_cmp_le_u32 s3, 6
    s_cbranch_scc0 LA_wb_39
    s_waitcnt vmcnt(15)
LA_wb_39:
    s_waitcnt lgkmcnt(0)
    s_barrier
    v_mfma_f32_16x16x32_bf16 v[180:183], v[72:75], v[52:55], v[180:183]
    ds_read_b64_tr_b16 v[240:241], v84 offset:24576
    ds_read_b64_tr_b16 v[242:243], v84 offset:25088
    v_exp_f32 v118, v118
    v_exp_f32 v119, v119
    v_exp_f32 v152, v152
    v_mfma_f32_16x16x32_bf16 v[184:187], v[76:79], v[52:55], v[184:187]
    ds_read_b64_tr_b16 v[244:245], v85 offset:24576
    ds_read_b64_tr_b16 v[246:247], v85 offset:25088
    v_exp_f32 v153, v153
    v_exp_f32 v154, v154
    v_exp_f32 v155, v155
    v_mfma_f32_16x16x32_bf16 v[188:191], v[80:83], v[52:55], v[188:191]
    ds_read_b64_tr_b16 v[248:249], v86 offset:24576
    ds_read_b64_tr_b16 v[250:251], v86 offset:25088
    v_cvt_pk_bf16_f32 v116, v116, v117
    v_cvt_pk_bf16_f32 v117, v118, v119
    v_cvt_pk_bf16_f32 v118, v152, v153
    v_mfma_f32_16x16x32_bf16 v[192:195], v[72:75], v[56:59], v[192:195]
    ds_read_b128 v[16:19], v1 offset:23552
    ds_read_b128 v[20:23], v1 offset:24576
    v_cvt_pk_bf16_f32 v119, v154, v155
    v_fma_f32 v120, v120, s36, -v168
    v_fma_f32 v121, v121, s36, -v168
    v_mfma_f32_16x16x32_bf16 v[196:199], v[76:79], v[56:59], v[196:199]
    ds_read_b128 v[24:27], v1 offset:25600
    ds_read_b128 v[28:31], v1 offset:26624
    v_add_f32 v175, v175, v148
    v_fma_f32 v122, v122, s36, -v168
    v_fma_f32 v123, v123, s36, -v168
    v_mfma_f32_16x16x32_bf16 v[200:203], v[80:83], v[56:59], v[200:203]
    ds_write_b128 v9, v[108:111] offset:5120
    ds_write_b128 v9, v[112:115] offset:6144
    v_mfma_f32_16x16x32_bf16 v[152:155], v[252:255], v[116:119], 0
    v_fma_f32 v156, v156, s36, -v168
    v_fma_f32 v157, v157, s36, -v168
    v_mfma_f32_16x16x32_bf16 v[204:207], v[72:75], v[60:63], v[204:207]
    s_add_u32 m0, s34, 0x21000
    s_mov_b32 s30, 0x3000
    buffer_load_dwordx4 v2, s[16:19], s30 offen offset:0 nt lds
    s_add_u32 m0, s34, 0x21f80
    s_mov_b32 s30, 0x3000
    buffer_load_dwordx4 v2, s[16:19], s30 offen offset:128 nt lds
    v_fma_f32 v158, v158, s36, -v168
    v_fma_f32 v159, v159, s36, -v168
    v_exp_f32 v120, v120
    v_mfma_f32_16x16x32_bf16 v[208:211], v[76:79], v[60:63], v[208:211]
    s_add_u32 m0, s34, 0x22f00
    s_mov_b32 s30, 0x3000
    buffer_load_dwordx4 v2, s[16:19], s30 offen offset:256 nt lds
    v_exp_f32 v121, v121
    v_exp_f32 v122, v122
    v_exp_f32 v123, v123
    v_mfma_f32_16x16x32_bf16 v[212:215], v[80:83], v[60:63], v[212:215]
    v_exp_f32 v156, v156
    v_exp_f32 v157, v157
    v_mfma_f32_16x16x32_bf16 v[216:219], v[72:75], v[64:67], v[216:219]
    v_exp_f32 v158, v158
    v_exp_f32 v159, v159
    v_mfma_f32_16x16x32_bf16 v[220:223], v[76:79], v[64:67], v[220:223]
    v_cvt_pk_bf16_f32 v120, v120, v121
    v_cvt_pk_bf16_f32 v121, v122, v123
    v_mfma_f32_16x16x32_bf16 v[224:227], v[80:83], v[64:67], v[224:227]
    v_cvt_pk_bf16_f32 v122, v156, v157
    v_cvt_pk_bf16_f32 v123, v158, v159
    s_waitcnt vmcnt(15) lgkmcnt(0)
    s_barrier
    v_mfma_f32_16x16x32_bf16 v[180:183], v[240:243], v[16:19], v[180:183]
    ds_read_b64_tr_b16 v[72:73], v4 offset:0
    ds_read_b64_tr_b16 v[74:75], v4 offset:512
    v_mfma_f32_16x16x32_bf16 v[156:159], v[252:255], v[120:123], 0
    v_mfma_f32_16x16x32_bf16 v[184:187], v[244:247], v[16:19], v[184:187]
    ds_read_b64_tr_b16 v[76:77], v5 offset:0
    ds_read_b64_tr_b16 v[78:79], v5 offset:512
    v_add_f32 v176, v176, v152
    v_mfma_f32_16x16x32_bf16 v[188:191], v[248:251], v[16:19], v[188:191]
    ds_read_b64_tr_b16 v[80:81], v6 offset:0
    ds_read_b64_tr_b16 v[82:83], v6 offset:512
    v_mfma_f32_16x16x32_bf16 v[192:195], v[240:243], v[20:23], v[192:195]
    ds_read_b128 v[52:55], v1 offset:32768
    ds_read_b128 v[56:59], v1 offset:33792
    v_mfma_f32_16x16x32_bf16 v[196:199], v[244:247], v[20:23], v[196:199]
    ds_read_b128 v[60:63], v1 offset:34816
    ds_read_b128 v[64:67], v1 offset:35840
    v_mfma_f32_16x16x32_bf16 v[200:203], v[248:251], v[20:23], v[200:203]
    ds_write_b128 v9, v[116:119] offset:7168
    ds_write_b128 v9, v[120:123] offset:8192
    v_mfma_f32_16x16x32_bf16 v[204:207], v[240:243], v[24:27], v[204:207]
    s_add_u32 m0, s34, 0x24000
    s_mov_b32 s30, 0x9000
    buffer_load_dwordx4 v2, s[16:19], s30 offen offset:0 nt lds
    s_add_u32 m0, s34, 0x24f80
    s_mov_b32 s30, 0x9000
    buffer_load_dwordx4 v2, s[16:19], s30 offen offset:128 nt lds
    v_mfma_f32_16x16x32_bf16 v[208:211], v[244:247], v[24:27], v[208:211]
    s_add_u32 m0, s34, 0x25f00
    s_mov_b32 s30, 0x9000
    buffer_load_dwordx4 v2, s[16:19], s30 offen offset:256 nt lds
    v_mfma_f32_16x16x32_bf16 v[212:215], v[248:251], v[24:27], v[212:215]
    v_mfma_f32_16x16x32_bf16 v[216:219], v[240:243], v[28:31], v[216:219]
    v_mfma_f32_16x16x32_bf16 v[220:223], v[244:247], v[28:31], v[220:223]
    v_mfma_f32_16x16x32_bf16 v[224:227], v[248:251], v[28:31], v[224:227]
    s_waitcnt vmcnt(15) lgkmcnt(0)
    s_barrier
    v_mfma_f32_16x16x32_bf16 v[180:183], v[72:75], v[52:55], v[180:183]
    ds_read_b64_tr_b16 v[240:241], v4 offset:12288
    ds_read_b64_tr_b16 v[242:243], v4 offset:12800
    v_add_f32 v177, v177, v156
    v_mfma_f32_16x16x32_bf16 v[184:187], v[76:79], v[52:55], v[184:187]
    ds_read_b64_tr_b16 v[244:245], v5 offset:12288
    ds_read_b64_tr_b16 v[246:247], v5 offset:12800
    v_mfma_f32_16x16x32_bf16 v[188:191], v[80:83], v[52:55], v[188:191]
    ds_read_b64_tr_b16 v[248:249], v6 offset:12288
    ds_read_b64_tr_b16 v[250:251], v6 offset:12800
    v_mfma_f32_16x16x32_bf16 v[192:195], v[72:75], v[56:59], v[192:195]
    ds_read_b128 v[16:19], v8 offset:5120
    ds_read_b128 v[20:23], v8 offset:6144
    v_mfma_f32_16x16x32_bf16 v[196:199], v[76:79], v[56:59], v[196:199]
    ds_read_b128 v[24:27], v8 offset:7168
    ds_read_b128 v[28:31], v8 offset:8192
    v_mfma_f32_16x16x32_bf16 v[200:203], v[80:83], v[56:59], v[200:203]
    s_add_u32 m0, s34, 0x12000
    s_mov_b32 s30, 0xf000
    buffer_load_dwordx4 v2, s[16:19], s30 offen offset:0 nt lds
    v_mfma_f32_16x16x32_bf16 v[204:207], v[72:75], v[60:63], v[204:207]
    s_add_u32 m0, s34, 0x12f80
    s_mov_b32 s30, 0xf000
    buffer_load_dwordx4 v2, s[16:19], s30 offen offset:128 nt lds
    v_mfma_f32_16x16x32_bf16 v[208:211], v[76:79], v[60:63], v[208:211]
    s_add_u32 m0, s34, 0x13f00
    s_mov_b32 s30, 0xf000
    buffer_load_dwordx4 v2, s[16:19], s30 offen offset:256 nt lds
    v_mfma_f32_16x16x32_bf16 v[212:215], v[80:83], v[60:63], v[212:215]
    v_mfma_f32_16x16x32_bf16 v[216:219], v[72:75], v[64:67], v[216:219]
    v_mfma_f32_16x16x32_bf16 v[220:223], v[76:79], v[64:67], v[220:223]
    v_mfma_f32_16x16x32_bf16 v[224:227], v[80:83], v[64:67], v[224:227]
    s_waitcnt vmcnt(15) lgkmcnt(0)
    s_barrier
    v_mfma_f32_16x16x32_bf16 v[180:183], v[240:243], v[16:19], v[180:183]
    ds_read_b64_tr_b16 v[72:73], v4 offset:24576
    ds_read_b64_tr_b16 v[74:75], v4 offset:25088
    v_mfma_f32_16x16x32_bf16 v[184:187], v[244:247], v[16:19], v[184:187]
    ds_read_b64_tr_b16 v[76:77], v5 offset:24576
    ds_read_b64_tr_b16 v[78:79], v5 offset:25088
    v_mfma_f32_16x16x32_bf16 v[188:191], v[248:251], v[16:19], v[188:191]
    ds_read_b64_tr_b16 v[80:81], v6 offset:24576
    ds_read_b64_tr_b16 v[82:83], v6 offset:25088
    v_mfma_f32_16x16x32_bf16 v[192:195], v[240:243], v[20:23], v[192:195]
    ds_read_b128 v[52:55], v8 offset:14336
    ds_read_b128 v[56:59], v8 offset:15360
    v_mfma_f32_16x16x32_bf16 v[196:199], v[244:247], v[20:23], v[196:199]
    ds_read_b128 v[60:63], v8 offset:16384
    ds_read_b128 v[64:67], v8 offset:17408
    v_mfma_f32_16x16x32_bf16 v[200:203], v[248:251], v[20:23], v[200:203]
    s_add_u32 m0, s34, 0x15000
    s_mov_b32 s30, 0x15000
    buffer_load_dwordx4 v2, s[16:19], s30 offen offset:0 nt lds
    v_mfma_f32_16x16x32_bf16 v[204:207], v[240:243], v[24:27], v[204:207]
    s_add_u32 m0, s34, 0x15f80
    s_mov_b32 s30, 0x15000
    buffer_load_dwordx4 v2, s[16:19], s30 offen offset:128 nt lds
    v_mfma_f32_16x16x32_bf16 v[208:211], v[244:247], v[24:27], v[208:211]
    s_add_u32 m0, s34, 0x16f00
    s_mov_b32 s30, 0x15000
    buffer_load_dwordx4 v2, s[16:19], s30 offen offset:256 nt lds
    v_mfma_f32_16x16x32_bf16 v[212:215], v[248:251], v[24:27], v[212:215]
    v_mfma_f32_16x16x32_bf16 v[216:219], v[240:243], v[28:31], v[216:219]
    v_mfma_f32_16x16x32_bf16 v[220:223], v[244:247], v[28:31], v[220:223]
    v_mfma_f32_16x16x32_bf16 v[224:227], v[248:251], v[28:31], v[224:227]
    s_waitcnt vmcnt(15) lgkmcnt(0)
    s_barrier
    s_cmp_eq_u32 s59, 0
    s_cbranch_scc0 LA_t2_40
    s_lshr_b32 s30, s58, 1
    s_mul_i32 s30, s30, 360
    s_mul_i32 s57, s24, 45
    s_add_u32 s30, s30, s57
    v_min_u32 v46, 44, v0
    v_add_u32 v46, s30, v46
    v_lshlrev_b32 v46, 7, v46
    buffer_load_dword v47, v46, s[44:47], 0 offen
    s_branch LA_t3_41
LA_t2_40:
    s_mul_i32 s30, s24, 7680
    v_min_u32 v46, 59, v0
    v_lshlrev_b32 v46, 7, v46
    buffer_load_dword v47, v46, s[48:51], s30 offen
LA_t3_41:
    v_mfma_f32_16x16x32_bf16 v[180:183], v[72:75], v[52:55], v[180:183]
    ds_read_b64_tr_b16 v[240:241], v4 offset:36864
    ds_read_b64_tr_b16 v[242:243], v4 offset:37376
    v_mfma_f32_16x16x32_bf16 v[184:187], v[76:79], v[52:55], v[184:187]
    ds_read_b64_tr_b16 v[244:245], v5 offset:36864
    ds_read_b64_tr_b16 v[246:247], v5 offset:37376
    v_mfma_f32_16x16x32_bf16 v[188:191], v[80:83], v[52:55], v[188:191]
    ds_read_b64_tr_b16 v[248:249], v6 offset:36864
    v_mfma_f32_16x16x32_bf16 v[192:195], v[72:75], v[56:59], v[192:195]
    ds_read_b64_tr_b16 v[250:251], v6 offset:37376
    v_mfma_f32_16x16x32_bf16 v[196:199], v[76:79], v[56:59], v[196:199]
    ds_read_b128 v[16:19], v8 offset:23552
    v_mfma_f32_16x16x32_bf16 v[200:203], v[80:83], v[56:59], v[200:203]
    ds_read_b128 v[20:23], v8 offset:24576
    v_mfma_f32_16x16x32_bf16 v[204:207], v[72:75], v[60:63], v[204:207]
    ds_read_b128 v[24:27], v8 offset:25600
    v_mfma_f32_16x16x32_bf16 v[208:211], v[76:79], v[60:63], v[208:211]
    ds_read_b128 v[28:31], v8 offset:26624
    v_mfma_f32_16x16x32_bf16 v[212:215], v[80:83], v[60:63], v[212:215]
    v_mfma_f32_16x16x32_bf16 v[216:219], v[72:75], v[64:67], v[216:219]
    v_mfma_f32_16x16x32_bf16 v[220:223], v[76:79], v[64:67], v[220:223]
    v_mfma_f32_16x16x32_bf16 v[224:227], v[80:83], v[64:67], v[224:227]
    s_waitcnt vmcnt(13) lgkmcnt(0)
    s_barrier
    v_mfma_f32_16x16x32_bf16 v[180:183], v[240:243], v[16:19], v[180:183]
    ds_read_b64_tr_b16 v[72:73], v84 offset:0
    ds_read_b64_tr_b16 v[74:75], v84 offset:512
    v_mfma_f32_16x16x32_bf16 v[184:187], v[244:247], v[16:19], v[184:187]
    ds_read_b64_tr_b16 v[76:77], v85 offset:0
    ds_read_b64_tr_b16 v[78:79], v85 offset:512
    v_mfma_f32_16x16x32_bf16 v[188:191], v[248:251], v[16:19], v[188:191]
    ds_read_b64_tr_b16 v[80:81], v86 offset:0
    v_mfma_f32_16x16x32_bf16 v[192:195], v[240:243], v[20:23], v[192:195]
    ds_read_b64_tr_b16 v[82:83], v86 offset:512
    v_mfma_f32_16x16x32_bf16 v[196:199], v[244:247], v[20:23], v[196:199]
    ds_read_b128 v[52:55], v8 offset:32768
    v_mfma_f32_16x16x32_bf16 v[200:203], v[248:251], v[20:23], v[200:203]
    ds_read_b128 v[56:59], v8 offset:33792
    v_mfma_f32_16x16x32_bf16 v[204:207], v[240:243], v[24:27], v[204:207]
    ds_read_b128 v[60:63], v8 offset:34816
    v_mfma_f32_16x16x32_bf16 v[208:211], v[244:247], v[24:27], v[208:211]
    ds_read_b128 v[64:67], v8 offset:35840
    v_mfma_f32_16x16x32_bf16 v[212:215], v[248:251], v[24:27], v[212:215]
    v_mfma_f32_16x16x32_bf16 v[216:219], v[240:243], v[28:31], v[216:219]
    v_mfma_f32_16x16x32_bf16 v[220:223], v[244:247], v[28:31], v[220:223]
    v_mfma_f32_16x16x32_bf16 v[224:227], v[248:251], v[28:31], v[224:227]
    s_waitcnt vmcnt(10) lgkmcnt(0)
    s_barrier
    v_mfma_f32_16x16x32_bf16 v[180:183], v[72:75], v[52:55], v[180:183]
    ds_read_b64_tr_b16 v[240:241], v84 offset:12288
    ds_read_b64_tr_b16 v[242:243], v84 offset:12800
    v_mfma_f32_16x16x32_bf16 v[184:187], v[76:79], v[52:55], v[184:187]
    ds_read_b64_tr_b16 v[244:245], v85 offset:12288
    ds_read_b64_tr_b16 v[246:247], v85 offset:12800
    v_mfma_f32_16x16x32_bf16 v[188:191], v[80:83], v[52:55], v[188:191]
    ds_read_b64_tr_b16 v[248:249], v86 offset:12288
    v_mfma_f32_16x16x32_bf16 v[192:195], v[72:75], v[56:59], v[192:195]
    ds_read_b64_tr_b16 v[250:251], v86 offset:12800
    v_mfma_f32_16x16x32_bf16 v[196:199], v[76:79], v[56:59], v[196:199]
    ds_read_b128 v[16:19], v1 offset:5120
    v_mfma_f32_16x16x32_bf16 v[200:203], v[80:83], v[56:59], v[200:203]
    ds_read_b128 v[20:23], v1 offset:6144
    v_mfma_f32_16x16x32_bf16 v[204:207], v[72:75], v[60:63], v[204:207]
    ds_read_b128 v[24:27], v1 offset:7168
    v_mfma_f32_16x16x32_bf16 v[208:211], v[76:79], v[60:63], v[208:211]
    ds_read_b128 v[28:31], v1 offset:8192
    v_mfma_f32_16x16x32_bf16 v[212:215], v[80:83], v[60:63], v[212:215]
    v_mfma_f32_16x16x32_bf16 v[216:219], v[72:75], v[64:67], v[216:219]
    v_mfma_f32_16x16x32_bf16 v[220:223], v[76:79], v[64:67], v[220:223]
    v_mfma_f32_16x16x32_bf16 v[224:227], v[80:83], v[64:67], v[224:227]
    s_waitcnt vmcnt(7) lgkmcnt(0)
    s_barrier
    v_mfma_f32_16x16x32_bf16 v[180:183], v[240:243], v[16:19], v[180:183]
    ds_read_b64_tr_b16 v[72:73], v84 offset:24576
    ds_read_b64_tr_b16 v[74:75], v84 offset:25088
    v_add_u32 v10, 0x24000, v10
    v_mfma_f32_16x16x32_bf16 v[184:187], v[244:247], v[16:19], v[184:187]
    ds_read_b64_tr_b16 v[76:77], v85 offset:24576
    ds_read_b64_tr_b16 v[78:79], v85 offset:25088
    v_add_u32 v11, 0x24000, v11
    v_mfma_f32_16x16x32_bf16 v[188:191], v[248:251], v[16:19], v[188:191]
    ds_read_b64_tr_b16 v[80:81], v86 offset:24576
    v_mfma_f32_16x16x32_bf16 v[192:195], v[240:243], v[20:23], v[192:195]
    ds_read_b64_tr_b16 v[82:83], v86 offset:25088
    v_mfma_f32_16x16x32_bf16 v[196:199], v[244:247], v[20:23], v[196:199]
    ds_read_b128 v[52:55], v1 offset:14336
    v_mfma_f32_16x16x32_bf16 v[200:203], v[248:251], v[20:23], v[200:203]
    ds_read_b128 v[56:59], v1 offset:15360
    v_mfma_f32_16x16x32_bf16 v[204:207], v[240:243], v[24:27], v[204:207]
    ds_read_b128 v[60:63], v1 offset:16384
    v_mfma_f32_16x16x32_bf16 v[208:211], v[244:247], v[24:27], v[208:211]
    ds_read_b128 v[64:67], v1 offset:17408
    v_mfma_f32_16x16x32_bf16 v[212:215], v[248:251], v[24:27], v[212:215]
    v_mfma_f32_16x16x32_bf16 v[216:219], v[240:243], v[28:31], v[216:219]
    v_mfma_f32_16x16x32_bf16 v[220:223], v[244:247], v[28:31], v[220:223]
    v_mfma_f32_16x16x32_bf16 v[224:227], v[248:251], v[28:31], v[224:227]
    s_waitcnt vmcnt(4) lgkmcnt(0)
    s_barrier
    v_mfma_f32_16x16x32_bf16 v[180:183], v[72:75], v[52:55], v[180:183]
    ds_read_b64_tr_b16 v[240:241], v4 offset:0
    ds_read_b64_tr_b16 v[242:243], v4 offset:512
    v_mfma_f32_16x16x32_bf16 v[184:187], v[76:79], v[52:55], v[184:187]
    ds_read_b64_tr_b16 v[244:245], v5 offset:0
    ds_read_b64_tr_b16 v[246:247], v5 offset:512
    v_mfma_f32_16x16x32_bf16 v[188:191], v[80:83], v[52:55], v[188:191]
    ds_read_b64_tr_b16 v[248:249], v6 offset:0
    ds_read_b64_tr_b16 v[250:251], v6 offset:512
    v_mfma_f32_16x16x32_bf16 v[192:195], v[72:75], v[56:59], v[192:195]
    ds_read_b128 v[16:19], v1 offset:23552
    v_mfma_f32_16x16x32_bf16 v[196:199], v[76:79], v[56:59], v[196:199]
    ds_read_b128 v[20:23], v1 offset:24576
    v_mfma_f32_16x16x32_bf16 v[200:203], v[80:83], v[56:59], v[200:203]
    ds_read_b128 v[24:27], v1 offset:25600
    v_mfma_f32_16x16x32_bf16 v[204:207], v[72:75], v[60:63], v[204:207]
    ds_read_b128 v[28:31], v1 offset:26624
    v_mfma_f32_16x16x32_bf16 v[208:211], v[76:79], v[60:63], v[208:211]
    s_mov_b64 exec, 0xffff
    ds_write_b32 v11, v169 offset:0
    ds_write_b32 v11, v170 offset:768
    ds_write_b32 v11, v171 offset:1536
    ds_write_b32 v11, v172 offset:2304
    ds_write_b32 v11, v173 offset:3072
    ds_write_b32 v11, v174 offset:3840
    ds_write_b32 v11, v175 offset:4608
    ds_write_b32 v11, v176 offset:5376
    ds_write_b32 v11, v177 offset:6144
    s_mov_b64 exec, -1
    v_mfma_f32_16x16x32_bf16 v[212:215], v[80:83], v[60:63], v[212:215]
    v_mfma_f32_16x16x32_bf16 v[216:219], v[72:75], v[64:67], v[216:219]
    v_mfma_f32_16x16x32_bf16 v[220:223], v[76:79], v[64:67], v[220:223]
    v_mfma_f32_16x16x32_bf16 v[224:227], v[80:83], v[64:67], v[224:227]
    s_waitcnt vmcnt(1) lgkmcnt(0)
    s_barrier
    v_mfma_f32_16x16x32_bf16 v[180:183], v[240:243], v[16:19], v[180:183]
    ds_read_b64_tr_b16 v[72:73], v4 offset:12288
    ds_read_b64_tr_b16 v[74:75], v4 offset:12800
    v_lshrrev_b32 v88, 4, v0
    v_lshrrev_b32 v89, 3, v0
    s_lshl_b32 s30, s25, 3
    v_mfma_f32_16x16x32_bf16 v[184:187], v[244:247], v[16:19], v[184:187]
    ds_read_b64_tr_b16 v[76:77], v5 offset:12288
    ds_read_b64_tr_b16 v[78:79], v5 offset:12800
    v_add_u32 v89, s30, v89
    v_bfe_u32 v90, v0, 1, 2
    v_and_b32 v91, 1, v88
    v_mfma_f32_16x16x32_bf16 v[188:191], v[248:251], v[16:19], v[188:191]
    ds_read_b64_tr_b16 v[80:81], v6 offset:12288
    v_xor_b32 v90, v90, v91
    s_and_b32 s30, s25, 1
    s_lshl_b32 s30, s30, 1
    v_mfma_f32_16x16x32_bf16 v[192:195], v[240:243], v[20:23], v[192:195]
    ds_read_b64_tr_b16 v[82:83], v6 offset:12800
    v_xor_b32 v90, s30, v90
    v_and_b32 v91, 1, v0
    v_lshlrev_b32 v91, 4, v91
    v_mfma_f32_16x16x32_bf16 v[196:199], v[244:247], v[20:23], v[196:199]
    ds_read_b128 v[52:55], v1 offset:32768
    v_lshl_add_u32 v90, v90, 5, v91
    v_mul_u32_u24 v154, 0x3000, v89
    v_mfma_f32_16x16x32_bf16 v[200:203], v[248:251], v[20:23], v[200:203]
    ds_read_b128 v[56:59], v1 offset:33792
    v_add_u32 v154, v154, v90
    v_mul_u32_u24 v2, 0x180, v89
    v_mfma_f32_16x16x32_bf16 v[204:207], v[240:243], v[24:27], v[204:207]
    ds_read_b128 v[60:63], v1 offset:34816
    v_add_u32 v2, v2, v90
    s_mul_i32 s30, s25, 36
    v_mfma_f32_16x16x32_bf16 v[208:211], v[244:247], v[24:27], v[208:211]
    ds_read_b128 v[64:67], v1 offset:35840
    v_lshrrev_b32 v89, 3, v0
    v_add_u32 v89, s30, v89
    v_mfma_f32_16x16x32_bf16 v[212:215], v[248:251], v[24:27], v[212:215]
    v_bfe_u32 v90, v89, 1, 3
    v_and_b32 v91, 7, v0
    v_mfma_f32_16x16x32_bf16 v[216:219], v[240:243], v[28:31], v[216:219]
    v_xor_b32 v90, v90, v91
    v_lshlrev_b32 v90, 4, v90
    v_mfma_f32_16x16x32_bf16 v[220:223], v[244:247], v[28:31], v[220:223]
    v_mul_u32_u24 v89, 0x500, v89
    v_add_u32 v152, v89, v90
    v_mfma_f32_16x16x32_bf16 v[224:227], v[248:251], v[28:31], v[224:227]
    v_xor_b32 v90, 64, v90
    v_add_u32 v153, v89, v90
    s_waitcnt lgkmcnt(0)
    s_barrier
    s_cmp_eq_u32 s59, 0
    s_cbranch_scc0 LA_nx_42
    s_mov_b32 s4, s44
    s_mov_b32 s5, s45
    s_add_u32 m0, s33, 0x0
    s_add_u32 s30, s31, 0x0
    buffer_load_dwordx4 v152, s[4:7], s30 offen lds
    s_add_u32 m0, s33, 0x400
    s_add_u32 s30, s31, 0x2800
    buffer_load_dwordx4 v153, s[4:7], s30 offen lds
    s_add_u32 m0, s33, 0x800
    s_add_u32 s30, s31, 0x5000
    buffer_load_dwordx4 v152, s[4:7], s30 offen lds
    s_add_u32 m0, s33, 0xc00
    s_add_u32 s30, s31, 0x7800
    buffer_load_dwordx4 v153, s[4:7], s30 offen lds
    s_add_u32 m0, s33, 0x1000
    s_add_u32 s30, s31, 0xa000
    s_mov_b32 exec_hi, 0
    buffer_load_dwordx4 v152, s[4:7], s30 offen lds
    s_mov_b32 exec_hi, -1
    s_add_u32 s31, s31, 128
    s_cmp_ge_u32 s31, 1280
    s_cselect_b32 s31, 0, s31
LA_nx_42:
    v_mfma_f32_16x16x32_bf16 v[180:183], v[72:75], v[52:55], v[180:183]
    v_mfma_f32_16x16x32_bf16 v[184:187], v[76:79], v[52:55], v[184:187]
    v_mfma_f32_16x16x32_bf16 v[188:191], v[80:83], v[52:55], v[188:191]
    v_mfma_f32_16x16x32_bf16 v[192:195], v[72:75], v[56:59], v[192:195]
    v_mfma_f32_16x16x32_bf16 v[196:199], v[76:79], v[56:59], v[196:199]
    v_mfma_f32_16x16x32_bf16 v[200:203], v[80:83], v[56:59], v[200:203]
    v_mfma_f32_16x16x32_bf16 v[204:207], v[72:75], v[60:63], v[204:207]
    v_mfma_f32_16x16x32_bf16 v[208:211], v[76:79], v[60:63], v[208:211]
    v_mfma_f32_16x16x32_bf16 v[212:215], v[80:83], v[60:63], v[212:215]
    v_mfma_f32_16x16x32_bf16 v[216:219], v[72:75], v[64:67], v[216:219]
    v_mfma_f32_16x16x32_bf16 v[220:223], v[76:79], v[64:67], v[220:223]
    v_mfma_f32_16x16x32_bf16 v[224:227], v[80:83], v[64:67], v[224:227]
    s_cmp_eq_u32 s59, 0
    s_cbranch_scc0 LA_nx_43
    s_add_u32 m0, s33, 0x10800
    s_add_u32 s30, s31, 0x0
    buffer_load_dwordx4 v152, s[4:7], s30 offen lds
    s_add_u32 m0, s33, 0x10c00
    s_add_u32 s30, s31, 0x2800
    buffer_load_dwordx4 v153, s[4:7], s30 offen lds
    s_add_u32 m0, s33, 0x11000
    s_add_u32 s30, s31, 0x5000
    buffer_load_dwordx4 v152, s[4:7], s30 offen lds
    s_add_u32 m0, s33, 0x11400
    s_add_u32 s30, s31, 0x7800
    buffer_load_dwordx4 v153, s[4:7], s30 offen lds
    s_add_u32 m0, s33, 0x11800
    s_add_u32 s30, s31, 0xa000
    s_mov_b32 exec_hi, 0
    buffer_load_dwordx4 v152, s[4:7], s30 offen lds
    s_mov_b32 exec_hi, -1
    s_add_u32 s31, s31, 128
    s_cmp_ge_u32 s31, 1280
    s_cselect_b32 s31, 0, s31
LA_nx_43:
    ds_read_b128 v[88:91], v10 offset:3840
    ds_read_b128 v[92:95], v10 offset:3856
    ds_read_b128 v[96:99], v10 offset:4608
    ds_read_b128 v[100:103], v10 offset:4624
    ds_read_b128 v[104:107], v10 offset:5376
    ds_read_b128 v[108:111], v10 offset:5392
    ds_read_b128 v[112:115], v10 offset:6144
    ds_read_b128 v[116:119], v10 offset:6160
    v_and_b32 v14, 15, v0
    v_lshlrev_b32 v14, 4, v14
    v_lshrrev_b32 v12, 5, v0
    v_lshl_add_u32 v14, v12, 8, v14
    v_bfe_u32 v12, v0, 4, 1
    v_lshl_add_u32 v14, v12, 3, v14
    v_add_u32 v12, s40, v14
    v_add_u32 v13, s41, v14
    v_add_u32 v14, s42, v14
    v_add_u32 v12, 0x15000, v12
    v_add_u32 v13, 0x15000, v13
    v_add_u32 v14, 0x15000, v14
    s_waitcnt lgkmcnt(0)
    v_add_f32 v88, v88, v92
    v_add_f32 v89, v89, v93
    v_add_f32 v90, v90, v94
    v_add_f32 v91, v91, v95
    v_add_f32 v96, v96, v100
    v_add_f32 v97, v97, v101
    v_add_f32 v98, v98, v102
    v_add_f32 v99, v99, v103
    v_add_f32 v104, v104, v108
    v_add_f32 v105, v105, v109
    v_add_f32 v106, v106, v110
    v_add_f32 v107, v107, v111
    v_add_f32 v112, v112, v116
    v_add_f32 v113, v113, v117
    v_add_f32 v114, v114, v118
    v_add_f32 v115, v115, v119
    v_add_f32 v88, v88, v89
    v_add_f32 v90, v90, v91
    v_add_f32 v96, v96, v97
    v_add_f32 v98, v98, v99
    v_add_f32 v104, v104, v105
    v_add_f32 v106, v106, v107
    v_add_f32 v112, v112, v113
    v_add_f32 v114, v114, v115
    v_add_f32 v88, v88, v90
    v_add_f32 v96, v96, v98
    v_add_f32 v104, v104, v106
    v_add_f32 v112, v112, v114
    v_rcp_f32 v88, v88
    v_rcp_f32 v96, v96
    v_rcp_f32 v104, v104
    v_rcp_f32 v112, v112
    s_nop 0
    v_pk_mul_f32 v[180:181], v[180:181], v[88:89] op_sel_hi:[1,0]
    v_pk_mul_f32 v[182:183], v[182:183], v[88:89] op_sel_hi:[1,0]
    v_cvt_pk_bf16_f32 v180, v180, v181
    v_cvt_pk_bf16_f32 v181, v182, v183
    ds_write_b64 v12, v[180:181] offset:5120
    v_pk_mul_f32 v[184:185], v[184:185], v[88:89] op_sel_hi:[1,0]
    v_pk_mul_f32 v[186:187], v[186:187], v[88:89] op_sel_hi:[1,0]
    v_cvt_pk_bf16_f32 v184, v184, v185
    v_cvt_pk_bf16_f32 v185, v186, v187
    ds_write_b64 v13, v[184:185] offset:5120
    v_pk_mul_f32 v[188:189], v[188:189], v[88:89] op_sel_hi:[1,0]
    v_pk_mul_f32 v[190:191], v[190:191], v[88:89] op_sel_hi:[1,0]
    v_cvt_pk_bf16_f32 v188, v188, v189
    v_cvt_pk_bf16_f32 v189, v190, v191
    ds_write_b64 v14, v[188:189] offset:5120
    v_pk_mul_f32 v[192:193], v[192:193], v[96:97] op_sel_hi:[1,0]
    v_pk_mul_f32 v[194:195], v[194:195], v[96:97] op_sel_hi:[1,0]
    v_cvt_pk_bf16_f32 v192, v192, v193
    v_cvt_pk_bf16_f32 v193, v194, v195
    ds_write_b64 v12, v[192:193] offset:6144
    v_pk_mul_f32 v[196:197], v[196:197], v[96:97] op_sel_hi:[1,0]
    v_pk_mul_f32 v[198:199], v[198:199], v[96:97] op_sel_hi:[1,0]
    v_cvt_pk_bf16_f32 v196, v196, v197
    v_cvt_pk_bf16_f32 v197, v198, v199
    ds_write_b64 v13, v[196:197] offset:6144
    v_pk_mul_f32 v[200:201], v[200:201], v[96:97] op_sel_hi:[1,0]
    v_pk_mul_f32 v[202:203], v[202:203], v[96:97] op_sel_hi:[1,0]
    v_cvt_pk_bf16_f32 v200, v200, v201
    v_cvt_pk_bf16_f32 v201, v202, v203
    ds_write_b64 v14, v[200:201] offset:6144
    v_pk_mul_f32 v[204:205], v[204:205], v[104:105] op_sel_hi:[1,0]
    v_pk_mul_f32 v[206:207], v[206:207], v[104:105] op_sel_hi:[1,0]
    v_cvt_pk_bf16_f32 v204, v204, v205
    v_cvt_pk_bf16_f32 v205, v206, v207
    ds_write_b64 v12, v[204:205] offset:7168
    v_pk_mul_f32 v[208:209], v[208:209], v[104:105] op_sel_hi:[1,0]
    v_pk_mul_f32 v[210:211], v[210:211], v[104:105] op_sel_hi:[1,0]
    v_cvt_pk_bf16_f32 v208, v208, v209
    v_cvt_pk_bf16_f32 v209, v210, v211
    ds_write_b64 v13, v[208:209] offset:7168
    v_pk_mul_f32 v[212:213], v[212:213], v[104:105] op_sel_hi:[1,0]
    v_pk_mul_f32 v[214:215], v[214:215], v[104:105] op_sel_hi:[1,0]
    v_cvt_pk_bf16_f32 v212, v212, v213
    v_cvt_pk_bf16_f32 v213, v214, v215
    ds_write_b64 v14, v[212:213] offset:7168
    v_pk_mul_f32 v[216:217], v[216:217], v[112:113] op_sel_hi:[1,0]
    v_pk_mul_f32 v[218:219], v[218:219], v[112:113] op_sel_hi:[1,0]
    v_cvt_pk_bf16_f32 v216, v216, v217
    v_cvt_pk_bf16_f32 v217, v218, v219
    ds_write_b64 v12, v[216:217] offset:8192
    v_pk_mul_f32 v[220:221], v[220:221], v[112:113] op_sel_hi:[1,0]
    v_pk_mul_f32 v[222:223], v[222:223], v[112:113] op_sel_hi:[1,0]
    v_cvt_pk_bf16_f32 v220, v220, v221
    v_cvt_pk_bf16_f32 v221, v222, v223
    ds_write_b64 v13, v[220:221] offset:8192
    v_pk_mul_f32 v[224:225], v[224:225], v[112:113] op_sel_hi:[1,0]
    v_pk_mul_f32 v[226:227], v[226:227], v[112:113] op_sel_hi:[1,0]
    v_cvt_pk_bf16_f32 v224, v224, v225
    v_cvt_pk_bf16_f32 v225, v226, v227
    ds_write_b64 v14, v[224:225] offset:8192
    s_mul_i32 s30, s24, 7168
    v_add_u32 v11, s30, v1
    v_add_u32 v10, 0x15000, v11
    s_waitcnt lgkmcnt(0)
    s_barrier
    ds_read_b128 v[160:163], v10 offset:0
    ds_read_b128 v[164:167], v10 offset:1024
    ds_read_b128 v[168:171], v10 offset:2048
    ds_read_b128 v[172:175], v10 offset:3072
    ds_read_b128 v[176:179], v10 offset:4096
    ds_read_b128 v[180:183], v10 offset:5120
    ds_read_b128 v[184:187], v10 offset:6144
    s_waitcnt lgkmcnt(6)
    s_mov_b32 s30, 0
    buffer_store_dwordx4 v[160:163], v11, s[20:23], s30 offen sc0 sc1
    s_waitcnt lgkmcnt(5)
    s_mov_b32 s30, 1024
    buffer_store_dwordx4 v[164:167], v11, s[20:23], s30 offen sc0 sc1
    s_waitcnt lgkmcnt(4)
    s_mov_b32 s30, 2048
    buffer_store_dwordx4 v[168:171], v11, s[20:23], s30 offen sc0 sc1
    s_waitcnt lgkmcnt(3)
    s_mov_b32 s30, 3072
    buffer_store_dwordx4 v[172:175], v11, s[20:23], s30 offen sc0 sc1
    s_waitcnt lgkmcnt(2)
    s_mov_b32 s30, 4096
    buffer_store_dwordx4 v[176:179], v11, s[20:23], s30 offen sc0 sc1
    s_waitcnt lgkmcnt(1)
    s_mov_b32 s30, 5120
    buffer_store_dwordx4 v[180:183], v11, s[20:23], s30 offen sc0 sc1
    s_waitcnt lgkmcnt(0)
    s_mov_b32 s30, 6144
    buffer_store_dwordx4 v[184:187], v11, s[20:23], s30 offen sc0 sc1
LA_st_44:
    s_cmp_eq_u32 s59, 0
    s_cbranch_scc0 LA_end
    s_mov_b32 s59, 1
    s_mov_b32 s35, 0
    s_add_u32 s12, s12, 25165824
    s_addc_u32 s13, s13, 0
    s_add_u32 s16, s16, 25165824
    s_addc_u32 s17, s17, 0
    s_add_u32 s20, s20, 7077888
    s_addc_u32 s21, s21, 0
    v_lshrrev_b32 v4, 4, v0
    v_and_b32 v5, 15, v0
    v_lshrrev_b32 v6, 4, v0
    v_bfe_u32 v7, v0, 2, 2
    v_lshl_add_u32 v6, v6, 3, v7
    v_and_b32 v7, 3, v0
    v_lshlrev_b32 v7, 3, v7
    v_lshl_add_u32 v6, v6, 7, v7
    v_bfe_u32 v7, v0, 3, 2
    v_xor_b32 v140, s96, v7
    v_lshl_add_u32 v140, v140, 5, v6
    s_add_u32 s30, s99, 0x4800
    v_add_u32 v140, s30, v140
    v_xor_b32 v141, s97, v7
    v_lshl_add_u32 v141, v141, 5, v6
    s_add_u32 s30, s100, 0x4800
    v_add_u32 v141, s30, v141
    v_xor_b32 v142, s98, v7
    v_lshl_add_u32 v142, v142, 5, v6
    s_add_u32 s30, s101, 0x4800
    v_add_u32 v142, s30, v142
    v_add_u32 v143, 0x15000, v140
    v_add_u32 v144, 0x15000, v141
    v_add_u32 v145, 0x15000, v142
    v_lshrrev_b32 v6, 1, v5
    v_xor_b32 v6, v6, v4
    v_lshlrev_b32 v6, 4, v6
    v_lshl_add_u32 v146, v5, 7, v6
    v_xor_b32 v147, 64, v146
    v_add_u32 v148, 0x10800, v146
    v_add_u32 v149, 0x10800, v147
    v_add_u32 v14, s37, v146
    v_add_u32 v15, s37, v147
    v_bfe_u32 v5, v0, 5, 1
    v_bfe_u32 v6, v0, 3, 2
    v_lshl_add_u32 v5, v5, 3, v6
    v_mul_u32_u24 v5, 0x180, v5
    s_mul_i32 s30, s24, 24576
    v_add_u32 v5, s30, v5
    v_and_b32 v7, 7, v0
    v_xor_b32 v6, v7, v4
    v_lshlrev_b32 v6, 4, v6
    v_add_u32 v12, v5, v6
    v_xor_b32 v6, 64, v6
    v_add_u32 v13, v5, v6
    v_add_u32 v13, 0x1800, v13
    v_and_b32 v157, 15, v0
    v_lshlrev_b32 v157, 4, v157
    v_lshrrev_b32 v155, 5, v0
    v_lshl_add_u32 v157, v155, 8, v157
    v_bfe_u32 v155, v0, 4, 1
    v_lshl_add_u32 v157, v155, 3, v157
    v_add_u32 v155, s40, v157
    v_add_u32 v156, s41, v157
    v_add_u32 v157, s42, v157
    s_waitcnt vmcnt(12) lgkmcnt(0)
    s_branch LA_p1_re1
LA_end:
    s_endpgm
.globl oproj_kernel
.p2align 8
.type oproj_kernel,@function
oproj_kernel:
    s_cmp_ge_u32 s2, 256
    s_cbranch_scc1 LB_end
    s_and_b32 s27, s2, 7
    s_lshr_b32 s28, s2, 3
    s_lshr_b32 s36, s27, 2
    s_and_b32 s37, s27, 3
    s_and_b32 s39, s28, 3
    s_lshr_b32 s38, s28, 2
    s_lshl_b32 s44, s39, 1
    s_add_u32 s44, s44, s38
    s_and_b32 s44, s44, 7
    s_mul_i32 s44, s44, 3
    s_mov_b32 s44, 0
    s_mul_i32 s29, s36, 40
    s_add_u32 s28, s0, s29
    s_addc_u32 s29, s1, 0
    s_load_dwordx2 s[40:41], s[28:29], 32
    s_load_dwordx2 s[42:43], s[0:1], 96
    s_load_dwordx4 s[48:51], s[0:1], 80
    v_lshrrev_b32 v3, 6, v0
    v_and_b32 v0, 63, v0
    v_readfirstlane_b32 s24, v3
    v_lshlrev_b32 v1, 4, v0
    v_lshrrev_b32 v4, 4, v0
    v_and_b32 v5, 15, v0
    s_and_b32 s25, s24, 3
    s_lshr_b32 s26, s24, 2
    s_mov_b32 s30, 0x74208630
    s_lshl_b32 s27, s24, 2
    s_lshr_b32 s45, s30, s27
    s_and_b32 s45, s45, 15
    v_mov_b32 v8, 0
    v_mov_b32 v9, 0
    v_mov_b32 v10, 0
    v_mov_b32 v11, 0
    v_mov_b32 v12, 0
    s_cmp_eq_u32 s26, 0
    s_cbranch_scc0 LB_nw
    s_mul_i32 s30, s25, 20
    s_add_u32 s30, s30, 0
    v_add_u32 v5, s30, v4
    v_mul_u32_u24 v6, 0xcd, v5
    v_lshrrev_b32 v6, 10, v6
    v_mul_u32_u24 v7, 5, v6
    v_sub_u32 v5, v5, v7
    v_and_b32 v7, 2, v6
    v_xor_b32 v7, v7, v0
    v_and_b32 v7, 3, v7
    v_lshlrev_b32 v7, 4, v7
    v_lshl_add_u32 v5, v5, 6, v7
    v_bfe_u32 v7, v0, 2, 2
    v_lshl_add_u32 v6, v6, 2, v7
    v_mul_u32_u24 v8, 0x500, v6
    v_add_u32 v8, v8, v5
    s_mul_i32 s30, s25, 20
    s_add_u32 s30, s30, 4
    v_add_u32 v5, s30, v4
    v_mul_u32_u24 v6, 0xcd, v5
    v_lshrrev_b32 v6, 10, v6
    v_mul_u32_u24 v7, 5, v6
    v_sub_u32 v5, v5, v7
    v_and_b32 v7, 2, v6
    v_xor_b32 v7, v7, v0
    v_and_b32 v7, 3, v7
    v_lshlrev_b32 v7, 4, v7
    v_lshl_add_u32 v5, v5, 6, v7
    v_bfe_u32 v7, v0, 2, 2
    v_lshl_add_u32 v6, v6, 2, v7
    v_mul_u32_u24 v9, 0x500, v6
    v_add_u32 v9, v9, v5
    s_mul_i32 s30, s25, 20
    s_add_u32 s30, s30, 8
    v_add_u32 v5, s30, v4
    v_mul_u32_u24 v6, 0xcd, v5
    v_lshrrev_b32 v6, 10, v6
    v_mul_u32_u24 v7, 5, v6
    v_sub_u32 v5, v5, v7
    v_and_b32 v7, 2, v6
    v_xor_b32 v7, v7, v0
    v_and_b32 v7, 3, v7
    v_lshlrev_b32 v7, 4, v7
    v_lshl_add_u32 v5, v5, 6, v7
    v_bfe_u32 v7, v0, 2, 2
    v_lshl_add_u32 v6, v6, 2, v7
    v_mul_u32_u24 v10, 0x500, v6
    v_add_u32 v10, v10, v5
    s_mul_i32 s30, s25, 20
    s_add_u32 s30, s30, 12
    v_add_u32 v5, s30, v4
    v_mul_u32_u24 v6, 0xcd, v5
    v_lshrrev_b32 v6, 10, v6
    v_mul_u32_u24 v7, 5, v6
    v_sub_u32 v5, v5, v7
    v_and_b32 v7, 2, v6
    v_xor_b32 v7, v7, v0
    v_and_b32 v7, 3, v7
    v_lshlrev_b32 v7, 4, v7
    v_lshl_add_u32 v5, v5, 6, v7
    v_bfe_u32 v7, v0, 2, 2
    v_lshl_add_u32 v6, v6, 2, v7
    v_mul_u32_u24 v11, 0x500, v6
    v_add_u32 v11, v11, v5
    s_mul_i32 s30, s25, 20
    s_add_u32 s30, s30, 16
    v_add_u32 v5, s30, v4
    v_mul_u32_u24 v6, 0xcd, v5
    v_lshrrev_b32 v6, 10, v6
    v_mul_u32_u24 v7, 5, v6
    v_sub_u32 v5, v5, v7
    v_and_b32 v7, 2, v6
    v_xor_b32 v7, v7, v0
    v_and_b32 v7, 3, v7
    v_lshlrev_b32 v7, 4, v7
    v_lshl_add_u32 v5, v5, 6, v7
    v_bfe_u32 v7, v0, 2, 2
    v_lshl_add_u32 v6, v6, 2, v7
    v_mul_u32_u24 v12, 0x500, v6
    v_add_u32 v12, v12, v5
LB_nw:
    s_mul_i32 s34, s25, 5120
    s_mul_i32 s33, s25, 4608
    v_add_u32 v13, s33, v1
    s_waitcnt lgkmcnt(0)
    s_lshl_b32 s30, s36, 3
    s_add_u32 s30, s30, s38
    s_lshl_b32 s27, s30, 2
    s_add_u32 s28, s27, s37
    s_mul_i32 s28, s28, 442368
    s_add_u32 s4, s42, s28
    s_addc_u32 s5, s43, 0
    s_mov_b32 s6, 442368
    s_mov_b32 s7, 0x20000
    s_add_u32 s46, s27, s39
    s_mul_i32 s27, s46, 262144
    s_add_u32 s27, s27, 0x2000000
    s_add_u32 s12, s42, s27
    s_addc_u32 s13, s43, 0
    s_mov_b32 s14, 262144
    s_mov_b32 s15, 0x20000
    s_add_u32 s27, s37, 1
    s_and_b32 s27, s27, 3
    s_mul_i32 s52, s27, 65536
    s_add_u32 s27, s37, 2
    s_and_b32 s27, s27, 3
    s_mul_i32 s53, s27, 65536
    s_add_u32 s27, s37, 3
    s_and_b32 s27, s27, 3
    s_mul_i32 s54, s27, 65536
    s_mul_i32 s27, s38, 368640
    s_mul_i32 s28, s36, 1280
    s_add_u32 s27, s27, s28
    s_mul_i32 s28, s39, 320
    s_add_u32 s27, s27, s28
    s_add_u32 s16, s48, s27
    s_addc_u32 s17, s49, 0
    s_sub_u32 s18, 2949120, s27
    s_mov_b32 s19, 0x20000
    s_add_u32 s20, s42, 0x3f00000
    s_addc_u32 s21, s43, 0
    s_mov_b32 s22, 8192
    s_mov_b32 s23, 0x20000
    s_mul_i32 s27, s37, 1966080
    s_mul_i32 s28, s39, 320
    s_add_u32 s27, s27, s28
    s_add_u32 s8, s40, s27
    s_addc_u32 s9, s41, 0
    s_sub_u32 s10, 1966080, s28
    s_mov_b32 s11, 0x20000
    s_mul_i32 s31, s44, 18432
    s_mul_i32 s32, s44, 81920
    s_lshr_b32 s30, s24, 1
    s_cmp_eq_u32 s30, 1
    s_cbranch_scc1 LB_v1
    s_cmp_eq_u32 s30, 2
    s_cbranch_scc1 LB_v2
    s_cmp_eq_u32 s30, 3
    s_cbranch_scc1 LB_v3
    s_add_u32 m0, s34, 0x4800
    s_nop 0
    buffer_load_dwordx4 v8, s[8:11], s32 offen lds
    s_add_u32 m0, s34, 0x4c00
    s_nop 0
    buffer_load_dwordx4 v9, s[8:11], s32 offen lds
    s_add_u32 m0, s34, 0x5000
    s_nop 0
    buffer_load_dwordx4 v10, s[8:11], s32 offen lds
    s_add_u32 m0, s34, 0x5400
    s_nop 0
    buffer_load_dwordx4 v11, s[8:11], s32 offen lds
    s_add_u32 m0, s34, 0x5800
    s_nop 0
    buffer_load_dwordx4 v12, s[8:11], s32 offen lds
    s_add_u32 s32, s32, 81920
    s_cmp_ge_u32 s32, 1966080
    s_cselect_b32 s32, 0, s32
    s_add_u32 m0, s34, 0xe000
    s_nop 0
    buffer_load_dwordx4 v8, s[8:11], s32 offen lds
    s_add_u32 m0, s34, 0xe400
    s_nop 0
    buffer_load_dwordx4 v9, s[8:11], s32 offen lds
    s_add_u32 m0, s34, 0xe800
    s_nop 0
    buffer_load_dwordx4 v10, s[8:11], s32 offen lds
    s_add_u32 m0, s34, 0xec00
    s_nop 0
    buffer_load_dwordx4 v11, s[8:11], s32 offen lds
    s_add_u32 m0, s34, 0xf000
    s_nop 0
    buffer_load_dwordx4 v12, s[8:11], s32 offen lds
    s_add_u32 s32, s32, 81920
    s_cmp_ge_u32 s32, 1966080
    s_cselect_b32 s32, 0, s32
    v_mul_u32_u24 v6, 0xa00, v4
    v_bfe_u32 v7, v0, 2, 2
    v_lshl_add_u32 v6, v7, 6, v6
    v_and_b32 v7, 3, v0
    v_lshl_add_u32 v6, v7, 3, v6
    s_add_u32 s30, s45, 0
    v_xor_b32 v7, s30, v4
    v_and_b32 v7, 1, v7
    v_lshl_add_u32 v16, v7, 5, v6
    s_lshr_b32 s30, s30, 1
    s_lshl_b32 s30, s30, 8
    s_add_u32 s30, s30, 0x4800
    v_add_u32 v16, s30, v16
    s_add_u32 s30, s45, 1
    v_xor_b32 v7, s30, v4
    v_and_b32 v7, 1, v7
    v_lshl_add_u32 v17, v7, 5, v6
    s_lshr_b32 s30, s30, 1
    s_lshl_b32 s30, s30, 8
    s_add_u32 s30, s30, 0x4800
    v_add_u32 v17, s30, v17
    s_add_u32 s30, s45, 2
    v_xor_b32 v7, s30, v4
    v_and_b32 v7, 1, v7
    v_lshl_add_u32 v18, v7, 5, v6
    s_lshr_b32 s30, s30, 1
    s_lshl_b32 s30, s30, 8
    s_add_u32 s30, s30, 0x4800
    v_add_u32 v18, s30, v18
    v_mov_b32 v19, v1
    v_add_u32 v20, 0x9800, v16
    v_add_u32 v21, 0x9800, v17
    v_add_u32 v22, 0x9800, v18
    v_add_u32 v23, 0x9800, v19
    v_add_u32 v24, 0x13000, v16
    v_add_u32 v25, 0x13000, v17
    v_add_u32 v26, 0x13000, v18
    v_add_u32 v27, 0x13000, v19
    v_mov_b32 v28, 0
    v_mov_b32 v29, 0
    v_mov_b32 v30, 0
    v_mov_b32 v31, 0
    v_mov_b32 v32, 0
    v_mov_b32 v33, 0
    v_mov_b32 v34, 0
    v_mov_b32 v35, 0
    v_mov_b32 v36, 0
    v_mov_b32 v37, 0
    v_mov_b32 v38, 0
    v_mov_b32 v39, 0
    v_mov_b32 v40, 0
    v_mov_b32 v41, 0
    v_mov_b32 v42, 0
    v_mov_b32 v43, 0
    v_mov_b32 v44, 0
    v_mov_b32 v45, 0
    v_mov_b32 v46, 0
    v_mov_b32 v47, 0
    v_mov_b32 v48, 0
    v_mov_b32 v49, 0
    v_mov_b32 v50, 0
    v_mov_b32 v51, 0
    v_mov_b32 v52, 0
    v_mov_b32 v53, 0
    v_mov_b32 v54, 0
    v_mov_b32 v55, 0
    v_mov_b32 v56, 0
    v_mov_b32 v57, 0
    v_mov_b32 v58, 0
    v_mov_b32 v59, 0
    v_mov_b32 v60, 0
    v_mov_b32 v61, 0
    v_mov_b32 v62, 0
    v_mov_b32 v63, 0
    v_mov_b32 v64, 0
    v_mov_b32 v65, 0
    v_mov_b32 v66, 0
    v_mov_b32 v67, 0
    v_mov_b32 v68, 0
    v_mov_b32 v69, 0
    v_mov_b32 v70, 0
    v_mov_b32 v71, 0
    v_mov_b32 v72, 0
    v_mov_b32 v73, 0
    v_mov_b32 v74, 0
    v_mov_b32 v75, 0
    v_mov_b32 v76, 0
    v_mov_b32 v77, 0
    v_mov_b32 v78, 0
    v_mov_b32 v79, 0
    v_mov_b32 v80, 0
    v_mov_b32 v81, 0
    v_mov_b32 v82, 0
    v_mov_b32 v83, 0
    v_mov_b32 v84, 0
    v_mov_b32 v85, 0
    v_mov_b32 v86, 0
    v_mov_b32 v87, 0
    s_waitcnt vmcnt(5)
    s_barrier
    ds_read_b64_tr_b16 v[88:89], v16 offset:0
    ds_read_b64_tr_b16 v[90:91], v16 offset:1280
    ds_read_b64_tr_b16 v[92:93], v17 offset:0
    ds_read_b64_tr_b16 v[94:95], v17 offset:1280
    ds_read_b64_tr_b16 v[96:97], v18 offset:0
    ds_read_b64_tr_b16 v[98:99], v18 offset:1280
    ds_read_b128 v[112:115], v19 offset:0
    ds_read_b128 v[116:119], v19 offset:1024
    ds_read_b128 v[120:123], v19 offset:2048
    ds_read_b128 v[124:127], v19 offset:3072
    ds_read_b128 v[128:131], v19 offset:4096
    s_add_u32 m0, s34, 0x17800
    s_nop 0
    buffer_load_dwordx4 v8, s[8:11], s32 offen lds
    s_add_u32 m0, s34, 0x17c00
    s_nop 0
    buffer_load_dwordx4 v9, s[8:11], s32 offen lds
    s_add_u32 m0, s34, 0x18000
    s_nop 0
    buffer_load_dwordx4 v10, s[8:11], s32 offen lds
    s_mov_b32 s35, 0
LB_loop0:
    s_waitcnt lgkmcnt(0)
    v_mfma_f32_16x16x32_bf16 v[28:31], v[88:91], v[112:115], v[28:31]
    ds_read_b64_tr_b16 v[100:101], v16 offset:10240
    ds_read_b64_tr_b16 v[102:103], v16 offset:11520
    v_mfma_f32_16x16x32_bf16 v[32:35], v[92:95], v[112:115], v[32:35]
    ds_read_b64_tr_b16 v[104:105], v17 offset:10240
    ds_read_b64_tr_b16 v[106:107], v17 offset:11520
    v_mfma_f32_16x16x32_bf16 v[36:39], v[96:99], v[112:115], v[36:39]
    ds_read_b64_tr_b16 v[108:109], v18 offset:10240
    v_mfma_f32_16x16x32_bf16 v[40:43], v[88:91], v[116:119], v[40:43]
    ds_read_b64_tr_b16 v[110:111], v18 offset:11520
    v_mfma_f32_16x16x32_bf16 v[44:47], v[92:95], v[116:119], v[44:47]
    ds_read_b128 v[132:135], v19 offset:9216
    v_mfma_f32_16x16x32_bf16 v[48:51], v[96:99], v[116:119], v[48:51]
    ds_read_b128 v[136:139], v19 offset:10240
    v_mfma_f32_16x16x32_bf16 v[52:55], v[88:91], v[120:123], v[52:55]
    ds_read_b128 v[140:143], v19 offset:11264
    v_mfma_f32_16x16x32_bf16 v[56:59], v[92:95], v[120:123], v[56:59]
    ds_read_b128 v[144:147], v19 offset:12288
    v_mfma_f32_16x16x32_bf16 v[60:63], v[96:99], v[120:123], v[60:63]
    ds_read_b128 v[148:151], v19 offset:13312
    v_mfma_f32_16x16x32_bf16 v[64:67], v[88:91], v[124:127], v[64:67]
    s_add_u32 m0, s34, 0x18400
    s_nop 0
    buffer_load_dwordx4 v11, s[8:11], s32 offen lds
    v_mfma_f32_16x16x32_bf16 v[68:71], v[92:95], v[124:127], v[68:71]
    s_add_u32 m0, s34, 0x18800
    s_nop 0
    buffer_load_dwordx4 v12, s[8:11], s32 offen lds
    v_mfma_f32_16x16x32_bf16 v[72:75], v[96:99], v[124:127], v[72:75]
    s_add_u32 s32, s32, 81920
    s_cmp_ge_u32 s32, 1966080
    s_cselect_b32 s32, 0, s32
    v_mfma_f32_16x16x32_bf16 v[76:79], v[88:91], v[128:131], v[76:79]
    v_mfma_f32_16x16x32_bf16 v[80:83], v[92:95], v[128:131], v[80:83]
    v_mfma_f32_16x16x32_bf16 v[84:87], v[96:99], v[128:131], v[84:87]
    s_waitcnt vmcnt(5) lgkmcnt(0)
    s_barrier
    v_mfma_f32_16x16x32_bf16 v[28:31], v[100:103], v[132:135], v[28:31]
    ds_read_b64_tr_b16 v[88:89], v20 offset:0
    ds_read_b64_tr_b16 v[90:91], v20 offset:1280
    v_mfma_f32_16x16x32_bf16 v[32:35], v[104:107], v[132:135], v[32:35]
    ds_read_b64_tr_b16 v[92:93], v21 offset:0
    ds_read_b64_tr_b16 v[94:95], v21 offset:1280
    v_mfma_f32_16x16x32_bf16 v[36:39], v[108:111], v[132:135], v[36:39]
    ds_read_b64_tr_b16 v[96:97], v22 offset:0
    v_mfma_f32_16x16x32_bf16 v[40:43], v[100:103], v[136:139], v[40:43]
    ds_read_b64_tr_b16 v[98:99], v22 offset:1280
    v_mfma_f32_16x16x32_bf16 v[44:47], v[104:107], v[136:139], v[44:47]
    ds_read_b128 v[112:115], v23 offset:0
    v_mfma_f32_16x16x32_bf16 v[48:51], v[108:111], v[136:139], v[48:51]
    ds_read_b128 v[116:119], v23 offset:1024
    v_mfma_f32_16x16x32_bf16 v[52:55], v[100:103], v[140:143], v[52:55]
    ds_read_b128 v[120:123], v23 offset:2048
    v_mfma_f32_16x16x32_bf16 v[56:59], v[104:107], v[140:143], v[56:59]
    ds_read_b128 v[124:127], v23 offset:3072
    v_mfma_f32_16x16x32_bf16 v[60:63], v[108:111], v[140:143], v[60:63]
    ds_read_b128 v[128:131], v23 offset:4096
    v_mfma_f32_16x16x32_bf16 v[64:67], v[100:103], v[144:147], v[64:67]
    s_add_u32 m0, s34, 0x4800
    s_nop 0
    buffer_load_dwordx4 v8, s[8:11], s32 offen lds
    v_mfma_f32_16x16x32_bf16 v[68:71], v[104:107], v[144:147], v[68:71]
    s_add_u32 m0, s34, 0x4c00
    s_nop 0
    buffer_load_dwordx4 v9, s[8:11], s32 offen lds
    v_mfma_f32_16x16x32_bf16 v[72:75], v[108:111], v[144:147], v[72:75]
    s_add_u32 m0, s34, 0x5000
    s_nop 0
    buffer_load_dwordx4 v10, s[8:11], s32 offen lds
    v_mfma_f32_16x16x32_bf16 v[76:79], v[100:103], v[148:151], v[76:79]
    v_mfma_f32_16x16x32_bf16 v[80:83], v[104:107], v[148:151], v[80:83]
    v_mfma_f32_16x16x32_bf16 v[84:87], v[108:111], v[148:151], v[84:87]
    s_waitcnt lgkmcnt(0)
    v_mfma_f32_16x16x32_bf16 v[28:31], v[88:91], v[112:115], v[28:31]
    ds_read_b64_tr_b16 v[100:101], v20 offset:10240
    ds_read_b64_tr_b16 v[102:103], v20 offset:11520
    v_mfma_f32_16x16x32_bf16 v[32:35], v[92:95], v[112:115], v[32:35]
    ds_read_b64_tr_b16 v[104:105], v21 offset:10240
    ds_read_b64_tr_b16 v[106:107], v21 offset:11520
    v_mfma_f32_16x16x32_bf16 v[36:39], v[96:99], v[112:115], v[36:39]
    ds_read_b64_tr_b16 v[108:109], v22 offset:10240
    v_mfma_f32_16x16x32_bf16 v[40:43], v[88:91], v[116:119], v[40:43]
    ds_read_b64_tr_b16 v[110:111], v22 offset:11520
    v_mfma_f32_16x16x32_bf16 v[44:47], v[92:95], v[116:119], v[44:47]
    ds_read_b128 v[132:135], v23 offset:9216
    v_mfma_f32_16x16x32_bf16 v[48:51], v[96:99], v[116:119], v[48:51]
    ds_read_b128 v[136:139], v23 offset:10240
    v_mfma_f32_16x16x32_bf16 v[52:55], v[88:91], v[120:123], v[52:55]
    ds_read_b128 v[140:143], v23 offset:11264
    v_mfma_f32_16x16x32_bf16 v[56:59], v[92:95], v[120:123], v[56:59]
    ds_read_b128 v[144:147], v23 offset:12288
    v_mfma_f32_16x16x32_bf16 v[60:63], v[96:99], v[120:123], v[60:63]
    ds_read_b128 v[148:151], v23 offset:13312
    v_mfma_f32_16x16x32_bf16 v[64:67], v[88:91], v[124:127], v[64:67]
    s_add_u32 m0, s34, 0x5400
    s_nop 0
    buffer_load_dwordx4 v11, s[8:11], s32 offen lds
    v_mfma_f32_16x16x32_bf16 v[68:71], v[92:95], v[124:127], v[68:71]
    s_add_u32 m0, s34, 0x5800
    s_nop 0
    buffer_load_dwordx4 v12, s[8:11], s32 offen lds
    v_mfma_f32_16x16x32_bf16 v[72:75], v[96:99], v[124:127], v[72:75]
    s_add_u32 s32, s32, 81920
    s_cmp_ge_u32 s32, 1966080
    s_cselect_b32 s32, 0, s32
    v_mfma_f32_16x16x32_bf16 v[76:79], v[88:91], v[128:131], v[76:79]
    v_mfma_f32_16x16x32_bf16 v[80:83], v[92:95], v[128:131], v[80:83]
    v_mfma_f32_16x16x32_bf16 v[84:87], v[96:99], v[128:131], v[84:87]
    s_waitcnt vmcnt(5) lgkmcnt(0)
    s_barrier
    v_mfma_f32_16x16x32_bf16 v[28:31], v[100:103], v[132:135], v[28:31]
    ds_read_b64_tr_b16 v[88:89], v24 offset:0
    ds_read_b64_tr_b16 v[90:91], v24 offset:1280
    v_mfma_f32_16x16x32_bf16 v[32:35], v[104:107], v[132:135], v[32:35]
    ds_read_b64_tr_b16 v[92:93], v25 offset:0
    ds_read_b64_tr_b16 v[94:95], v25 offset:1280
    v_mfma_f32_16x16x32_bf16 v[36:39], v[108:111], v[132:135], v[36:39]
    ds_read_b64_tr_b16 v[96:97], v26 offset:0
    v_mfma_f32_16x16x32_bf16 v[40:43], v[100:103], v[136:139], v[40:43]
    ds_read_b64_tr_b16 v[98:99], v26 offset:1280
    v_mfma_f32_16x16x32_bf16 v[44:47], v[104:107], v[136:139], v[44:47]
    ds_read_b128 v[112:115], v27 offset:0
    v_mfma_f32_16x16x32_bf16 v[48:51], v[108:111], v[136:139], v[48:51]
    ds_read_b128 v[116:119], v27 offset:1024
    v_mfma_f32_16x16x32_bf16 v[52:55], v[100:103], v[140:143], v[52:55]
    ds_read_b128 v[120:123], v27 offset:2048
    v_mfma_f32_16x16x32_bf16 v[56:59], v[104:107], v[140:143], v[56:59]
    ds_read_b128 v[124:127], v27 offset:3072
    v_mfma_f32_16x16x32_bf16 v[60:63], v[108:111], v[140:143], v[60:63]
    ds_read_b128 v[128:131], v27 offset:4096
    v_mfma_f32_16x16x32_bf16 v[64:67], v[100:103], v[144:147], v[64:67]
    s_add_u32 m0, s34, 0xe000
    s_nop 0
    buffer_load_dwordx4 v8, s[8:11], s32 offen lds
    v_mfma_f32_16x16x32_bf16 v[68:71], v[104:107], v[144:147], v[68:71]
    s_add_u32 m0, s34, 0xe400
    s_nop 0
    buffer_load_dwordx4 v9, s[8:11], s32 offen lds
    v_mfma_f32_16x16x32_bf16 v[72:75], v[108:111], v[144:147], v[72:75]
    s_add_u32 m0, s34, 0xe800
    s_nop 0
    buffer_load_dwordx4 v10, s[8:11], s32 offen lds
    v_mfma_f32_16x16x32_bf16 v[76:79], v[100:103], v[148:151], v[76:79]
    v_mfma_f32_16x16x32_bf16 v[80:83], v[104:107], v[148:151], v[80:83]
    v_mfma_f32_16x16x32_bf16 v[84:87], v[108:111], v[148:151], v[84:87]
    s_waitcnt lgkmcnt(0)
    v_mfma_f32_16x16x32_bf16 v[28:31], v[88:91], v[112:115], v[28:31]
    ds_read_b64_tr_b16 v[100:101], v24 offset:10240
    ds_read_b64_tr_b16 v[102:103], v24 offset:11520
    v_mfma_f32_16x16x32_bf16 v[32:35], v[92:95], v[112:115], v[32:35]
    ds_read_b64_tr_b16 v[104:105], v25 offset:10240
    ds_read_b64_tr_b16 v[106:107], v25 offset:11520
    v_mfma_f32_16x16x32_bf16 v[36:39], v[96:99], v[112:115], v[36:39]
    ds_read_b64_tr_b16 v[108:109], v26 offset:10240
    v_mfma_f32_16x16x32_bf16 v[40:43], v[88:91], v[116:119], v[40:43]
    ds_read_b64_tr_b16 v[110:111], v26 offset:11520
    v_mfma_f32_16x16x32_bf16 v[44:47], v[92:95], v[116:119], v[44:47]
    ds_read_b128 v[132:135], v27 offset:9216
    v_mfma_f32_16x16x32_bf16 v[48:51], v[96:99], v[116:119], v[48:51]
    ds_read_b128 v[136:139], v27 offset:10240
    v_mfma_f32_16x16x32_bf16 v[52:55], v[88:91], v[120:123], v[52:55]
    ds_read_b128 v[140:143], v27 offset:11264
    v_mfma_f32_16x16x32_bf16 v[56:59], v[92:95], v[120:123], v[56:59]
    ds_read_b128 v[144:147], v27 offset:12288
    v_mfma_f32_16x16x32_bf16 v[60:63], v[96:99], v[120:123], v[60:63]
    ds_read_b128 v[148:151], v27 offset:13312
    v_mfma_f32_16x16x32_bf16 v[64:67], v[88:91], v[124:127], v[64:67]
    s_add_u32 m0, s34, 0xec00
    s_nop 0
    buffer_load_dwordx4 v11, s[8:11], s32 offen lds
    v_mfma_f32_16x16x32_bf16 v[68:71], v[92:95], v[124:127], v[68:71]
    s_add_u32 m0, s34, 0xf000
    s_nop 0
    buffer_load_dwordx4 v12, s[8:11], s32 offen lds
    v_mfma_f32_16x16x32_bf16 v[72:75], v[96:99], v[124:127], v[72:75]
    s_add_u32 s32, s32, 81920
    s_cmp_ge_u32 s32, 1966080
    s_cselect_b32 s32, 0, s32
    v_mfma_f32_16x16x32_bf16 v[76:79], v[88:91], v[128:131], v[76:79]
    v_mfma_f32_16x16x32_bf16 v[80:83], v[92:95], v[128:131], v[80:83]
    v_mfma_f32_16x16x32_bf16 v[84:87], v[96:99], v[128:131], v[84:87]
    s_waitcnt vmcnt(5) lgkmcnt(0)
    s_barrier
    v_mfma_f32_16x16x32_bf16 v[28:31], v[100:103], v[132:135], v[28:31]
    ds_read_b64_tr_b16 v[88:89], v16 offset:0
    ds_read_b64_tr_b16 v[90:91], v16 offset:1280
    v_mfma_f32_16x16x32_bf16 v[32:35], v[104:107], v[132:135], v[32:35]
    ds_read_b64_tr_b16 v[92:93], v17 offset:0
    ds_read_b64_tr_b16 v[94:95], v17 offset:1280
    v_mfma_f32_16x16x32_bf16 v[36:39], v[108:111], v[132:135], v[36:39]
    ds_read_b64_tr_b16 v[96:97], v18 offset:0
    v_mfma_f32_16x16x32_bf16 v[40:43], v[100:103], v[136:139], v[40:43]
    ds_read_b64_tr_b16 v[98:99], v18 offset:1280
    v_mfma_f32_16x16x32_bf16 v[44:47], v[104:107], v[136:139], v[44:47]
    ds_read_b128 v[112:115], v19 offset:0
    v_mfma_f32_16x16x32_bf16 v[48:51], v[108:111], v[136:139], v[48:51]
    ds_read_b128 v[116:119], v19 offset:1024
    v_mfma_f32_16x16x32_bf16 v[52:55], v[100:103], v[140:143], v[52:55]
    ds_read_b128 v[120:123], v19 offset:2048
    v_mfma_f32_16x16x32_bf16 v[56:59], v[104:107], v[140:143], v[56:59]
    ds_read_b128 v[124:127], v19 offset:3072
    v_mfma_f32_16x16x32_bf16 v[60:63], v[108:111], v[140:143], v[60:63]
    ds_read_b128 v[128:131], v19 offset:4096
    v_mfma_f32_16x16x32_bf16 v[64:67], v[100:103], v[144:147], v[64:67]
    s_add_u32 m0, s34, 0x17800
    s_nop 0
    buffer_load_dwordx4 v8, s[8:11], s32 offen lds
    v_mfma_f32_16x16x32_bf16 v[68:71], v[104:107], v[144:147], v[68:71]
    s_add_u32 m0, s34, 0x17c00
    s_nop 0
    buffer_load_dwordx4 v9, s[8:11], s32 offen lds
    v_mfma_f32_16x16x32_bf16 v[72:75], v[108:111], v[144:147], v[72:75]
    s_add_u32 m0, s34, 0x18000
    s_nop 0
    buffer_load_dwordx4 v10, s[8:11], s32 offen lds
    v_mfma_f32_16x16x32_bf16 v[76:79], v[100:103], v[148:151], v[76:79]
    v_mfma_f32_16x16x32_bf16 v[80:83], v[104:107], v[148:151], v[80:83]
    v_mfma_f32_16x16x32_bf16 v[84:87], v[108:111], v[148:151], v[84:87]
    s_add_u32 s35, s35, 1
    s_cmp_lt_u32 s35, 7
    s_cbranch_scc1 LB_loop0
    s_waitcnt lgkmcnt(0)
    v_mfma_f32_16x16x32_bf16 v[28:31], v[88:91], v[112:115], v[28:31]
    ds_read_b64_tr_b16 v[100:101], v16 offset:10240
    ds_read_b64_tr_b16 v[102:103], v16 offset:11520
    v_mfma_f32_16x16x32_bf16 v[32:35], v[92:95], v[112:115], v[32:35]
    ds_read_b64_tr_b16 v[104:105], v17 offset:10240
    ds_read_b64_tr_b16 v[106:107], v17 offset:11520
    v_mfma_f32_16x16x32_bf16 v[36:39], v[96:99], v[112:115], v[36:39]
    ds_read_b64_tr_b16 v[108:109], v18 offset:10240
    v_mfma_f32_16x16x32_bf16 v[40:43], v[88:91], v[116:119], v[40:43]
    ds_read_b64_tr_b16 v[110:111], v18 offset:11520
    v_mfma_f32_16x16x32_bf16 v[44:47], v[92:95], v[116:119], v[44:47]
    ds_read_b128 v[132:135], v19 offset:9216
    v_mfma_f32_16x16x32_bf16 v[48:51], v[96:99], v[116:119], v[48:51]
    ds_read_b128 v[136:139], v19 offset:10240
    v_mfma_f32_16x16x32_bf16 v[52:55], v[88:91], v[120:123], v[52:55]
    ds_read_b128 v[140:143], v19 offset:11264
    v_mfma_f32_16x16x32_bf16 v[56:59], v[92:95], v[120:123], v[56:59]
    ds_read_b128 v[144:147], v19 offset:12288
    v_mfma_f32_16x16x32_bf16 v[60:63], v[96:99], v[120:123], v[60:63]
    ds_read_b128 v[148:151], v19 offset:13312
    v_mfma_f32_16x16x32_bf16 v[64:67], v[88:91], v[124:127], v[64:67]
    s_add_u32 m0, s34, 0x18400
    s_nop 0
    buffer_load_dwordx4 v11, s[8:11], s32 offen lds
    v_mfma_f32_16x16x32_bf16 v[68:71], v[92:95], v[124:127], v[68:71]
    s_add_u32 m0, s34, 0x18800
    s_nop 0
    buffer_load_dwordx4 v12, s[8:11], s32 offen lds
    v_mfma_f32_16x16x32_bf16 v[72:75], v[96:99], v[124:127], v[72:75]
    s_add_u32 s32, s32, 81920
    s_cmp_ge_u32 s32, 1966080
    s_cselect_b32 s32, 0, s32
    v_mfma_f32_16x16x32_bf16 v[76:79], v[88:91], v[128:131], v[76:79]
    v_mfma_f32_16x16x32_bf16 v[80:83], v[92:95], v[128:131], v[80:83]
    v_mfma_f32_16x16x32_bf16 v[84:87], v[96:99], v[128:131], v[84:87]
    s_waitcnt vmcnt(5) lgkmcnt(0)
    s_barrier
    v_mfma_f32_16x16x32_bf16 v[28:31], v[100:103], v[132:135], v[28:31]
    ds_read_b64_tr_b16 v[88:89], v20 offset:0
    ds_read_b64_tr_b16 v[90:91], v20 offset:1280
    v_mfma_f32_16x16x32_bf16 v[32:35], v[104:107], v[132:135], v[32:35]
    ds_read_b64_tr_b16 v[92:93], v21 offset:0
    ds_read_b64_tr_b16 v[94:95], v21 offset:1280
    v_mfma_f32_16x16x32_bf16 v[36:39], v[108:111], v[132:135], v[36:39]
    ds_read_b64_tr_b16 v[96:97], v22 offset:0
    v_mfma_f32_16x16x32_bf16 v[40:43], v[100:103], v[136:139], v[40:43]
    ds_read_b64_tr_b16 v[98:99], v22 offset:1280
    v_mfma_f32_16x16x32_bf16 v[44:47], v[104:107], v[136:139], v[44:47]
    ds_read_b128 v[112:115], v23 offset:0
    v_mfma_f32_16x16x32_bf16 v[48:51], v[108:111], v[136:139], v[48:51]
    ds_read_b128 v[116:119], v23 offset:1024
    v_mfma_f32_16x16x32_bf16 v[52:55], v[100:103], v[140:143], v[52:55]
    ds_read_b128 v[120:123], v23 offset:2048
    v_mfma_f32_16x16x32_bf16 v[56:59], v[104:107], v[140:143], v[56:59]
    ds_read_b128 v[124:127], v23 offset:3072
    v_mfma_f32_16x16x32_bf16 v[60:63], v[108:111], v[140:143], v[60:63]
    ds_read_b128 v[128:131], v23 offset:4096
    v_mfma_f32_16x16x32_bf16 v[64:67], v[100:103], v[144:147], v[64:67]
    v_mfma_f32_16x16x32_bf16 v[68:71], v[104:107], v[144:147], v[68:71]
    v_mfma_f32_16x16x32_bf16 v[72:75], v[108:111], v[144:147], v[72:75]
    v_mfma_f32_16x16x32_bf16 v[76:79], v[100:103], v[148:151], v[76:79]
    v_mfma_f32_16x16x32_bf16 v[80:83], v[104:107], v[148:151], v[80:83]
    v_mfma_f32_16x16x32_bf16 v[84:87], v[108:111], v[148:151], v[84:87]
    s_waitcnt lgkmcnt(0)
    v_mfma_f32_16x16x32_bf16 v[28:31], v[88:91], v[112:115], v[28:31]
    ds_read_b64_tr_b16 v[100:101], v20 offset:10240
    ds_read_b64_tr_b16 v[102:103], v20 offset:11520
    v_mfma_f32_16x16x32_bf16 v[32:35], v[92:95], v[112:115], v[32:35]
    ds_read_b64_tr_b16 v[104:105], v21 offset:10240
    ds_read_b64_tr_b16 v[106:107], v21 offset:11520
    v_mfma_f32_16x16x32_bf16 v[36:39], v[96:99], v[112:115], v[36:39]
    ds_read_b64_tr_b16 v[108:109], v22 offset:10240
    v_mfma_f32_16x16x32_bf16 v[40:43], v[88:91], v[116:119], v[40:43]
    ds_read_b64_tr_b16 v[110:111], v22 offset:11520
    v_mfma_f32_16x16x32_bf16 v[44:47], v[92:95], v[116:119], v[44:47]
    ds_read_b128 v[132:135], v23 offset:9216
    v_mfma_f32_16x16x32_bf16 v[48:51], v[96:99], v[116:119], v[48:51]
    ds_read_b128 v[136:139], v23 offset:10240
    v_mfma_f32_16x16x32_bf16 v[52:55], v[88:91], v[120:123], v[52:55]
    ds_read_b128 v[140:143], v23 offset:11264
    v_mfma_f32_16x16x32_bf16 v[56:59], v[92:95], v[120:123], v[56:59]
    ds_read_b128 v[144:147], v23 offset:12288
    v_mfma_f32_16x16x32_bf16 v[60:63], v[96:99], v[120:123], v[60:63]
    ds_read_b128 v[148:151], v23 offset:13312
    v_mfma_f32_16x16x32_bf16 v[64:67], v[88:91], v[124:127], v[64:67]
    v_mfma_f32_16x16x32_bf16 v[68:71], v[92:95], v[124:127], v[68:71]
    v_mfma_f32_16x16x32_bf16 v[72:75], v[96:99], v[124:127], v[72:75]
    v_mfma_f32_16x16x32_bf16 v[76:79], v[88:91], v[128:131], v[76:79]
    v_mfma_f32_16x16x32_bf16 v[80:83], v[92:95], v[128:131], v[80:83]
    v_mfma_f32_16x16x32_bf16 v[84:87], v[96:99], v[128:131], v[84:87]
    s_waitcnt vmcnt(0) lgkmcnt(0)
    s_barrier
    v_mfma_f32_16x16x32_bf16 v[28:31], v[100:103], v[132:135], v[28:31]
    ds_read_b64_tr_b16 v[88:89], v24 offset:0
    ds_read_b64_tr_b16 v[90:91], v24 offset:1280
    v_mfma_f32_16x16x32_bf16 v[32:35], v[104:107], v[132:135], v[32:35]
    ds_read_b64_tr_b16 v[92:93], v25 offset:0
    ds_read_b64_tr_b16 v[94:95], v25 offset:1280
    v_mfma_f32_16x16x32_bf16 v[36:39], v[108:111], v[132:135], v[36:39]
    ds_read_b64_tr_b16 v[96:97], v26 offset:0
    v_mfma_f32_16x16x32_bf16 v[40:43], v[100:103], v[136:139], v[40:43]
    ds_read_b64_tr_b16 v[98:99], v26 offset:1280
    v_mfma_f32_16x16x32_bf16 v[44:47], v[104:107], v[136:139], v[44:47]
    ds_read_b128 v[112:115], v27 offset:0
    v_mfma_f32_16x16x32_bf16 v[48:51], v[108:111], v[136:139], v[48:51]
    ds_read_b128 v[116:119], v27 offset:1024
    v_mfma_f32_16x16x32_bf16 v[52:55], v[100:103], v[140:143], v[52:55]
    ds_read_b128 v[120:123], v27 offset:2048
    v_mfma_f32_16x16x32_bf16 v[56:59], v[104:107], v[140:143], v[56:59]
    ds_read_b128 v[124:127], v27 offset:3072
    v_mfma_f32_16x16x32_bf16 v[60:63], v[108:111], v[140:143], v[60:63]
    ds_read_b128 v[128:131], v27 offset:4096
    v_mfma_f32_16x16x32_bf16 v[64:67], v[100:103], v[144:147], v[64:67]
    v_mfma_f32_16x16x32_bf16 v[68:71], v[104:107], v[144:147], v[68:71]
    v_mfma_f32_16x16x32_bf16 v[72:75], v[108:111], v[144:147], v[72:75]
    v_mfma_f32_16x16x32_bf16 v[76:79], v[100:103], v[148:151], v[76:79]
    v_mfma_f32_16x16x32_bf16 v[80:83], v[104:107], v[148:151], v[80:83]
    v_mfma_f32_16x16x32_bf16 v[84:87], v[108:111], v[148:151], v[84:87]
    s_waitcnt lgkmcnt(0)
    v_mfma_f32_16x16x32_bf16 v[28:31], v[88:91], v[112:115], v[28:31]
    ds_read_b64_tr_b16 v[100:101], v24 offset:10240
    ds_read_b64_tr_b16 v[102:103], v24 offset:11520
    v_mfma_f32_16x16x32_bf16 v[32:35], v[92:95], v[112:115], v[32:35]
    ds_read_b64_tr_b16 v[104:105], v25 offset:10240
    ds_read_b64_tr_b16 v[106:107], v25 offset:11520
    v_mfma_f32_16x16x32_bf16 v[36:39], v[96:99], v[112:115], v[36:39]
    ds_read_b64_tr_b16 v[108:109], v26 offset:10240
    v_mfma_f32_16x16x32_bf16 v[40:43], v[88:91], v[116:119], v[40:43]
    ds_read_b64_tr_b16 v[110:111], v26 offset:11520
    v_mfma_f32_16x16x32_bf16 v[44:47], v[92:95], v[116:119], v[44:47]
    ds_read_b128 v[132:135], v27 offset:9216
    v_mfma_f32_16x16x32_bf16 v[48:51], v[96:99], v[116:119], v[48:51]
    ds_read_b128 v[136:139], v27 offset:10240
    v_mfma_f32_16x16x32_bf16 v[52:55], v[88:91], v[120:123], v[52:55]
    ds_read_b128 v[140:143], v27 offset:11264
    v_mfma_f32_16x16x32_bf16 v[56:59], v[92:95], v[120:123], v[56:59]
    ds_read_b128 v[144:147], v27 offset:12288
    v_mfma_f32_16x16x32_bf16 v[60:63], v[96:99], v[120:123], v[60:63]
    ds_read_b128 v[148:151], v27 offset:13312
    v_mfma_f32_16x16x32_bf16 v[64:67], v[88:91], v[124:127], v[64:67]
    v_mfma_f32_16x16x32_bf16 v[68:71], v[92:95], v[124:127], v[68:71]
    v_mfma_f32_16x16x32_bf16 v[72:75], v[96:99], v[124:127], v[72:75]
    v_mfma_f32_16x16x32_bf16 v[76:79], v[88:91], v[128:131], v[76:79]
    v_mfma_f32_16x16x32_bf16 v[80:83], v[92:95], v[128:131], v[80:83]
    v_mfma_f32_16x16x32_bf16 v[84:87], v[96:99], v[128:131], v[84:87]
    s_waitcnt vmcnt(0) lgkmcnt(0)
    s_barrier
    v_mfma_f32_16x16x32_bf16 v[28:31], v[100:103], v[132:135], v[28:31]
    v_mfma_f32_16x16x32_bf16 v[32:35], v[104:107], v[132:135], v[32:35]
    v_mfma_f32_16x16x32_bf16 v[36:39], v[108:111], v[132:135], v[36:39]
    v_mfma_f32_16x16x32_bf16 v[40:43], v[100:103], v[136:139], v[40:43]
    v_mfma_f32_16x16x32_bf16 v[44:47], v[104:107], v[136:139], v[44:47]
    v_mfma_f32_16x16x32_bf16 v[48:51], v[108:111], v[136:139], v[48:51]
    v_mfma_f32_16x16x32_bf16 v[52:55], v[100:103], v[140:143], v[52:55]
    v_mfma_f32_16x16x32_bf16 v[56:59], v[104:107], v[140:143], v[56:59]
    v_mfma_f32_16x16x32_bf16 v[60:63], v[108:111], v[140:143], v[60:63]
    v_mfma_f32_16x16x32_bf16 v[64:67], v[100:103], v[144:147], v[64:67]
    v_mfma_f32_16x16x32_bf16 v[68:71], v[104:107], v[144:147], v[68:71]
    v_mfma_f32_16x16x32_bf16 v[72:75], v[108:111], v[144:147], v[72:75]
    v_mfma_f32_16x16x32_bf16 v[76:79], v[100:103], v[148:151], v[76:79]
    v_mfma_f32_16x16x32_bf16 v[80:83], v[104:107], v[148:151], v[80:83]
    v_mfma_f32_16x16x32_bf16 v[84:87], v[108:111], v[148:151], v[84:87]
    s_nop 7
    s_lshl_b32 s27, s24, 13
    v_add_u32 v4, s27, v1
    s_mul_i32 s28, s37, 65536
    s_cmp_eq_u32 s37, 0
    s_cbranch_scc1 LB_ps_45
    s_add_u32 s30, s28, 0
    v_cvt_pk_bf16_f32 v88, v28, v29
    v_cvt_pk_bf16_f32 v89, v30, v31
    v_cvt_pk_bf16_f32 v90, v44, v45
    v_cvt_pk_bf16_f32 v91, v46, v47
    buffer_store_dwordx4 v[88:91], v4, s[12:15], s30 offen offset:0 sc1
    v_cvt_pk_bf16_f32 v92, v60, v61
    v_cvt_pk_bf16_f32 v93, v62, v63
    v_cvt_pk_bf16_f32 v94, v76, v77
    v_cvt_pk_bf16_f32 v95, v78, v79
    buffer_store_dwordx4 v[92:95], v4, s[12:15], s30 offen offset:1024 sc1
LB_ps_45:
    s_cmp_eq_u32 s37, 1
    s_cbranch_scc1 LB_ps_46
    s_add_u32 s30, s28, 2048
    v_cvt_pk_bf16_f32 v96, v32, v33
    v_cvt_pk_bf16_f32 v97, v34, v35
    v_cvt_pk_bf16_f32 v98, v48, v49
    v_cvt_pk_bf16_f32 v99, v50, v51
    buffer_store_dwordx4 v[96:99], v4, s[12:15], s30 offen offset:0 sc1
    v_cvt_pk_bf16_f32 v100, v64, v65
    v_cvt_pk_bf16_f32 v101, v66, v67
    v_cvt_pk_bf16_f32 v102, v80, v81
    v_cvt_pk_bf16_f32 v103, v82, v83
    buffer_store_dwordx4 v[100:103], v4, s[12:15], s30 offen offset:1024 sc1
LB_ps_46:
    s_cmp_eq_u32 s37, 2
    s_cbranch_scc1 LB_ps_47
    s_add_u32 s30, s28, 4096
    v_cvt_pk_bf16_f32 v104, v36, v37
    v_cvt_pk_bf16_f32 v105, v38, v39
    v_cvt_pk_bf16_f32 v106, v52, v53
    v_cvt_pk_bf16_f32 v107, v54, v55
    buffer_store_dwordx4 v[104:107], v4, s[12:15], s30 offen offset:0 sc1
    v_cvt_pk_bf16_f32 v108, v68, v69
    v_cvt_pk_bf16_f32 v109, v70, v71
    v_cvt_pk_bf16_f32 v110, v84, v85
    v_cvt_pk_bf16_f32 v111, v86, v87
    buffer_store_dwordx4 v[108:111], v4, s[12:15], s30 offen offset:1024 sc1
LB_ps_47:
    s_cmp_eq_u32 s37, 3
    s_cbranch_scc1 LB_ps_48
    s_add_u32 s30, s28, 6144
    v_cvt_pk_bf16_f32 v112, v40, v41
    v_cvt_pk_bf16_f32 v113, v42, v43
    v_cvt_pk_bf16_f32 v114, v56, v57
    v_cvt_pk_bf16_f32 v115, v58, v59
    buffer_store_dwordx4 v[112:115], v4, s[12:15], s30 offen offset:0 sc1
    v_cvt_pk_bf16_f32 v116, v72, v73
    v_cvt_pk_bf16_f32 v117, v74, v75
    buffer_store_dwordx4 v[116:119], v4, s[12:15], s30 offen offset:1024 sc1
LB_ps_48:
    v_and_b32 v5, 15, v0
    v_mul_u32_u24 v5, 0xa00, v5
    v_lshrrev_b32 v6, 4, v0
    v_lshl_add_u32 v5, v6, 3, v5
    s_lshl_b32 s27, s45, 5
    v_add_u32 v5, s27, v5
    s_waitcnt vmcnt(0)
    s_barrier
    s_lshl_b32 s27, s46, 7
    s_cmp_eq_u32 s24, 0
    s_cbranch_scc0 LB_fw_49
    v_mov_b32 v6, 0x1
    s_mov_b64 exec, 1
    buffer_atomic_add v6, off, s[20:23], s27 sc1
    s_mov_b32 s35, 0
LB_fp_50:
    buffer_load_dword v7, off, s[20:23], s27 sc1
    s_waitcnt vmcnt(0)
    v_readfirstlane_b32 s28, v7
    s_add_u32 s35, s35, 1
    s_bfe_u32 s28, s28, 0x100000
    s_cmp_ge_u32 s28, 4
    s_cbranch_scc1 LB_fd_51
    s_cmp_lt_u32 s35, 0x40000
    s_cbranch_scc1 LB_fp_50
LB_fd_51:
    s_mov_b64 exec, -1
LB_fw_49:
    s_barrier
    s_cmp_eq_u32 s37, 0
    s_cbranch_scc0 LB_pr_52
    s_add_u32 s30, s52, 0
    buffer_load_dwordx4 v[88:91], v4, s[12:15], s30 offen offset:0 sc1
    s_add_u32 s30, s53, 0
    buffer_load_dwordx4 v[92:95], v4, s[12:15], s30 offen offset:0 sc1
    s_add_u32 s30, s54, 0
    buffer_load_dwordx4 v[96:99], v4, s[12:15], s30 offen offset:0 sc1
    s_add_u32 s30, s52, 0
    buffer_load_dwordx4 v[100:103], v4, s[12:15], s30 offen offset:1024 sc1
    s_add_u32 s30, s53, 0
    buffer_load_dwordx4 v[104:107], v4, s[12:15], s30 offen offset:1024 sc1
    s_add_u32 s30, s54, 0
    buffer_load_dwordx4 v[108:111], v4, s[12:15], s30 offen offset:1024 sc1
    s_waitcnt vmcnt(3)
    v_lshlrev_b32 v6, 16, v88
    v_and_b32 v7, 0xffff0000, v88
    v_add_f32 v28, v28, v6
    v_add_f32 v29, v29, v7
    v_lshlrev_b32 v6, 16, v89
    v_and_b32 v7, 0xffff0000, v89
    v_add_f32 v30, v30, v6
    v_add_f32 v31, v31, v7
    v_lshlrev_b32 v6, 16, v92
    v_and_b32 v7, 0xffff0000, v92
    v_add_f32 v28, v28, v6
    v_add_f32 v29, v29, v7
    v_lshlrev_b32 v6, 16, v93
    v_and_b32 v7, 0xffff0000, v93
    v_add_f32 v30, v30, v6
    v_add_f32 v31, v31, v7
    v_lshlrev_b32 v6, 16, v96
    v_and_b32 v7, 0xffff0000, v96
    v_add_f32 v28, v28, v6
    v_add_f32 v29, v29, v7
    v_lshlrev_b32 v6, 16, v97
    v_and_b32 v7, 0xffff0000, v97
    v_add_f32 v30, v30, v6
    v_add_f32 v31, v31, v7
    v_cvt_pk_bf16_f32 v28, v28, v29
    v_cvt_pk_bf16_f32 v29, v30, v31
    s_mov_b32 s30, 0
    buffer_store_dwordx2 v[28:29], v5, s[16:19], s30 offen offset:0
    v_lshlrev_b32 v6, 16, v90
    v_and_b32 v7, 0xffff0000, v90
    v_add_f32 v44, v44, v6
    v_add_f32 v45, v45, v7
    v_lshlrev_b32 v6, 16, v91
    v_and_b32 v7, 0xffff0000, v91
    v_add_f32 v46, v46, v6
    v_add_f32 v47, v47, v7
    v_lshlrev_b32 v6, 16, v94
    v_and_b32 v7, 0xffff0000, v94
    v_add_f32 v44, v44, v6
    v_add_f32 v45, v45, v7
    v_lshlrev_b32 v6, 16, v95
    v_and_b32 v7, 0xffff0000, v95
    v_add_f32 v46, v46, v6
    v_add_f32 v47, v47, v7
    v_lshlrev_b32 v6, 16, v98
    v_and_b32 v7, 0xffff0000, v98
    v_add_f32 v44, v44, v6
    v_add_f32 v45, v45, v7
    v_lshlrev_b32 v6, 16, v99
    v_and_b32 v7, 0xffff0000, v99
    v_add_f32 v46, v46, v6
    v_add_f32 v47, v47, v7
    v_cvt_pk_bf16_f32 v44, v44, v45
    v_cvt_pk_bf16_f32 v45, v46, v47
    s_mov_b32 s30, 40960
    buffer_store_dwordx2 v[44:45], v5, s[16:19], s30 offen offset:32
    s_waitcnt vmcnt(2)
    v_lshlrev_b32 v6, 16, v100
    v_and_b32 v7, 0xffff0000, v100
    v_add_f32 v60, v60, v6
    v_add_f32 v61, v61, v7
    v_lshlrev_b32 v6, 16, v101
    v_and_b32 v7, 0xffff0000, v101
    v_add_f32 v62, v62, v6
    v_add_f32 v63, v63, v7
    v_lshlrev_b32 v6, 16, v104
    v_and_b32 v7, 0xffff0000, v104
    v_add_f32 v60, v60, v6
    v_add_f32 v61, v61, v7
    v_lshlrev_b32 v6, 16, v105
    v_and_b32 v7, 0xffff0000, v105
    v_add_f32 v62, v62, v6
    v_add_f32 v63, v63, v7
    v_lshlrev_b32 v6, 16, v108
    v_and_b32 v7, 0xffff0000, v108
    v_add_f32 v60, v60, v6
    v_add_f32 v61, v61, v7
    v_lshlrev_b32 v6, 16, v109
    v_and_b32 v7, 0xffff0000, v109
    v_add_f32 v62, v62, v6
    v_add_f32 v63, v63, v7
    v_cvt_pk_bf16_f32 v60, v60, v61
    v_cvt_pk_bf16_f32 v61, v62, v63
    s_mov_b32 s30, 81920
    buffer_store_dwordx2 v[60:61], v5, s[16:19], s30 offen offset:64
    v_lshlrev_b32 v6, 16, v102
    v_and_b32 v7, 0xffff0000, v102
    v_add_f32 v76, v76, v6
    v_add_f32 v77, v77, v7
    v_lshlrev_b32 v6, 16, v103
    v_and_b32 v7, 0xffff0000, v103
    v_add_f32 v78, v78, v6
    v_add_f32 v79, v79, v7
    v_lshlrev_b32 v6, 16, v106
    v_and_b32 v7, 0xffff0000, v106
    v_add_f32 v76, v76, v6
    v_add_f32 v77, v77, v7
    v_lshlrev_b32 v6, 16, v107
    v_and_b32 v7, 0xffff0000, v107
    v_add_f32 v78, v78, v6
    v_add_f32 v79, v79, v7
    v_lshlrev_b32 v6, 16, v110
    v_and_b32 v7, 0xffff0000, v110
    v_add_f32 v76, v76, v6
    v_add_f32 v77, v77, v7
    v_lshlrev_b32 v6, 16, v111
    v_and_b32 v7, 0xffff0000, v111
    v_add_f32 v78, v78, v6
    v_add_f32 v79, v79, v7
    v_cvt_pk_bf16_f32 v76, v76, v77
    v_cvt_pk_bf16_f32 v77, v78, v79
    s_mov_b32 s30, 163840
    buffer_store_dwordx2 v[76:77], v5, s[16:19], s30 offen offset:0
LB_pr_52:
    s_cmp_eq_u32 s37, 1
    s_cbranch_scc0 LB_pr_53
    s_add_u32 s30, s52, 2048
    buffer_load_dwordx4 v[88:91], v4, s[12:15], s30 offen offset:0 sc1
    s_add_u32 s30, s53, 2048
    buffer_load_dwordx4 v[92:95], v4, s[12:15], s30 offen offset:0 sc1
    s_add_u32 s30, s54, 2048
    buffer_load_dwordx4 v[96:99], v4, s[12:15], s30 offen offset:0 sc1
    s_add_u32 s30, s52, 2048
    buffer_load_dwordx4 v[100:103], v4, s[12:15], s30 offen offset:1024 sc1
    s_add_u32 s30, s53, 2048
    buffer_load_dwordx4 v[104:107], v4, s[12:15], s30 offen offset:1024 sc1
    s_add_u32 s30, s54, 2048
    buffer_load_dwordx4 v[108:111], v4, s[12:15], s30 offen offset:1024 sc1
    s_waitcnt vmcnt(3)
    v_lshlrev_b32 v6, 16, v88
    v_and_b32 v7, 0xffff0000, v88
    v_add_f32 v32, v32, v6
    v_add_f32 v33, v33, v7
    v_lshlrev_b32 v6, 16, v89
    v_and_b32 v7, 0xffff0000, v89
    v_add_f32 v34, v34, v6
    v_add_f32 v35, v35, v7
    v_lshlrev_b32 v6, 16, v92
    v_and_b32 v7, 0xffff0000, v92
    v_add_f32 v32, v32, v6
    v_add_f32 v33, v33, v7
    v_lshlrev_b32 v6, 16, v93
    v_and_b32 v7, 0xffff0000, v93
    v_add_f32 v34, v34, v6
    v_add_f32 v35, v35, v7
    v_lshlrev_b32 v6, 16, v96
    v_and_b32 v7, 0xffff0000, v96
    v_add_f32 v32, v32, v6
    v_add_f32 v33, v33, v7
    v_lshlrev_b32 v6, 16, v97
    v_and_b32 v7, 0xffff0000, v97
    v_add_f32 v34, v34, v6
    v_add_f32 v35, v35, v7
    v_cvt_pk_bf16_f32 v32, v32, v33
    v_cvt_pk_bf16_f32 v33, v34, v35
    s_mov_b32 s30, 0
    buffer_store_dwordx2 v[32:33], v5, s[16:19], s30 offen offset:32
    v_lshlrev_b32 v6, 16, v90
    v_and_b32 v7, 0xffff0000, v90
    v_add_f32 v48, v48, v6
    v_add_f32 v49, v49, v7
    v_lshlrev_b32 v6, 16, v91
    v_and_b32 v7, 0xffff0000, v91
    v_add_f32 v50, v50, v6
    v_add_f32 v51, v51, v7
    v_lshlrev_b32 v6, 16, v94
    v_and_b32 v7, 0xffff0000, v94
    v_add_f32 v48, v48, v6
    v_add_f32 v49, v49, v7
    v_lshlrev_b32 v6, 16, v95
    v_and_b32 v7, 0xffff0000, v95
    v_add_f32 v50, v50, v6
    v_add_f32 v51, v51, v7
    v_lshlrev_b32 v6, 16, v98
    v_and_b32 v7, 0xffff0000, v98
    v_add_f32 v48, v48, v6
    v_add_f32 v49, v49, v7
    v_lshlrev_b32 v6, 16, v99
    v_and_b32 v7, 0xffff0000, v99
    v_add_f32 v50, v50, v6
    v_add_f32 v51, v51, v7
    v_cvt_pk_bf16_f32 v48, v48, v49
    v_cvt_pk_bf16_f32 v49, v50, v51
    s_mov_b32 s30, 40960
    buffer_store_dwordx2 v[48:49], v5, s[16:19], s30 offen offset:64
    s_waitcnt vmcnt(2)
    v_lshlrev_b32 v6, 16, v100
    v_and_b32 v7, 0xffff0000, v100
    v_add_f32 v64, v64, v6
    v_add_f32 v65, v65, v7
    v_lshlrev_b32 v6, 16, v101
    v_and_b32 v7, 0xffff0000, v101
    v_add_f32 v66, v66, v6
    v_add_f32 v67, v67, v7
    v_lshlrev_b32 v6, 16, v104
    v_and_b32 v7, 0xffff0000, v104
    v_add_f32 v64, v64, v6
    v_add_f32 v65, v65, v7
    v_lshlrev_b32 v6, 16, v105
    v_and_b32 v7, 0xffff0000, v105
    v_add_f32 v66, v66, v6
    v_add_f32 v67, v67, v7
    v_lshlrev_b32 v6, 16, v108
    v_and_b32 v7, 0xffff0000, v108
    v_add_f32 v64, v64, v6
    v_add_f32 v65, v65, v7
    v_lshlrev_b32 v6, 16, v109
    v_and_b32 v7, 0xffff0000, v109
    v_add_f32 v66, v66, v6
    v_add_f32 v67, v67, v7
    v_cvt_pk_bf16_f32 v64, v64, v65
    v_cvt_pk_bf16_f32 v65, v66, v67
    s_mov_b32 s30, 122880
    buffer_store_dwordx2 v[64:65], v5, s[16:19], s30 offen offset:0
    v_lshlrev_b32 v6, 16, v102
    v_and_b32 v7, 0xffff0000, v102
    v_add_f32 v80, v80, v6
    v_add_f32 v81, v81, v7
    v_lshlrev_b32 v6, 16, v103
    v_and_b32 v7, 0xffff0000, v103
    v_add_f32 v82, v82, v6
    v_add_f32 v83, v83, v7
    v_lshlrev_b32 v6, 16, v106
    v_and_b32 v7, 0xffff0000, v106
    v_add_f32 v80, v80, v6
    v_add_f32 v81, v81, v7
    v_lshlrev_b32 v6, 16, v107
    v_and_b32 v7, 0xffff0000, v107
    v_add_f32 v82, v82, v6
    v_add_f32 v83, v83, v7
    v_lshlrev_b32 v6, 16, v110
    v_and_b32 v7, 0xffff0000, v110
    v_add_f32 v80, v80, v6
    v_add_f32 v81, v81, v7
    v_lshlrev_b32 v6, 16, v111
    v_and_b32 v7, 0xffff0000, v111
    v_add_f32 v82, v82, v6
    v_add_f32 v83, v83, v7
    v_cvt_pk_bf16_f32 v80, v80, v81
    v_cvt_pk_bf16_f32 v81, v82, v83
    s_mov_b32 s30, 163840
    buffer_store_dwordx2 v[80:81], v5, s[16:19], s30 offen offset:32
LB_pr_53:
    s_cmp_eq_u32 s37, 2
    s_cbranch_scc0 LB_pr_54
    s_add_u32 s30, s52, 4096
    buffer_load_dwordx4 v[88:91], v4, s[12:15], s30 offen offset:0 sc1
    s_add_u32 s30, s53, 4096
    buffer_load_dwordx4 v[92:95], v4, s[12:15], s30 offen offset:0 sc1
    s_add_u32 s30, s54, 4096
    buffer_load_dwordx4 v[96:99], v4, s[12:15], s30 offen offset:0 sc1
    s_add_u32 s30, s52, 4096
    buffer_load_dwordx4 v[100:103], v4, s[12:15], s30 offen offset:1024 sc1
    s_add_u32 s30, s53, 4096
    buffer_load_dwordx4 v[104:107], v4, s[12:15], s30 offen offset:1024 sc1
    s_add_u32 s30, s54, 4096
    buffer_load_dwordx4 v[108:111], v4, s[12:15], s30 offen offset:1024 sc1
    s_waitcnt vmcnt(3)
    v_lshlrev_b32 v6, 16, v88
    v_and_b32 v7, 0xffff0000, v88
    v_add_f32 v36, v36, v6
    v_add_f32 v37, v37, v7
    v_lshlrev_b32 v6, 16, v89
    v_and_b32 v7, 0xffff0000, v89
    v_add_f32 v38, v38, v6
    v_add_f32 v39, v39, v7
    v_lshlrev_b32 v6, 16, v92
    v_and_b32 v7, 0xffff0000, v92
    v_add_f32 v36, v36, v6
    v_add_f32 v37, v37, v7
    v_lshlrev_b32 v6, 16, v93
    v_and_b32 v7, 0xffff0000, v93
    v_add_f32 v38, v38, v6
    v_add_f32 v39, v39, v7
    v_lshlrev_b32 v6, 16, v96
    v_and_b32 v7, 0xffff0000, v96
    v_add_f32 v36, v36, v6
    v_add_f32 v37, v37, v7
    v_lshlrev_b32 v6, 16, v97
    v_and_b32 v7, 0xffff0000, v97
    v_add_f32 v38, v38, v6
    v_add_f32 v39, v39, v7
    v_cvt_pk_bf16_f32 v36, v36, v37
    v_cvt_pk_bf16_f32 v37, v38, v39
    s_mov_b32 s30, 0
    buffer_store_dwordx2 v[36:37], v5, s[16:19], s30 offen offset:64
    v_lshlrev_b32 v6, 16, v90
    v_and_b32 v7, 0xffff0000, v90
    v_add_f32 v52, v52, v6
    v_add_f32 v53, v53, v7
    v_lshlrev_b32 v6, 16, v91
    v_and_b32 v7, 0xffff0000, v91
    v_add_f32 v54, v54, v6
    v_add_f32 v55, v55, v7
    v_lshlrev_b32 v6, 16, v94
    v_and_b32 v7, 0xffff0000, v94
    v_add_f32 v52, v52, v6
    v_add_f32 v53, v53, v7
    v_lshlrev_b32 v6, 16, v95
    v_and_b32 v7, 0xffff0000, v95
    v_add_f32 v54, v54, v6
    v_add_f32 v55, v55, v7
    v_lshlrev_b32 v6, 16, v98
    v_and_b32 v7, 0xffff0000, v98
    v_add_f32 v52, v52, v6
    v_add_f32 v53, v53, v7
    v_lshlrev_b32 v6, 16, v99
    v_and_b32 v7, 0xffff0000, v99
    v_add_f32 v54, v54, v6
    v_add_f32 v55, v55, v7
    v_cvt_pk_bf16_f32 v52, v52, v53
    v_cvt_pk_bf16_f32 v53, v54, v55
    s_mov_b32 s30, 81920
    buffer_store_dwordx2 v[52:53], v5, s[16:19], s30 offen offset:0
    s_waitcnt vmcnt(2)
    v_lshlrev_b32 v6, 16, v100
    v_and_b32 v7, 0xffff0000, v100
    v_add_f32 v68, v68, v6
    v_add_f32 v69, v69, v7
    v_lshlrev_b32 v6, 16, v101
    v_and_b32 v7, 0xffff0000, v101
    v_add_f32 v70, v70, v6
    v_add_f32 v71, v71, v7
    v_lshlrev_b32 v6, 16, v104
    v_and_b32 v7, 0xffff0000, v104
    v_add_f32 v68, v68, v6
    v_add_f32 v69, v69, v7
    v_lshlrev_b32 v6, 16, v105
    v_and_b32 v7, 0xffff0000, v105
    v_add_f32 v70, v70, v6
    v_add_f32 v71, v71, v7
    v_lshlrev_b32 v6, 16, v108
    v_and_b32 v7, 0xffff0000, v108
    v_add_f32 v68, v68, v6
    v_add_f32 v69, v69, v7
    v_lshlrev_b32 v6, 16, v109
    v_and_b32 v7, 0xffff0000, v109
    v_add_f32 v70, v70, v6
    v_add_f32 v71, v71, v7
    v_cvt_pk_bf16_f32 v68, v68, v69
    v_cvt_pk_bf16_f32 v69, v70, v71
    s_mov_b32 s30, 122880
    buffer_store_dwordx2 v[68:69], v5, s[16:19], s30 offen offset:32
    v_lshlrev_b32 v6, 16, v102
    v_and_b32 v7, 0xffff0000, v102
    v_add_f32 v84, v84, v6
    v_add_f32 v85, v85, v7
    v_lshlrev_b32 v6, 16, v103
    v_and_b32 v7, 0xffff0000, v103
    v_add_f32 v86, v86, v6
    v_add_f32 v87, v87, v7
    v_lshlrev_b32 v6, 16, v106
    v_and_b32 v7, 0xffff0000, v106
    v_add_f32 v84, v84, v6
    v_add_f32 v85, v85, v7
    v_lshlrev_b32 v6, 16, v107
    v_and_b32 v7, 0xffff0000, v107
    v_add_f32 v86, v86, v6
    v_add_f32 v87, v87, v7
    v_lshlrev_b32 v6, 16, v110
    v_and_b32 v7, 0xffff0000, v110
    v_add_f32 v84, v84, v6
    v_add_f32 v85, v85, v7
    v_lshlrev_b32 v6, 16, v111
    v_and_b32 v7, 0xffff0000, v111
    v_add_f32 v86, v86, v6
    v_add_f32 v87, v87, v7
    v_cvt_pk_bf16_f32 v84, v84, v85
    v_cvt_pk_bf16_f32 v85, v86, v87
    s_mov_b32 s30, 163840
    buffer_store_dwordx2 v[84:85], v5, s[16:19], s30 offen offset:64
LB_pr_54:
    s_cmp_eq_u32 s37, 3
    s_cbranch_scc0 LB_pr_55
    s_add_u32 s30, s52, 6144
    buffer_load_dwordx4 v[88:91], v4, s[12:15], s30 offen offset:0 sc1
    s_add_u32 s30, s53, 6144
    buffer_load_dwordx4 v[92:95], v4, s[12:15], s30 offen offset:0 sc1
    s_add_u32 s30, s54, 6144
    buffer_load_dwordx4 v[96:99], v4, s[12:15], s30 offen offset:0 sc1
    s_add_u32 s30, s52, 6144
    buffer_load_dwordx4 v[100:103], v4, s[12:15], s30 offen offset:1024 sc1
    s_add_u32 s30, s53, 6144
    buffer_load_dwordx4 v[104:107], v4, s[12:15], s30 offen offset:1024 sc1
    s_add_u32 s30, s54, 6144
    buffer_load_dwordx4 v[108:111], v4, s[12:15], s30 offen offset:1024 sc1
    s_waitcnt vmcnt(3)
    v_lshlrev_b32 v6, 16, v88
    v_and_b32 v7, 0xffff0000, v88
    v_add_f32 v40, v40, v6
    v_add_f32 v41, v41, v7
    v_lshlrev_b32 v6, 16, v89
    v_and_b32 v7, 0xffff0000, v89
    v_add_f32 v42, v42, v6
    v_add_f32 v43, v43, v7
    v_lshlrev_b32 v6, 16, v92
    v_and_b32 v7, 0xffff0000, v92
    v_add_f32 v40, v40, v6
    v_add_f32 v41, v41, v7
    v_lshlrev_b32 v6, 16, v93
    v_and_b32 v7, 0xffff0000, v93
    v_add_f32 v42, v42, v6
    v_add_f32 v43, v43, v7
    v_lshlrev_b32 v6, 16, v96
    v_and_b32 v7, 0xffff0000, v96
    v_add_f32 v40, v40, v6
    v_add_f32 v41, v41, v7
    v_lshlrev_b32 v6, 16, v97
    v_and_b32 v7, 0xffff0000, v97
    v_add_f32 v42, v42, v6
    v_add_f32 v43, v43, v7
    v_cvt_pk_bf16_f32 v40, v40, v41
    v_cvt_pk_bf16_f32 v41, v42, v43
    s_mov_b32 s30, 40960
    buffer_store_dwordx2 v[40:41], v5, s[16:19], s30 offen offset:0
    v_lshlrev_b32 v6, 16, v90
    v_and_b32 v7, 0xffff0000, v90
    v_add_f32 v56, v56, v6
    v_add_f32 v57, v57, v7
    v_lshlrev_b32 v6, 16, v91
    v_and_b32 v7, 0xffff0000, v91
    v_add_f32 v58, v58, v6
    v_add_f32 v59, v59, v7
    v_lshlrev_b32 v6, 16, v94
    v_and_b32 v7, 0xffff0000, v94
    v_add_f32 v56, v56, v6
    v_add_f32 v57, v57, v7
    v_lshlrev_b32 v6, 16, v95
    v_and_b32 v7, 0xffff0000, v95
    v_add_f32 v58, v58, v6
    v_add_f32 v59, v59, v7
    v_lshlrev_b32 v6, 16, v98
    v_and_b32 v7, 0xffff0000, v98
    v_add_f32 v56, v56, v6
    v_add_f32 v57, v57, v7
    v_lshlrev_b32 v6, 16, v99
    v_and_b32 v7, 0xffff0000, v99
    v_add_f32 v58, v58, v6
    v_add_f32 v59, v59, v7
    v_cvt_pk_bf16_f32 v56, v56, v57
    v_cvt_pk_bf16_f32 v57, v58, v59
    s_mov_b32 s30, 81920
    buffer_store_dwordx2 v[56:57], v5, s[16:19], s30 offen offset:32
    s_waitcnt vmcnt(2)
    v_lshlrev_b32 v6, 16, v100
    v_and_b32 v7, 0xffff0000, v100
    v_add_f32 v72, v72, v6
    v_add_f32 v73, v73, v7
    v_lshlrev_b32 v6, 16, v101
    v_and_b32 v7, 0xffff0000, v101
    v_add_f32 v74, v74, v6
    v_add_f32 v75, v75, v7
    v_lshlrev_b32 v6, 16, v104
    v_and_b32 v7, 0xffff0000, v104
    v_add_f32 v72, v72, v6
    v_add_f32 v73, v73, v7
    v_lshlrev_b32 v6, 16, v105
    v_and_b32 v7, 0xffff0000, v105
    v_add_f32 v74, v74, v6
    v_add_f32 v75, v75, v7
    v_lshlrev_b32 v6, 16, v108
    v_and_b32 v7, 0xffff0000, v108
    v_add_f32 v72, v72, v6
    v_add_f32 v73, v73, v7
    v_lshlrev_b32 v6, 16, v109
    v_and_b32 v7, 0xffff0000, v109
    v_add_f32 v74, v74, v6
    v_add_f32 v75, v75, v7
    v_cvt_pk_bf16_f32 v72, v72, v73
    v_cvt_pk_bf16_f32 v73, v74, v75
    s_mov_b32 s30, 122880
    buffer_store_dwordx2 v[72:73], v5, s[16:19], s30 offen offset:64
LB_pr_55:
    s_endpgm
LB_v1:
    s_add_u32 m0, s34, 0x4800
    s_nop 0
    buffer_load_dwordx4 v8, s[8:11], s32 offen lds
    s_add_u32 m0, s34, 0x4c00
    s_nop 0
    buffer_load_dwordx4 v9, s[8:11], s32 offen lds
    s_add_u32 m0, s34, 0x5000
    s_nop 0
    buffer_load_dwordx4 v10, s[8:11], s32 offen lds
    s_add_u32 m0, s34, 0x5400
    s_nop 0
    buffer_load_dwordx4 v11, s[8:11], s32 offen lds
    s_add_u32 m0, s34, 0x5800
    s_nop 0
    buffer_load_dwordx4 v12, s[8:11], s32 offen lds
    s_add_u32 s32, s32, 81920
    s_cmp_ge_u32 s32, 1966080
    s_cselect_b32 s32, 0, s32
    s_add_u32 m0, s34, 0xe000
    s_nop 0
    buffer_load_dwordx4 v8, s[8:11], s32 offen lds
    s_add_u32 m0, s34, 0xe400
    s_nop 0
    buffer_load_dwordx4 v9, s[8:11], s32 offen lds
    s_add_u32 m0, s34, 0xe800
    s_nop 0
    buffer_load_dwordx4 v10, s[8:11], s32 offen lds
    s_add_u32 m0, s34, 0xec00
    s_nop 0
    buffer_load_dwordx4 v11, s[8:11], s32 offen lds
    s_add_u32 m0, s34, 0xf000
    s_nop 0
    buffer_load_dwordx4 v12, s[8:11], s32 offen lds
    s_add_u32 s32, s32, 81920
    s_cmp_ge_u32 s32, 1966080
    s_cselect_b32 s32, 0, s32
    v_mul_u32_u24 v6, 0xa00, v4
    v_bfe_u32 v7, v0, 2, 2
    v_lshl_add_u32 v6, v7, 6, v6
    v_and_b32 v7, 3, v0
    v_lshl_add_u32 v6, v7, 3, v6
    s_add_u32 s30, s45, 0
    v_xor_b32 v7, s30, v4
    v_and_b32 v7, 1, v7
    v_lshl_add_u32 v16, v7, 5, v6
    s_lshr_b32 s30, s30, 1
    s_lshl_b32 s30, s30, 8
    s_add_u32 s30, s30, 0x4800
    v_add_u32 v16, s30, v16
    s_add_u32 s30, s45, 1
    v_xor_b32 v7, s30, v4
    v_and_b32 v7, 1, v7
    v_lshl_add_u32 v17, v7, 5, v6
    s_lshr_b32 s30, s30, 1
    s_lshl_b32 s30, s30, 8
    s_add_u32 s30, s30, 0x4800
    v_add_u32 v17, s30, v17
    s_add_u32 s30, s45, 2
    v_xor_b32 v7, s30, v4
    v_and_b32 v7, 1, v7
    v_lshl_add_u32 v18, v7, 5, v6
    s_lshr_b32 s30, s30, 1
    s_lshl_b32 s30, s30, 8
    s_add_u32 s30, s30, 0x4800
    v_add_u32 v18, s30, v18
    v_mov_b32 v19, v1
    v_add_u32 v20, 0x9800, v16
    v_add_u32 v21, 0x9800, v17
    v_add_u32 v22, 0x9800, v18
    v_add_u32 v23, 0x9800, v19
    v_add_u32 v24, 0x13000, v16
    v_add_u32 v25, 0x13000, v17
    v_add_u32 v26, 0x13000, v18
    v_add_u32 v27, 0x13000, v19
    v_mov_b32 v28, 0
    v_mov_b32 v29, 0
    v_mov_b32 v30, 0
    v_mov_b32 v31, 0
    v_mov_b32 v32, 0
    v_mov_b32 v33, 0
    v_mov_b32 v34, 0
    v_mov_b32 v35, 0
    v_mov_b32 v36, 0
    v_mov_b32 v37, 0
    v_mov_b32 v38, 0
    v_mov_b32 v39, 0
    v_mov_b32 v40, 0
    v_mov_b32 v41, 0
    v_mov_b32 v42, 0
    v_mov_b32 v43, 0
    v_mov_b32 v44, 0
    v_mov_b32 v45, 0
    v_mov_b32 v46, 0
    v_mov_b32 v47, 0
    v_mov_b32 v48, 0
    v_mov_b32 v49, 0
    v_mov_b32 v50, 0
    v_mov_b32 v51, 0
    v_mov_b32 v52, 0
    v_mov_b32 v53, 0
    v_mov_b32 v54, 0
    v_mov_b32 v55, 0
    v_mov_b32 v56, 0
    v_mov_b32 v57, 0
    v_mov_b32 v58, 0
    v_mov_b32 v59, 0
    v_mov_b32 v60, 0
    v_mov_b32 v61, 0
    v_mov_b32 v62, 0
    v_mov_b32 v63, 0
    v_mov_b32 v64, 0
    v_mov_b32 v65, 0
    v_mov_b32 v66, 0
    v_mov_b32 v67, 0
    v_mov_b32 v68, 0
    v_mov_b32 v69, 0
    v_mov_b32 v70, 0
    v_mov_b32 v71, 0
    v_mov_b32 v72, 0
    v_mov_b32 v73, 0
    v_mov_b32 v74, 0
    v_mov_b32 v75, 0
    v_mov_b32 v76, 0
    v_mov_b32 v77, 0
    v_mov_b32 v78, 0
    v_mov_b32 v79, 0
    v_mov_b32 v80, 0
    v_mov_b32 v81, 0
    v_mov_b32 v82, 0
    v_mov_b32 v83, 0
    v_mov_b32 v84, 0
    v_mov_b32 v85, 0
    v_mov_b32 v86, 0
    v_mov_b32 v87, 0
    s_waitcnt vmcnt(5)
    s_barrier
    ds_read_b64_tr_b16 v[88:89], v16 offset:0
    ds_read_b64_tr_b16 v[90:91], v16 offset:1280
    ds_read_b64_tr_b16 v[92:93], v17 offset:0
    ds_read_b64_tr_b16 v[94:95], v17 offset:1280
    ds_read_b128 v[112:115], v19 offset:0
    ds_read_b128 v[116:119], v19 offset:1024
    ds_read_b128 v[120:123], v19 offset:2048
    ds_read_b128 v[124:127], v19 offset:3072
    ds_read_b128 v[128:131], v19 offset:4096
    s_add_u32 m0, s34, 0x17800
    s_nop 0
    buffer_load_dwordx4 v8, s[8:11], s32 offen lds
    s_add_u32 m0, s34, 0x17c00
    s_nop 0
    buffer_load_dwordx4 v9, s[8:11], s32 offen lds
    s_add_u32 m0, s34, 0x18000
    s_nop 0
    buffer_load_dwordx4 v10, s[8:11], s32 offen lds
    s_mov_b32 s35, 0
LB_loop1:
    s_waitcnt lgkmcnt(0)
    v_mfma_f32_16x16x32_bf16 v[28:31], v[88:91], v[112:115], v[28:31]
    ds_read_b64_tr_b16 v[100:101], v16 offset:10240
    ds_read_b64_tr_b16 v[102:103], v16 offset:11520
    v_mfma_f32_16x16x32_bf16 v[32:35], v[92:95], v[112:115], v[32:35]
    ds_read_b64_tr_b16 v[104:105], v17 offset:10240
    ds_read_b64_tr_b16 v[106:107], v17 offset:11520
    v_mfma_f32_16x16x32_bf16 v[40:43], v[88:91], v[116:119], v[40:43]
    ds_read_b128 v[132:135], v19 offset:9216
    ds_read_b128 v[136:139], v19 offset:10240
    v_mfma_f32_16x16x32_bf16 v[44:47], v[92:95], v[116:119], v[44:47]
    ds_read_b128 v[140:143], v19 offset:11264
    v_mfma_f32_16x16x32_bf16 v[52:55], v[88:91], v[120:123], v[52:55]
    ds_read_b128 v[144:147], v19 offset:12288
    v_mfma_f32_16x16x32_bf16 v[56:59], v[92:95], v[120:123], v[56:59]
    ds_read_b128 v[148:151], v19 offset:13312
    v_mfma_f32_16x16x32_bf16 v[64:67], v[88:91], v[124:127], v[64:67]
    s_add_u32 m0, s34, 0x18400
    s_nop 0
    buffer_load_dwordx4 v11, s[8:11], s32 offen lds
    v_mfma_f32_16x16x32_bf16 v[68:71], v[92:95], v[124:127], v[68:71]
    s_add_u32 m0, s34, 0x18800
    s_nop 0
    buffer_load_dwordx4 v12, s[8:11], s32 offen lds
    v_mfma_f32_16x16x32_bf16 v[76:79], v[88:91], v[128:131], v[76:79]
    s_add_u32 s32, s32, 81920
    s_cmp_ge_u32 s32, 1966080
    s_cselect_b32 s32, 0, s32
    v_mfma_f32_16x16x32_bf16 v[80:83], v[92:95], v[128:131], v[80:83]
    s_waitcnt vmcnt(5) lgkmcnt(0)
    s_barrier
    v_mfma_f32_16x16x32_bf16 v[28:31], v[100:103], v[132:135], v[28:31]
    ds_read_b64_tr_b16 v[88:89], v20 offset:0
    ds_read_b64_tr_b16 v[90:91], v20 offset:1280
    v_mfma_f32_16x16x32_bf16 v[32:35], v[104:107], v[132:135], v[32:35]
    ds_read_b64_tr_b16 v[92:93], v21 offset:0
    ds_read_b64_tr_b16 v[94:95], v21 offset:1280
    v_mfma_f32_16x16x32_bf16 v[40:43], v[100:103], v[136:139], v[40:43]
    ds_read_b128 v[112:115], v23 offset:0
    ds_read_b128 v[116:119], v23 offset:1024
    v_mfma_f32_16x16x32_bf16 v[44:47], v[104:107], v[136:139], v[44:47]
    ds_read_b128 v[120:123], v23 offset:2048
    v_mfma_f32_16x16x32_bf16 v[52:55], v[100:103], v[140:143], v[52:55]
    ds_read_b128 v[124:127], v23 offset:3072
    v_mfma_f32_16x16x32_bf16 v[56:59], v[104:107], v[140:143], v[56:59]
    ds_read_b128 v[128:131], v23 offset:4096
    v_mfma_f32_16x16x32_bf16 v[64:67], v[100:103], v[144:147], v[64:67]
    s_add_u32 m0, s34, 0x4800
    s_nop 0
    buffer_load_dwordx4 v8, s[8:11], s32 offen lds
    v_mfma_f32_16x16x32_bf16 v[68:71], v[104:107], v[144:147], v[68:71]
    s_add_u32 m0, s34, 0x4c00
    s_nop 0
    buffer_load_dwordx4 v9, s[8:11], s32 offen lds
    v_mfma_f32_16x16x32_bf16 v[76:79], v[100:103], v[148:151], v[76:79]
    s_add_u32 m0, s34, 0x5000
    s_nop 0
    buffer_load_dwordx4 v10, s[8:11], s32 offen lds
    v_mfma_f32_16x16x32_bf16 v[80:83], v[104:107], v[148:151], v[80:83]
    s_waitcnt lgkmcnt(0)
    v_mfma_f32_16x16x32_bf16 v[28:31], v[88:91], v[112:115], v[28:31]
    ds_read_b64_tr_b16 v[100:101], v20 offset:10240
    ds_read_b64_tr_b16 v[102:103], v20 offset:11520
    v_mfma_f32_16x16x32_bf16 v[32:35], v[92:95], v[112:115], v[32:35]
    ds_read_b64_tr_b16 v[104:105], v21 offset:10240
    ds_read_b64_tr_b16 v[106:107], v21 offset:11520
    v_mfma_f32_16x16x32_bf16 v[40:43], v[88:91], v[116:119], v[40:43]
    ds_read_b128 v[132:135], v23 offset:9216
    ds_read_b128 v[136:139], v23 offset:10240
    v_mfma_f32_16x16x32_bf16 v[44:47], v[92:95], v[116:119], v[44:47]
    ds_read_b128 v[140:143], v23 offset:11264
    v_mfma_f32_16x16x32_bf16 v[52:55], v[88:91], v[120:123], v[52:55]
    ds_read_b128 v[144:147], v23 offset:12288
    v_mfma_f32_16x16x32_bf16 v[56:59], v[92:95], v[120:123], v[56:59]
    ds_read_b128 v[148:151], v23 offset:13312
    v_mfma_f32_16x16x32_bf16 v[64:67], v[88:91], v[124:127], v[64:67]
    s_add_u32 m0, s34, 0x5400
    s_nop 0
    buffer_load_dwordx4 v11, s[8:11], s32 offen lds
    v_mfma_f32_16x16x32_bf16 v[68:71], v[92:95], v[124:127], v[68:71]
    s_add_u32 m0, s34, 0x5800
    s_nop 0
    buffer_load_dwordx4 v12, s[8:11], s32 offen lds
    v_mfma_f32_16x16x32_bf16 v[76:79], v[88:91], v[128:131], v[76:79]
    s_add_u32 s32, s32, 81920
    s_cmp_ge_u32 s32, 1966080
    s_cselect_b32 s32, 0, s32
    v_mfma_f32_16x16x32_bf16 v[80:83], v[92:95], v[128:131], v[80:83]
    s_waitcnt vmcnt(5) lgkmcnt(0)
    s_barrier
    v_mfma_f32_16x16x32_bf16 v[28:31], v[100:103], v[132:135], v[28:31]
    ds_read_b64_tr_b16 v[88:89], v24 offset:0
    ds_read_b64_tr_b16 v[90:91], v24 offset:1280
    v_mfma_f32_16x16x32_bf16 v[32:35], v[104:107], v[132:135], v[32:35]
    ds_read_b64_tr_b16 v[92:93], v25 offset:0
    ds_read_b64_tr_b16 v[94:95], v25 offset:1280
    v_mfma_f32_16x16x32_bf16 v[40:43], v[100:103], v[136:139], v[40:43]
    ds_read_b128 v[112:115], v27 offset:0
    ds_read_b128 v[116:119], v27 offset:1024
    v_mfma_f32_16x16x32_bf16 v[44:47], v[104:107], v[136:139], v[44:47]
    ds_read_b128 v[120:123], v27 offset:2048
    v_mfma_f32_16x16x32_bf16 v[52:55], v[100:103], v[140:143], v[52:55]
    ds_read_b128 v[124:127], v27 offset:3072
    v_mfma_f32_16x16x32_bf16 v[56:59], v[104:107], v[140:143], v[56:59]
    ds_read_b128 v[128:131], v27 offset:4096
    v_mfma_f32_16x16x32_bf16 v[64:67], v[100:103], v[144:147], v[64:67]
    s_add_u32 m0, s34, 0xe000
    s_nop 0
    buffer_load_dwordx4 v8, s[8:11], s32 offen lds
    v_mfma_f32_16x16x32_bf16 v[68:71], v[104:107], v[144:147], v[68:71]
    s_add_u32 m0, s34, 0xe400
    s_nop 0
    buffer_load_dwordx4 v9, s[8:11], s32 offen lds
    v_mfma_f32_16x16x32_bf16 v[76:79], v[100:103], v[148:151], v[76:79]
    s_add_u32 m0, s34, 0xe800
    s_nop 0
    buffer_load_dwordx4 v10, s[8:11], s32 offen lds
    v_mfma_f32_16x16x32_bf16 v[80:83], v[104:107], v[148:151], v[80:83]
    s_waitcnt lgkmcnt(0)
    v_mfma_f32_16x16x32_bf16 v[28:31], v[88:91], v[112:115], v[28:31]
    ds_read_b64_tr_b16 v[100:101], v24 offset:10240
    ds_read_b64_tr_b16 v[102:103], v24 offset:11520
    v_mfma_f32_16x16x32_bf16 v[32:35], v[92:95], v[112:115], v[32:35]
    ds_read_b64_tr_b16 v[104:105], v25 offset:10240
    ds_read_b64_tr_b16 v[106:107], v25 offset:11520
    v_mfma_f32_16x16x32_bf16 v[40:43], v[88:91], v[116:119], v[40:43]
    ds_read_b128 v[132:135], v27 offset:9216
    ds_read_b128 v[136:139], v27 offset:10240
    v_mfma_f32_16x16x32_bf16 v[44:47], v[92:95], v[116:119], v[44:47]
    ds_read_b128 v[140:143], v27 offset:11264
    v_mfma_f32_16x16x32_bf16 v[52:55], v[88:91], v[120:123], v[52:55]
    ds_read_b128 v[144:147], v27 offset:12288
    v_mfma_f32_16x16x32_bf16 v[56:59], v[92:95], v[120:123], v[56:59]
    ds_read_b128 v[148:151], v27 offset:13312
    v_mfma_f32_16x16x32_bf16 v[64:67], v[88:91], v[124:127], v[64:67]
    s_add_u32 m0, s34, 0xec00
    s_nop 0
    buffer_load_dwordx4 v11, s[8:11], s32 offen lds
    v_mfma_f32_16x16x32_bf16 v[68:71], v[92:95], v[124:127], v[68:71]
    s_add_u32 m0, s34, 0xf000
    s_nop 0
    buffer_load_dwordx4 v12, s[8:11], s32 offen lds
    v_mfma_f32_16x16x32_bf16 v[76:79], v[88:91], v[128:131], v[76:79]
    s_add_u32 s32, s32, 81920
    s_cmp_ge_u32 s32, 1966080
    s_cselect_b32 s32, 0, s32
    v_mfma_f32_16x16x32_bf16 v[80:83], v[92:95], v[128:131], v[80:83]
    s_waitcnt vmcnt(5) lgkmcnt(0)
    s_barrier
    v_mfma_f32_16x16x32_bf16 v[28:31], v[100:103], v[132:135], v[28:31]
    ds_read_b64_tr_b16 v[88:89], v16 offset:0
    ds_read_b64_tr_b16 v[90:91], v16 offset:1280
    v_mfma_f32_16x16x32_bf16 v[32:35], v[104:107], v[132:135], v[32:35]
    ds_read_b64_tr_b16 v[92:93], v17 offset:0
    ds_read_b64_tr_b16 v[94:95], v17 offset:1280
    v_mfma_f32_16x16x32_bf16 v[40:43], v[100:103], v[136:139], v[40:43]
    ds_read_b128 v[112:115], v19 offset:0
    ds_read_b128 v[116:119], v19 offset:1024
    v_mfma_f32_16x16x32_bf16 v[44:47], v[104:107], v[136:139], v[44:47]
    ds_read_b128 v[120:123], v19 offset:2048
    v_mfma_f32_16x16x32_bf16 v[52:55], v[100:103], v[140:143], v[52:55]
    ds_read_b128 v[124:127], v19 offset:3072
    v_mfma_f32_16x16x32_bf16 v[56:59], v[104:107], v[140:143], v[56:59]
    ds_read_b128 v[128:131], v19 offset:4096
    v_mfma_f32_16x16x32_bf16 v[64:67], v[100:103], v[144:147], v[64:67]
    s_add_u32 m0, s34, 0x17800
    s_nop 0
    buffer_load_dwordx4 v8, s[8:11], s32 offen lds
    v_mfma_f32_16x16x32_bf16 v[68:71], v[104:107], v[144:147], v[68:71]
    s_add_u32 m0, s34, 0x17c00
    s_nop 0
    buffer_load_dwordx4 v9, s[8:11], s32 offen lds
    v_mfma_f32_16x16x32_bf16 v[76:79], v[100:103], v[148:151], v[76:79]
    s_add_u32 m0, s34, 0x18000
    s_nop 0
    buffer_load_dwordx4 v10, s[8:11], s32 offen lds
    v_mfma_f32_16x16x32_bf16 v[80:83], v[104:107], v[148:151], v[80:83]
    s_add_u32 s35, s35, 1
    s_cmp_lt_u32 s35, 7
    s_cbranch_scc1 LB_loop1
    s_waitcnt lgkmcnt(0)
    v_mfma_f32_16x16x32_bf16 v[28:31], v[88:91], v[112:115], v[28:31]
    ds_read_b64_tr_b16 v[100:101], v16 offset:10240
    ds_read_b64_tr_b16 v[102:103], v16 offset:11520
    v_mfma_f32_16x16x32_bf16 v[32:35], v[92:95], v[112:115], v[32:35]
    ds_read_b64_tr_b16 v[104:105], v17 offset:10240
    ds_read_b64_tr_b16 v[106:107], v17 offset:11520
    v_mfma_f32_16x16x32_bf16 v[40:43], v[88:91], v[116:119], v[40:43]
    ds_read_b128 v[132:135], v19 offset:9216
    ds_read_b128 v[136:139], v19 offset:10240
    v_mfma_f32_16x16x32_bf16 v[44:47], v[92:95], v[116:119], v[44:47]
    ds_read_b128 v[140:143], v19 offset:11264
    v_mfma_f32_16x16x32_bf16 v[52:55], v[88:91], v[120:123], v[52:55]
    ds_read_b128 v[144:147], v19 offset:12288
    v_mfma_f32_16x16x32_bf16 v[56:59], v[92:95], v[120:123], v[56:59]
    ds_read_b128 v[148:151], v19 offset:13312
    v_mfma_f32_16x16x32_bf16 v[64:67], v[88:91], v[124:127], v[64:67]
    s_add_u32 m0, s34, 0x18400
    s_nop 0
    buffer_load_dwordx4 v11, s[8:11], s32 offen lds
    v_mfma_f32_16x16x32_bf16 v[68:71], v[92:95], v[124:127], v[68:71]
    s_add_u32 m0, s34, 0x18800
    s_nop 0
    buffer_load_dwordx4 v12, s[8:11], s32 offen lds
    v_mfma_f32_16x16x32_bf16 v[76:79], v[88:91], v[128:131], v[76:79]
    s_add_u32 s32, s32, 81920
    s_cmp_ge_u32 s32, 1966080
    s_cselect_b32 s32, 0, s32
    v_mfma_f32_16x16x32_bf16 v[80:83], v[92:95], v[128:131], v[80:83]
    s_waitcnt vmcnt(5) lgkmcnt(0)
    s_barrier
    v_mfma_f32_16x16x32_bf16 v[28:31], v[100:103], v[132:135], v[28:31]
    ds_read_b64_tr_b16 v[88:89], v20 offset:0
    ds_read_b64_tr_b16 v[90:91], v20 offset:1280
    v_mfma_f32_16x16x32_bf16 v[32:35], v[104:107], v[132:135], v[32:35]
    ds_read_b64_tr_b16 v[92:93], v21 offset:0
    ds_read_b64_tr_b16 v[94:95], v21 offset:1280
    v_mfma_f32_16x16x32_bf16 v[40:43], v[100:103], v[136:139], v[40:43]
    ds_read_b128 v[112:115], v23 offset:0
    ds_read_b128 v[116:119], v23 offset:1024
    v_mfma_f32_16x16x32_bf16 v[44:47], v[104:107], v[136:139], v[44:47]
    ds_read_b128 v[120:123], v23 offset:2048
    v_mfma_f32_16x16x32_bf16 v[52:55], v[100:103], v[140:143], v[52:55]
    ds_read_b128 v[124:127], v23 offset:3072
    v_mfma_f32_16x16x32_bf16 v[56:59], v[104:107], v[140:143], v[56:59]
    ds_read_b128 v[128:131], v23 offset:4096
    v_mfma_f32_16x16x32_bf16 v[64:67], v[100:103], v[144:147], v[64:67]
    v_mfma_f32_16x16x32_bf16 v[68:71], v[104:107], v[144:147], v[68:71]
    v_mfma_f32_16x16x32_bf16 v[76:79], v[100:103], v[148:151], v[76:79]
    v_mfma_f32_16x16x32_bf16 v[80:83], v[104:107], v[148:151], v[80:83]
    s_waitcnt lgkmcnt(0)
    v_mfma_f32_16x16x32_bf16 v[28:31], v[88:91], v[112:115], v[28:31]
    ds_read_b64_tr_b16 v[100:101], v20 offset:10240
    ds_read_b64_tr_b16 v[102:103], v20 offset:11520
    v_mfma_f32_16x16x32_bf16 v[32:35], v[92:95], v[112:115], v[32:35]
    ds_read_b64_tr_b16 v[104:105], v21 offset:10240
    ds_read_b64_tr_b16 v[106:107], v21 offset:11520
    v_mfma_f32_16x16x32_bf16 v[40:43], v[88:91], v[116:119], v[40:43]
    ds_read_b128 v[132:135], v23 offset:9216
    ds_read_b128 v[136:139], v23 offset:10240
    v_mfma_f32_16x16x32_bf16 v[44:47], v[92:95], v[116:119], v[44:47]
    ds_read_b128 v[140:143], v23 offset:11264
    v_mfma_f32_16x16x32_bf16 v[52:55], v[88:91], v[120:123], v[52:55]
    ds_read_b128 v[144:147], v23 offset:12288
    v_mfma_f32_16x16x32_bf16 v[56:59], v[92:95], v[120:123], v[56:59]
    ds_read_b128 v[148:151], v23 offset:13312
    v_mfma_f32_16x16x32_bf16 v[64:67], v[88:91], v[124:127], v[64:67]
    v_mfma_f32_16x16x32_bf16 v[68:71], v[92:95], v[124:127], v[68:71]
    v_mfma_f32_16x16x32_bf16 v[76:79], v[88:91], v[128:131], v[76:79]
    v_mfma_f32_16x16x32_bf16 v[80:83], v[92:95], v[128:131], v[80:83]
    s_waitcnt vmcnt(0) lgkmcnt(0)
    s_barrier
    v_mfma_f32_16x16x32_bf16 v[28:31], v[100:103], v[132:135], v[28:31]
    ds_read_b64_tr_b16 v[88:89], v24 offset:0
    ds_read_b64_tr_b16 v[90:91], v24 offset:1280
    v_mfma_f32_16x16x32_bf16 v[32:35], v[104:107], v[132:135], v[32:35]
    ds_read_b64_tr_b16 v[92:93], v25 offset:0
    ds_read_b64_tr_b16 v[94:95], v25 offset:1280
    v_mfma_f32_16x16x32_bf16 v[40:43], v[100:103], v[136:139], v[40:43]
    ds_read_b128 v[112:115], v27 offset:0
    ds_read_b128 v[116:119], v27 offset:1024
    v_mfma_f32_16x16x32_bf16 v[44:47], v[104:107], v[136:139], v[44:47]
    ds_read_b128 v[120:123], v27 offset:2048
    v_mfma_f32_16x16x32_bf16 v[52:55], v[100:103], v[140:143], v[52:55]
    ds_read_b128 v[124:127], v27 offset:3072
    v_mfma_f32_16x16x32_bf16 v[56:59], v[104:107], v[140:143], v[56:59]
    ds_read_b128 v[128:131], v27 offset:4096
    v_mfma_f32_16x16x32_bf16 v[64:67], v[100:103], v[144:147], v[64:67]
    v_mfma_f32_16x16x32_bf16 v[68:71], v[104:107], v[144:147], v[68:71]
    v_mfma_f32_16x16x32_bf16 v[76:79], v[100:103], v[148:151], v[76:79]
    v_mfma_f32_16x16x32_bf16 v[80:83], v[104:107], v[148:151], v[80:83]
    s_waitcnt lgkmcnt(0)
    v_mfma_f32_16x16x32_bf16 v[28:31], v[88:91], v[112:115], v[28:31]
    ds_read_b64_tr_b16 v[100:101], v24 offset:10240
    ds_read_b64_tr_b16 v[102:103], v24 offset:11520
    v_mfma_f32_16x16x32_bf16 v[32:35], v[92:95], v[112:115], v[32:35]
    ds_read_b64_tr_b16 v[104:105], v25 offset:10240
    ds_read_b64_tr_b16 v[106:107], v25 offset:11520
    v_mfma_f32_16x16x32_bf16 v[40:43], v[88:91], v[116:119], v[40:43]
    ds_read_b128 v[132:135], v27 offset:9216
    ds_read_b128 v[136:139], v27 offset:10240
    v_mfma_f32_16x16x32_bf16 v[44:47], v[92:95], v[116:119], v[44:47]
    ds_read_b128 v[140:143], v27 offset:11264
    v_mfma_f32_16x16x32_bf16 v[52:55], v[88:91], v[120:123], v[52:55]
    ds_read_b128 v[144:147], v27 offset:12288
    v_mfma_f32_16x16x32_bf16 v[56:59], v[92:95], v[120:123], v[56:59]
    ds_read_b128 v[148:151], v27 offset:13312
    v_mfma_f32_16x16x32_bf16 v[64:67], v[88:91], v[124:127], v[64:67]
    v_mfma_f32_16x16x32_bf16 v[68:71], v[92:95], v[124:127], v[68:71]
    v_mfma_f32_16x16x32_bf16 v[76:79], v[88:91], v[128:131], v[76:79]
    v_mfma_f32_16x16x32_bf16 v[80:83], v[92:95], v[128:131], v[80:83]
    s_waitcnt vmcnt(0) lgkmcnt(0)
    s_barrier
    v_mfma_f32_16x16x32_bf16 v[28:31], v[100:103], v[132:135], v[28:31]
    v_mfma_f32_16x16x32_bf16 v[32:35], v[104:107], v[132:135], v[32:35]
    v_mfma_f32_16x16x32_bf16 v[40:43], v[100:103], v[136:139], v[40:43]
    v_mfma_f32_16x16x32_bf16 v[44:47], v[104:107], v[136:139], v[44:47]
    v_mfma_f32_16x16x32_bf16 v[52:55], v[100:103], v[140:143], v[52:55]
    v_mfma_f32_16x16x32_bf16 v[56:59], v[104:107], v[140:143], v[56:59]
    v_mfma_f32_16x16x32_bf16 v[64:67], v[100:103], v[144:147], v[64:67]
    v_mfma_f32_16x16x32_bf16 v[68:71], v[104:107], v[144:147], v[68:71]
    v_mfma_f32_16x16x32_bf16 v[76:79], v[100:103], v[148:151], v[76:79]
    v_mfma_f32_16x16x32_bf16 v[80:83], v[104:107], v[148:151], v[80:83]
    s_nop 7
    s_lshl_b32 s27, s24, 13
    v_add_u32 v4, s27, v1
    s_mul_i32 s28, s37, 65536
    s_cmp_eq_u32 s37, 0
    s_cbranch_scc1 LB_ps_56
    s_add_u32 s30, s28, 0
    v_cvt_pk_bf16_f32 v88, v28, v29
    v_cvt_pk_bf16_f32 v89, v30, v31
    v_cvt_pk_bf16_f32 v90, v52, v53
    v_cvt_pk_bf16_f32 v91, v54, v55
    buffer_store_dwordx4 v[88:91], v4, s[12:15], s30 offen offset:0 sc1
    v_cvt_pk_bf16_f32 v92, v76, v77
    v_cvt_pk_bf16_f32 v93, v78, v79
    buffer_store_dwordx4 v[92:95], v4, s[12:15], s30 offen offset:1024 sc1
LB_ps_56:
    s_cmp_eq_u32 s37, 1
    s_cbranch_scc1 LB_ps_57
    s_add_u32 s30, s28, 2048
    v_cvt_pk_bf16_f32 v96, v32, v33
    v_cvt_pk_bf16_f32 v97, v34, v35
    v_cvt_pk_bf16_f32 v98, v56, v57
    v_cvt_pk_bf16_f32 v99, v58, v59
    buffer_store_dwordx4 v[96:99], v4, s[12:15], s30 offen offset:0 sc1
    v_cvt_pk_bf16_f32 v100, v80, v81
    v_cvt_pk_bf16_f32 v101, v82, v83
    buffer_store_dwordx4 v[100:103], v4, s[12:15], s30 offen offset:1024 sc1
LB_ps_57:
    s_cmp_eq_u32 s37, 2
    s_cbranch_scc1 LB_ps_58
    s_add_u32 s30, s28, 4096
    v_cvt_pk_bf16_f32 v104, v40, v41
    v_cvt_pk_bf16_f32 v105, v42, v43
    v_cvt_pk_bf16_f32 v106, v64, v65
    v_cvt_pk_bf16_f32 v107, v66, v67
    buffer_store_dwordx4 v[104:107], v4, s[12:15], s30 offen offset:0 sc1
LB_ps_58:
    s_cmp_eq_u32 s37, 3
    s_cbranch_scc1 LB_ps_59
    s_add_u32 s30, s28, 6144
    v_cvt_pk_bf16_f32 v112, v44, v45
    v_cvt_pk_bf16_f32 v113, v46, v47
    v_cvt_pk_bf16_f32 v114, v68, v69
    v_cvt_pk_bf16_f32 v115, v70, v71
    buffer_store_dwordx4 v[112:115], v4, s[12:15], s30 offen offset:0 sc1
LB_ps_59:
    v_and_b32 v5, 15, v0
    v_mul_u32_u24 v5, 0xa00, v5
    v_lshrrev_b32 v6, 4, v0
    v_lshl_add_u32 v5, v6, 3, v5
    s_lshl_b32 s27, s45, 5
    v_add_u32 v5, s27, v5
    s_waitcnt vmcnt(0)
    s_barrier
    s_barrier
    s_cmp_eq_u32 s37, 0
    s_cbranch_scc0 LB_pr_60
    s_add_u32 s30, s52, 0
    buffer_load_dwordx4 v[88:91], v4, s[12:15], s30 offen offset:0 sc1
    s_add_u32 s30, s53, 0
    buffer_load_dwordx4 v[92:95], v4, s[12:15], s30 offen offset:0 sc1
    s_add_u32 s30, s54, 0
    buffer_load_dwordx4 v[96:99], v4, s[12:15], s30 offen offset:0 sc1
    s_add_u32 s30, s52, 0
    buffer_load_dwordx4 v[100:103], v4, s[12:15], s30 offen offset:1024 sc1
    s_add_u32 s30, s53, 0
    buffer_load_dwordx4 v[104:107], v4, s[12:15], s30 offen offset:1024 sc1
    s_add_u32 s30, s54, 0
    buffer_load_dwordx4 v[108:111], v4, s[12:15], s30 offen offset:1024 sc1
    s_waitcnt vmcnt(3)
    v_lshlrev_b32 v6, 16, v88
    v_and_b32 v7, 0xffff0000, v88
    v_add_f32 v28, v28, v6
    v_add_f32 v29, v29, v7
    v_lshlrev_b32 v6, 16, v89
    v_and_b32 v7, 0xffff0000, v89
    v_add_f32 v30, v30, v6
    v_add_f32 v31, v31, v7
    v_lshlrev_b32 v6, 16, v92
    v_and_b32 v7, 0xffff0000, v92
    v_add_f32 v28, v28, v6
    v_add_f32 v29, v29, v7
    v_lshlrev_b32 v6, 16, v93
    v_and_b32 v7, 0xffff0000, v93
    v_add_f32 v30, v30, v6
    v_add_f32 v31, v31, v7
    v_lshlrev_b32 v6, 16, v96
    v_and_b32 v7, 0xffff0000, v96
    v_add_f32 v28, v28, v6
    v_add_f32 v29, v29, v7
    v_lshlrev_b32 v6, 16, v97
    v_and_b32 v7, 0xffff0000, v97
    v_add_f32 v30, v30, v6
    v_add_f32 v31, v31, v7
    v_cvt_pk_bf16_f32 v28, v28, v29
    v_cvt_pk_bf16_f32 v29, v30, v31
    s_mov_b32 s30, 0
    buffer_store_dwordx2 v[28:29], v5, s[16:19], s30 offen offset:0
    v_lshlrev_b32 v6, 16, v90
    v_and_b32 v7, 0xffff0000, v90
    v_add_f32 v52, v52, v6
    v_add_f32 v53, v53, v7
    v_lshlrev_b32 v6, 16, v91
    v_and_b32 v7, 0xffff0000, v91
    v_add_f32 v54, v54, v6
    v_add_f32 v55, v55, v7
    v_lshlrev_b32 v6, 16, v94
    v_and_b32 v7, 0xffff0000, v94
    v_add_f32 v52, v52, v6
    v_add_f32 v53, v53, v7
    v_lshlrev_b32 v6, 16, v95
    v_and_b32 v7, 0xffff0000, v95
    v_add_f32 v54, v54, v6
    v_add_f32 v55, v55, v7
    v_lshlrev_b32 v6, 16, v98
    v_and_b32 v7, 0xffff0000, v98
    v_add_f32 v52, v52, v6
    v_add_f32 v53, v53, v7
    v_lshlrev_b32 v6, 16, v99
    v_and_b32 v7, 0xffff0000, v99
    v_add_f32 v54, v54, v6
    v_add_f32 v55, v55, v7
    v_cvt_pk_bf16_f32 v52, v52, v53
    v_cvt_pk_bf16_f32 v53, v54, v55
    s_mov_b32 s30, 81920
    buffer_store_dwordx2 v[52:53], v5, s[16:19], s30 offen offset:0
    s_waitcnt vmcnt(2)
    v_lshlrev_b32 v6, 16, v100
    v_and_b32 v7, 0xffff0000, v100
    v_add_f32 v76, v76, v6
    v_add_f32 v77, v77, v7
    v_lshlrev_b32 v6, 16, v101
    v_and_b32 v7, 0xffff0000, v101
    v_add_f32 v78, v78, v6
    v_add_f32 v79, v79, v7
    v_lshlrev_b32 v6, 16, v104
    v_and_b32 v7, 0xffff0000, v104
    v_add_f32 v76, v76, v6
    v_add_f32 v77, v77, v7
    v_lshlrev_b32 v6, 16, v105
    v_and_b32 v7, 0xffff0000, v105
    v_add_f32 v78, v78, v6
    v_add_f32 v79, v79, v7
    v_lshlrev_b32 v6, 16, v108
    v_and_b32 v7, 0xffff0000, v108
    v_add_f32 v76, v76, v6
    v_add_f32 v77, v77, v7
    v_lshlrev_b32 v6, 16, v109
    v_and_b32 v7, 0xffff0000, v109
    v_add_f32 v78, v78, v6
    v_add_f32 v79, v79, v7
    v_cvt_pk_bf16_f32 v76, v76, v77
    v_cvt_pk_bf16_f32 v77, v78, v79
    s_mov_b32 s30, 163840
    buffer_store_dwordx2 v[76:77], v5, s[16:19], s30 offen offset:0
LB_pr_60:
    s_cmp_eq_u32 s37, 1
    s_cbranch_scc0 LB_pr_61
    s_add_u32 s30, s52, 2048
    buffer_load_dwordx4 v[88:91], v4, s[12:15], s30 offen offset:0 sc1
    s_add_u32 s30, s53, 2048
    buffer_load_dwordx4 v[92:95], v4, s[12:15], s30 offen offset:0 sc1
    s_add_u32 s30, s54, 2048
    buffer_load_dwordx4 v[96:99], v4, s[12:15], s30 offen offset:0 sc1
    s_add_u32 s30, s52, 2048
    buffer_load_dwordx4 v[100:103], v4, s[12:15], s30 offen offset:1024 sc1
    s_add_u32 s30, s53, 2048
    buffer_load_dwordx4 v[104:107], v4, s[12:15], s30 offen offset:1024 sc1
    s_add_u32 s30, s54, 2048
    buffer_load_dwordx4 v[108:111], v4, s[12:15], s30 offen offset:1024 sc1
    s_waitcnt vmcnt(3)
    v_lshlrev_b32 v6, 16, v88
    v_and_b32 v7, 0xffff0000, v88
    v_add_f32 v32, v32, v6
    v_add_f32 v33, v33, v7
    v_lshlrev_b32 v6, 16, v89
    v_and_b32 v7, 0xffff0000, v89
    v_add_f32 v34, v34, v6
    v_add_f32 v35, v35, v7
    v_lshlrev_b32 v6, 16, v92
    v_and_b32 v7, 0xffff0000, v92
    v_add_f32 v32, v32, v6
    v_add_f32 v33, v33, v7
    v_lshlrev_b32 v6, 16, v93
    v_and_b32 v7, 0xffff0000, v93
    v_add_f32 v34, v34, v6
    v_add_f32 v35, v35, v7
    v_lshlrev_b32 v6, 16, v96
    v_and_b32 v7, 0xffff0000, v96
    v_add_f32 v32, v32, v6
    v_add_f32 v33, v33, v7
    v_lshlrev_b32 v6, 16, v97
    v_and_b32 v7, 0xffff0000, v97
    v_add_f32 v34, v34, v6
    v_add_f32 v35, v35, v7
    v_cvt_pk_bf16_f32 v32, v32, v33
    v_cvt_pk_bf16_f32 v33, v34, v35
    s_mov_b32 s30, 0
    buffer_store_dwordx2 v[32:33], v5, s[16:19], s30 offen offset:32
    v_lshlrev_b32 v6, 16, v90
    v_and_b32 v7, 0xffff0000, v90
    v_add_f32 v56, v56, v6
    v_add_f32 v57, v57, v7
    v_lshlrev_b32 v6, 16, v91
    v_and_b32 v7, 0xffff0000, v91
    v_add_f32 v58, v58, v6
    v_add_f32 v59, v59, v7
    v_lshlrev_b32 v6, 16, v94
    v_and_b32 v7, 0xffff0000, v94
    v_add_f32 v56, v56, v6
    v_add_f32 v57, v57, v7
    v_lshlrev_b32 v6, 16, v95
    v_and_b32 v7, 0xffff0000, v95
    v_add_f32 v58, v58, v6
    v_add_f32 v59, v59, v7
    v_lshlrev_b32 v6, 16, v98
    v_and_b32 v7, 0xffff0000, v98
    v_add_f32 v56, v56, v6
    v_add_f32 v57, v57, v7
    v_lshlrev_b32 v6, 16, v99
    v_and_b32 v7, 0xffff0000, v99
    v_add_f32 v58, v58, v6
    v_add_f32 v59, v59, v7
    v_cvt_pk_bf16_f32 v56, v56, v57
    v_cvt_pk_bf16_f32 v57, v58, v59
    s_mov_b32 s30, 81920
    buffer_store_dwordx2 v[56:57], v5, s[16:19], s30 offen offset:32
    s_waitcnt vmcnt(2)
    v_lshlrev_b32 v6, 16, v100
    v_and_b32 v7, 0xffff0000, v100
    v_add_f32 v80, v80, v6
    v_add_f32 v81, v81, v7
    v_lshlrev_b32 v6, 16, v101
    v_and_b32 v7, 0xffff0000, v101
    v_add_f32 v82, v82, v6
    v_add_f32 v83, v83, v7
    v_lshlrev_b32 v6, 16, v104
    v_and_b32 v7, 0xffff0000, v104
    v_add_f32 v80, v80, v6
    v_add_f32 v81, v81, v7
    v_lshlrev_b32 v6, 16, v105
    v_and_b32 v7, 0xffff0000, v105
    v_add_f32 v82, v82, v6
    v_add_f32 v83, v83, v7
    v_lshlrev_b32 v6, 16, v108
    v_and_b32 v7, 0xffff0000, v108
    v_add_f32 v80, v80, v6
    v_add_f32 v81, v81, v7
    v_lshlrev_b32 v6, 16, v109
    v_and_b32 v7, 0xffff0000, v109
    v_add_f32 v82, v82, v6
    v_add_f32 v83, v83, v7
    v_cvt_pk_bf16_f32 v80, v80, v81
    v_cvt_pk_bf16_f32 v81, v82, v83
    s_mov_b32 s30, 163840
    buffer_store_dwordx2 v[80:81], v5, s[16:19], s30 offen offset:32
LB_pr_61:
    s_cmp_eq_u32 s37, 2
    s_cbranch_scc0 LB_pr_62
    s_add_u32 s30, s52, 4096
    buffer_load_dwordx4 v[88:91], v4, s[12:15], s30 offen offset:0 sc1
    s_add_u32 s30, s53, 4096
    buffer_load_dwordx4 v[92:95], v4, s[12:15], s30 offen offset:0 sc1
    s_add_u32 s30, s54, 4096
    buffer_load_dwordx4 v[96:99], v4, s[12:15], s30 offen offset:0 sc1
    s_waitcnt vmcnt(0)
    v_lshlrev_b32 v6, 16, v88
    v_and_b32 v7, 0xffff0000, v88
    v_add_f32 v40, v40, v6
    v_add_f32 v41, v41, v7
    v_lshlrev_b32 v6, 16, v89
    v_and_b32 v7, 0xffff0000, v89
    v_add_f32 v42, v42, v6
    v_add_f32 v43, v43, v7
    v_lshlrev_b32 v6, 16, v92
    v_and_b32 v7, 0xffff0000, v92
    v_add_f32 v40, v40, v6
    v_add_f32 v41, v41, v7
    v_lshlrev_b32 v6, 16, v93
    v_and_b32 v7, 0xffff0000, v93
    v_add_f32 v42, v42, v6
    v_add_f32 v43, v43, v7
    v_lshlrev_b32 v6, 16, v96
    v_and_b32 v7, 0xffff0000, v96
    v_add_f32 v40, v40, v6
    v_add_f32 v41, v41, v7
    v_lshlrev_b32 v6, 16, v97
    v_and_b32 v7, 0xffff0000, v97
    v_add_f32 v42, v42, v6
    v_add_f32 v43, v43, v7
    v_cvt_pk_bf16_f32 v40, v40, v41
    v_cvt_pk_bf16_f32 v41, v42, v43
    s_mov_b32 s30, 40960
    buffer_store_dwordx2 v[40:41], v5, s[16:19], s30 offen offset:0
    v_lshlrev_b32 v6, 16, v90
    v_and_b32 v7, 0xffff0000, v90
    v_add_f32 v64, v64, v6
    v_add_f32 v65, v65, v7
    v_lshlrev_b32 v6, 16, v91
    v_and_b32 v7, 0xffff0000, v91
    v_add_f32 v66, v66, v6
    v_add_f32 v67, v67, v7
    v_lshlrev_b32 v6, 16, v94
    v_and_b32 v7, 0xffff0000, v94
    v_add_f32 v64, v64, v6
    v_add_f32 v65, v65, v7
    v_lshlrev_b32 v6, 16, v95
    v_and_b32 v7, 0xffff0000, v95
    v_add_f32 v66, v66, v6
    v_add_f32 v67, v67, v7
    v_lshlrev_b32 v6, 16, v98
    v_and_b32 v7, 0xffff0000, v98
    v_add_f32 v64, v64, v6
    v_add_f32 v65, v65, v7
    v_lshlrev_b32 v6, 16, v99
    v_and_b32 v7, 0xffff0000, v99
    v_add_f32 v66, v66, v6
    v_add_f32 v67, v67, v7
    v_cvt_pk_bf16_f32 v64, v64, v65
    v_cvt_pk_bf16_f32 v65, v66, v67
    s_mov_b32 s30, 122880
    buffer_store_dwordx2 v[64:65], v5, s[16:19], s30 offen offset:0
LB_pr_62:
    s_cmp_eq_u32 s37, 3
    s_cbranch_scc0 LB_pr_63
    s_add_u32 s30, s52, 6144
    buffer_load_dwordx4 v[88:91], v4, s[12:15], s30 offen offset:0 sc1
    s_add_u32 s30, s53, 6144
    buffer_load_dwordx4 v[92:95], v4, s[12:15], s30 offen offset:0 sc1
    s_add_u32 s30, s54, 6144
    buffer_load_dwordx4 v[96:99], v4, s[12:15], s30 offen offset:0 sc1
    s_waitcnt vmcnt(0)
    v_lshlrev_b32 v6, 16, v88
    v_and_b32 v7, 0xffff0000, v88
    v_add_f32 v44, v44, v6
    v_add_f32 v45, v45, v7
    v_lshlrev_b32 v6, 16, v89
    v_and_b32 v7, 0xffff0000, v89
    v_add_f32 v46, v46, v6
    v_add_f32 v47, v47, v7
    v_lshlrev_b32 v6, 16, v92
    v_and_b32 v7, 0xffff0000, v92
    v_add_f32 v44, v44, v6
    v_add_f32 v45, v45, v7
    v_lshlrev_b32 v6, 16, v93
    v_and_b32 v7, 0xffff0000, v93
    v_add_f32 v46, v46, v6
    v_add_f32 v47, v47, v7
    v_lshlrev_b32 v6, 16, v96
    v_and_b32 v7, 0xffff0000, v96
    v_add_f32 v44, v44, v6
    v_add_f32 v45, v45, v7
    v_lshlrev_b32 v6, 16, v97
    v_and_b32 v7, 0xffff0000, v97
    v_add_f32 v46, v46, v6
    v_add_f32 v47, v47, v7
    v_cvt_pk_bf16_f32 v44, v44, v45
    v_cvt_pk_bf16_f32 v45, v46, v47
    s_mov_b32 s30, 40960
    buffer_store_dwordx2 v[44:45], v5, s[16:19], s30 offen offset:32
    v_lshlrev_b32 v6, 16, v90
    v_and_b32 v7, 0xffff0000, v90
    v_add_f32 v68, v68, v6
    v_add_f32 v69, v69, v7
    v_lshlrev_b32 v6, 16, v91
    v_and_b32 v7, 0xffff0000, v91
    v_add_f32 v70, v70, v6
    v_add_f32 v71, v71, v7
    v_lshlrev_b32 v6, 16, v94
    v_and_b32 v7, 0xffff0000, v94
    v_add_f32 v68, v68, v6
    v_add_f32 v69, v69, v7
    v_lshlrev_b32 v6, 16, v95
    v_and_b32 v7, 0xffff0000, v95
    v_add_f32 v70, v70, v6
    v_add_f32 v71, v71, v7
    v_lshlrev_b32 v6, 16, v98
    v_and_b32 v7, 0xffff0000, v98
    v_add_f32 v68, v68, v6
    v_add_f32 v69, v69, v7
    v_lshlrev_b32 v6, 16, v99
    v_and_b32 v7, 0xffff0000, v99
    v_add_f32 v70, v70, v6
    v_add_f32 v71, v71, v7
    v_cvt_pk_bf16_f32 v68, v68, v69
    v_cvt_pk_bf16_f32 v69, v70, v71
    s_mov_b32 s30, 122880
    buffer_store_dwordx2 v[68:69], v5, s[16:19], s30 offen offset:32
LB_pr_63:
    s_endpgm
LB_v2:
    s_add_u32 m0, s33, 0x0
    s_add_u32 s30, s31, 0x0
    buffer_load_dwordx4 v13, s[4:7], s30 offen lds
    s_add_u32 m0, s33, 0x400
    s_add_u32 s30, s31, 0x400
    buffer_load_dwordx4 v13, s[4:7], s30 offen lds
    s_add_u32 m0, s33, 0x800
    s_add_u32 s30, s31, 0x800
    buffer_load_dwordx4 v13, s[4:7], s30 offen lds
    s_add_u32 m0, s33, 0xc00
    s_add_u32 s30, s31, 0xc00
    buffer_load_dwordx4 v13, s[4:7], s30 offen lds
    s_add_u32 m0, s33, 0x1000
    s_add_u32 s30, s31, 0x1000
    s_mov_b32 exec_hi, 0
    buffer_load_dwordx4 v13, s[4:7], s30 offen lds
    s_mov_b32 exec_hi, -1
    s_add_u32 s31, s31, 18432
    s_cmp_ge_u32 s31, 442368
    s_cselect_b32 s31, 0, s31
    s_add_u32 m0, s33, 0x9800
    s_add_u32 s30, s31, 0x0
    buffer_load_dwordx4 v13, s[4:7], s30 offen lds
    s_add_u32 m0, s33, 0x9c00
    s_add_u32 s30, s31, 0x400
    buffer_load_dwordx4 v13, s[4:7], s30 offen lds
    s_add_u32 m0, s33, 0xa000
    s_add_u32 s30, s31, 0x800
    buffer_load_dwordx4 v13, s[4:7], s30 offen lds
    s_add_u32 m0, s33, 0xa400
    s_add_u32 s30, s31, 0xc00
    buffer_load_dwordx4 v13, s[4:7], s30 offen lds
    s_add_u32 m0, s33, 0xa800
    s_add_u32 s30, s31, 0x1000
    s_mov_b32 exec_hi, 0
    buffer_load_dwordx4 v13, s[4:7], s30 offen lds
    s_mov_b32 exec_hi, -1
    s_add_u32 s31, s31, 18432
    s_cmp_ge_u32 s31, 442368
    s_cselect_b32 s31, 0, s31
    v_mul_u32_u24 v6, 0xa00, v4
    v_bfe_u32 v7, v0, 2, 2
    v_lshl_add_u32 v6, v7, 6, v6
    v_and_b32 v7, 3, v0
    v_lshl_add_u32 v6, v7, 3, v6
    s_add_u32 s30, s45, 0
    v_xor_b32 v7, s30, v4
    v_and_b32 v7, 1, v7
    v_lshl_add_u32 v16, v7, 5, v6
    s_lshr_b32 s30, s30, 1
    s_lshl_b32 s30, s30, 8
    s_add_u32 s30, s30, 0x4800
    v_add_u32 v16, s30, v16
    s_add_u32 s30, s45, 1
    v_xor_b32 v7, s30, v4
    v_and_b32 v7, 1, v7
    v_lshl_add_u32 v17, v7, 5, v6
    s_lshr_b32 s30, s30, 1
    s_lshl_b32 s30, s30, 8
    s_add_u32 s30, s30, 0x4800
    v_add_u32 v17, s30, v17
    s_add_u32 s30, s45, 2
    v_xor_b32 v7, s30, v4
    v_and_b32 v7, 1, v7
    v_lshl_add_u32 v18, v7, 5, v6
    s_lshr_b32 s30, s30, 1
    s_lshl_b32 s30, s30, 8
    s_add_u32 s30, s30, 0x4800
    v_add_u32 v18, s30, v18
    v_mov_b32 v19, v1
    v_add_u32 v20, 0x9800, v16
    v_add_u32 v21, 0x9800, v17
    v_add_u32 v22, 0x9800, v18
    v_add_u32 v23, 0x9800, v19
    v_add_u32 v24, 0x13000, v16
    v_add_u32 v25, 0x13000, v17
    v_add_u32 v26, 0x13000, v18
    v_add_u32 v27, 0x13000, v19
    v_mov_b32 v28, 0
    v_mov_b32 v29, 0
    v_mov_b32 v30, 0
    v_mov_b32 v31, 0
    v_mov_b32 v32, 0
    v_mov_b32 v33, 0
    v_mov_b32 v34, 0
    v_mov_b32 v35, 0
    v_mov_b32 v36, 0
    v_mov_b32 v37, 0
    v_mov_b32 v38, 0
    v_mov_b32 v39, 0
    v_mov_b32 v40, 0
    v_mov_b32 v41, 0
    v_mov_b32 v42, 0
    v_mov_b32 v43, 0
    v_mov_b32 v44, 0
    v_mov_b32 v45, 0
    v_mov_b32 v46, 0
    v_mov_b32 v47, 0
    v_mov_b32 v48, 0
    v_mov_b32 v49, 0
    v_mov_b32 v50, 0
    v_mov_b32 v51, 0
    v_mov_b32 v52, 0
    v_mov_b32 v53, 0
    v_mov_b32 v54, 0
    v_mov_b32 v55, 0
    v_mov_b32 v56, 0
    v_mov_b32 v57, 0
    v_mov_b32 v58, 0
    v_mov_b32 v59, 0
    v_mov_b32 v60, 0
    v_mov_b32 v61, 0
    v_mov_b32 v62, 0
    v_mov_b32 v63, 0
    v_mov_b32 v64, 0
    v_mov_b32 v65, 0
    v_mov_b32 v66, 0
    v_mov_b32 v67, 0
    v_mov_b32 v68, 0
    v_mov_b32 v69, 0
    v_mov_b32 v70, 0
    v_mov_b32 v71, 0
    v_mov_b32 v72, 0
    v_mov_b32 v73, 0
    v_mov_b32 v74, 0
    v_mov_b32 v75, 0
    v_mov_b32 v76, 0
    v_mov_b32 v77, 0
    v_mov_b32 v78, 0
    v_mov_b32 v79, 0
    v_mov_b32 v80, 0
    v_mov_b32 v81, 0
    v_mov_b32 v82, 0
    v_mov_b32 v83, 0
    v_mov_b32 v84, 0
    v_mov_b32 v85, 0
    v_mov_b32 v86, 0
    v_mov_b32 v87, 0
    s_waitcnt vmcnt(5)
    s_barrier
    ds_read_b64_tr_b16 v[88:89], v16 offset:0
    ds_read_b64_tr_b16 v[90:91], v16 offset:1280
    ds_read_b64_tr_b16 v[92:93], v17 offset:0
    ds_read_b64_tr_b16 v[94:95], v17 offset:1280
    ds_read_b128 v[112:115], v19 offset:5120
    ds_read_b128 v[116:119], v19 offset:6144
    ds_read_b128 v[120:123], v19 offset:7168
    ds_read_b128 v[124:127], v19 offset:8192
    s_add_u32 m0, s33, 0x13000
    s_add_u32 s30, s31, 0x0
    buffer_load_dwordx4 v13, s[4:7], s30 offen lds
    s_add_u32 m0, s33, 0x13400
    s_add_u32 s30, s31, 0x400
    buffer_load_dwordx4 v13, s[4:7], s30 offen lds
    s_add_u32 m0, s33, 0x13800
    s_add_u32 s30, s31, 0x800
    buffer_load_dwordx4 v13, s[4:7], s30 offen lds
    s_mov_b32 s35, 0
LB_loop2:
    s_waitcnt lgkmcnt(0)
    v_mfma_f32_16x16x32_bf16 v[28:31], v[88:91], v[112:115], v[28:31]
    ds_read_b64_tr_b16 v[100:101], v16 offset:10240
    ds_read_b64_tr_b16 v[102:103], v16 offset:11520
    v_mfma_f32_16x16x32_bf16 v[32:35], v[92:95], v[112:115], v[32:35]
    ds_read_b64_tr_b16 v[104:105], v17 offset:10240
    ds_read_b64_tr_b16 v[106:107], v17 offset:11520
    v_mfma_f32_16x16x32_bf16 v[40:43], v[88:91], v[116:119], v[40:43]
    ds_read_b128 v[132:135], v19 offset:14336
    ds_read_b128 v[136:139], v19 offset:15360
    v_mfma_f32_16x16x32_bf16 v[44:47], v[92:95], v[116:119], v[44:47]
    ds_read_b128 v[140:143], v19 offset:16384
    ds_read_b128 v[144:147], v19 offset:17408
    v_mfma_f32_16x16x32_bf16 v[52:55], v[88:91], v[120:123], v[52:55]
    s_add_u32 m0, s33, 0x13c00
    s_add_u32 s30, s31, 0xc00
    buffer_load_dwordx4 v13, s[4:7], s30 offen lds
    v_mfma_f32_16x16x32_bf16 v[56:59], v[92:95], v[120:123], v[56:59]
    s_add_u32 m0, s33, 0x14000
    s_add_u32 s30, s31, 0x1000
    s_mov_b32 exec_hi, 0
    buffer_load_dwordx4 v13, s[4:7], s30 offen lds
    s_mov_b32 exec_hi, -1
    v_mfma_f32_16x16x32_bf16 v[64:67], v[88:91], v[124:127], v[64:67]
    s_add_u32 s31, s31, 18432
    s_cmp_ge_u32 s31, 442368
    s_cselect_b32 s31, 0, s31
    v_mfma_f32_16x16x32_bf16 v[68:71], v[92:95], v[124:127], v[68:71]
    s_waitcnt vmcnt(5) lgkmcnt(0)
    s_barrier
    v_mfma_f32_16x16x32_bf16 v[28:31], v[100:103], v[132:135], v[28:31]
    ds_read_b64_tr_b16 v[88:89], v20 offset:0
    ds_read_b64_tr_b16 v[90:91], v20 offset:1280
    v_mfma_f32_16x16x32_bf16 v[32:35], v[104:107], v[132:135], v[32:35]
    ds_read_b64_tr_b16 v[92:93], v21 offset:0
    ds_read_b64_tr_b16 v[94:95], v21 offset:1280
    v_mfma_f32_16x16x32_bf16 v[40:43], v[100:103], v[136:139], v[40:43]
    ds_read_b128 v[112:115], v23 offset:5120
    ds_read_b128 v[116:119], v23 offset:6144
    v_mfma_f32_16x16x32_bf16 v[44:47], v[104:107], v[136:139], v[44:47]
    ds_read_b128 v[120:123], v23 offset:7168
    ds_read_b128 v[124:127], v23 offset:8192
    v_mfma_f32_16x16x32_bf16 v[52:55], v[100:103], v[140:143], v[52:55]
    s_add_u32 m0, s33, 0x0
    s_add_u32 s30, s31, 0x0
    buffer_load_dwordx4 v13, s[4:7], s30 offen lds
    v_mfma_f32_16x16x32_bf16 v[56:59], v[104:107], v[140:143], v[56:59]
    s_add_u32 m0, s33, 0x400
    s_add_u32 s30, s31, 0x400
    buffer_load_dwordx4 v13, s[4:7], s30 offen lds
    v_mfma_f32_16x16x32_bf16 v[64:67], v[100:103], v[144:147], v[64:67]
    s_add_u32 m0, s33, 0x800
    s_add_u32 s30, s31, 0x800
    buffer_load_dwordx4 v13, s[4:7], s30 offen lds
    v_mfma_f32_16x16x32_bf16 v[68:71], v[104:107], v[144:147], v[68:71]
    s_waitcnt lgkmcnt(0)
    v_mfma_f32_16x16x32_bf16 v[28:31], v[88:91], v[112:115], v[28:31]
    ds_read_b64_tr_b16 v[100:101], v20 offset:10240
    ds_read_b64_tr_b16 v[102:103], v20 offset:11520
    v_mfma_f32_16x16x32_bf16 v[32:35], v[92:95], v[112:115], v[32:35]
    ds_read_b64_tr_b16 v[104:105], v21 offset:10240
    ds_read_b64_tr_b16 v[106:107], v21 offset:11520
    v_mfma_f32_16x16x32_bf16 v[40:43], v[88:91], v[116:119], v[40:43]
    ds_read_b128 v[132:135], v23 offset:14336
    ds_read_b128 v[136:139], v23 offset:15360
    v_mfma_f32_16x16x32_bf16 v[44:47], v[92:95], v[116:119], v[44:47]
    ds_read_b128 v[140:143], v23 offset:16384
    ds_read_b128 v[144:147], v23 offset:17408
    v_mfma_f32_16x16x32_bf16 v[52:55], v[88:91], v[120:123], v[52:55]
    s_add_u32 m0, s33, 0xc00
    s_add_u32 s30, s31, 0xc00
    buffer_load_dwordx4 v13, s[4:7], s30 offen lds
    v_mfma_f32_16x16x32_bf16 v[56:59], v[92:95], v[120:123], v[56:59]
    s_add_u32 m0, s33, 0x1000
    s_add_u32 s30, s31, 0x1000
    s_mov_b32 exec_hi, 0
    buffer_load_dwordx4 v13, s[4:7], s30 offen lds
    s_mov_b32 exec_hi, -1
    v_mfma_f32_16x16x32_bf16 v[64:67], v[88:91], v[124:127], v[64:67]
    s_add_u32 s31, s31, 18432
    s_cmp_ge_u32 s31, 442368
    s_cselect_b32 s31, 0, s31
    v_mfma_f32_16x16x32_bf16 v[68:71], v[92:95], v[124:127], v[68:71]
    s_waitcnt vmcnt(5) lgkmcnt(0)
    s_barrier
    v_mfma_f32_16x16x32_bf16 v[28:31], v[100:103], v[132:135], v[28:31]
    ds_read_b64_tr_b16 v[88:89], v24 offset:0
    ds_read_b64_tr_b16 v[90:91], v24 offset:1280
    v_mfma_f32_16x16x32_bf16 v[32:35], v[104:107], v[132:135], v[32:35]
    ds_read_b64_tr_b16 v[92:93], v25 offset:0
    ds_read_b64_tr_b16 v[94:95], v25 offset:1280
    v_mfma_f32_16x16x32_bf16 v[40:43], v[100:103], v[136:139], v[40:43]
    ds_read_b128 v[112:115], v27 offset:5120
    ds_read_b128 v[116:119], v27 offset:6144
    v_mfma_f32_16x16x32_bf16 v[44:47], v[104:107], v[136:139], v[44:47]
    ds_read_b128 v[120:123], v27 offset:7168
    ds_read_b128 v[124:127], v27 offset:8192
    v_mfma_f32_16x16x32_bf16 v[52:55], v[100:103], v[140:143], v[52:55]
    s_add_u32 m0, s33, 0x9800
    s_add_u32 s30, s31, 0x0
    buffer_load_dwordx4 v13, s[4:7], s30 offen lds
    v_mfma_f32_16x16x32_bf16 v[56:59], v[104:107], v[140:143], v[56:59]
    s_add_u32 m0, s33, 0x9c00
    s_add_u32 s30, s31, 0x400
    buffer_load_dwordx4 v13, s[4:7], s30 offen lds
    v_mfma_f32_16x16x32_bf16 v[64:67], v[100:103], v[144:147], v[64:67]
    s_add_u32 m0, s33, 0xa000
    s_add_u32 s30, s31, 0x800
    buffer_load_dwordx4 v13, s[4:7], s30 offen lds
    v_mfma_f32_16x16x32_bf16 v[68:71], v[104:107], v[144:147], v[68:71]
    s_waitcnt lgkmcnt(0)
    v_mfma_f32_16x16x32_bf16 v[28:31], v[88:91], v[112:115], v[28:31]
    ds_read_b64_tr_b16 v[100:101], v24 offset:10240
    ds_read_b64_tr_b16 v[102:103], v24 offset:11520
    v_mfma_f32_16x16x32_bf16 v[32:35], v[92:95], v[112:115], v[32:35]
    ds_read_b64_tr_b16 v[104:105], v25 offset:10240
    ds_read_b64_tr_b16 v[106:107], v25 offset:11520
    v_mfma_f32_16x16x32_bf16 v[40:43], v[88:91], v[116:119], v[40:43]
    ds_read_b128 v[132:135], v27 offset:14336
    ds_read_b128 v[136:139], v27 offset:15360
    v_mfma_f32_16x16x32_bf16 v[44:47], v[92:95], v[116:119], v[44:47]
    ds_read_b128 v[140:143], v27 offset:16384
    ds_read_b128 v[144:147], v27 offset:17408
    v_mfma_f32_16x16x32_bf16 v[52:55], v[88:91], v[120:123], v[52:55]
    s_add_u32 m0, s33, 0xa400
    s_add_u32 s30, s31, 0xc00
    buffer_load_dwordx4 v13, s[4:7], s30 offen lds
    v_mfma_f32_16x16x32_bf16 v[56:59], v[92:95], v[120:123], v[56:59]
    s_add_u32 m0, s33, 0xa800
    s_add_u32 s30, s31, 0x1000
    s_mov_b32 exec_hi, 0
    buffer_load_dwordx4 v13, s[4:7], s30 offen lds
    s_mov_b32 exec_hi, -1
    v_mfma_f32_16x16x32_bf16 v[64:67], v[88:91], v[124:127], v[64:67]
    s_add_u32 s31, s31, 18432
    s_cmp_ge_u32 s31, 442368
    s_cselect_b32 s31, 0, s31
    v_mfma_f32_16x16x32_bf16 v[68:71], v[92:95], v[124:127], v[68:71]
    s_waitcnt vmcnt(5) lgkmcnt(0)
    s_barrier
    v_mfma_f32_16x16x32_bf16 v[28:31], v[100:103], v[132:135], v[28:31]
    ds_read_b64_tr_b16 v[88:89], v16 offset:0
    ds_read_b64_tr_b16 v[90:91], v16 offset:1280
    v_mfma_f32_16x16x32_bf16 v[32:35], v[104:107], v[132:135], v[32:35]
    ds_read_b64_tr_b16 v[92:93], v17 offset:0
    ds_read_b64_tr_b16 v[94:95], v17 offset:1280
    v_mfma_f32_16x16x32_bf16 v[40:43], v[100:103], v[136:139], v[40:43]
    ds_read_b128 v[112:115], v19 offset:5120
    ds_read_b128 v[116:119], v19 offset:6144
    v_mfma_f32_16x16x32_bf16 v[44:47], v[104:107], v[136:139], v[44:47]
    ds_read_b128 v[120:123], v19 offset:7168
    ds_read_b128 v[124:127], v19 offset:8192
    v_mfma_f32_16x16x32_bf16 v[52:55], v[100:103], v[140:143], v[52:55]
    s_add_u32 m0, s33, 0x13000
    s_add_u32 s30, s31, 0x0
    buffer_load_dwordx4 v13, s[4:7], s30 offen lds
    v_mfma_f32_16x16x32_bf16 v[56:59], v[104:107], v[140:143], v[56:59]
    s_add_u32 m0, s33, 0x13400
    s_add_u32 s30, s31, 0x400
    buffer_load_dwordx4 v13, s[4:7], s30 offen lds
    v_mfma_f32_16x16x32_bf16 v[64:67], v[100:103], v[144:147], v[64:67]
    s_add_u32 m0, s33, 0x13800
    s_add_u32 s30, s31, 0x800
    buffer_load_dwordx4 v13, s[4:7], s30 offen lds
    v_mfma_f32_16x16x32_bf16 v[68:71], v[104:107], v[144:147], v[68:71]
    s_add_u32 s35, s35, 1
    s_cmp_lt_u32 s35, 7
    s_cbranch_scc1 LB_loop2
    s_waitcnt lgkmcnt(0)
    v_mfma_f32_16x16x32_bf16 v[28:31], v[88:91], v[112:115], v[28:31]
    ds_read_b64_tr_b16 v[100:101], v16 offset:10240
    ds_read_b64_tr_b16 v[102:103], v16 offset:11520
    v_mfma_f32_16x16x32_bf16 v[32:35], v[92:95], v[112:115], v[32:35]
    ds_read_b64_tr_b16 v[104:105], v17 offset:10240
    ds_read_b64_tr_b16 v[106:107], v17 offset:11520
    v_mfma_f32_16x16x32_bf16 v[40:43], v[88:91], v[116:119], v[40:43]
    ds_read_b128 v[132:135], v19 offset:14336
    ds_read_b128 v[136:139], v19 offset:15360
    v_mfma_f32_16x16x32_bf16 v[44:47], v[92:95], v[116:119], v[44:47]
    ds_read_b128 v[140:143], v19 offset:16384
    ds_read_b128 v[144:147], v19 offset:17408
    v_mfma_f32_16x16x32_bf16 v[52:55], v[88:91], v[120:123], v[52:55]
    s_add_u32 m0, s33, 0x13c00
    s_add_u32 s30, s31, 0xc00
    buffer_load_dwordx4 v13, s[4:7], s30 offen lds
    v_mfma_f32_16x16x32_bf16 v[56:59], v[92:95], v[120:123], v[56:59]
    s_add_u32 m0, s33, 0x14000
    s_add_u32 s30, s31, 0x1000
    s_mov_b32 exec_hi, 0
    buffer_load_dwordx4 v13, s[4:7], s30 offen lds
    s_mov_b32 exec_hi, -1
    v_mfma_f32_16x16x32_bf16 v[64:67], v[88:91], v[124:127], v[64:67]
    s_add_u32 s31, s31, 18432
    s_cmp_ge_u32 s31, 442368
    s_cselect_b32 s31, 0, s31
    v_mfma_f32_16x16x32_bf16 v[68:71], v[92:95], v[124:127], v[68:71]
    s_waitcnt vmcnt(5) lgkmcnt(0)
    s_barrier
    v_mfma_f32_16x16x32_bf16 v[28:31], v[100:103], v[132:135], v[28:31]
    ds_read_b64_tr_b16 v[88:89], v20 offset:0
    ds_read_b64_tr_b16 v[90:91], v20 offset:1280
    v_mfma_f32_16x16x32_bf16 v[32:35], v[104:107], v[132:135], v[32:35]
    ds_read_b64_tr_b16 v[92:93], v21 offset:0
    ds_read_b64_tr_b16 v[94:95], v21 offset:1280
    v_mfma_f32_16x16x32_bf16 v[40:43], v[100:103], v[136:139], v[40:43]
    ds_read_b128 v[112:115], v23 offset:5120
    ds_read_b128 v[116:119], v23 offset:6144
    v_mfma_f32_16x16x32_bf16 v[44:47], v[104:107], v[136:139], v[44:47]
    ds_read_b128 v[120:123], v23 offset:7168
    ds_read_b128 v[124:127], v23 offset:8192
    v_mfma_f32_16x16x32_bf16 v[52:55], v[100:103], v[140:143], v[52:55]
    v_mfma_f32_16x16x32_bf16 v[56:59], v[104:107], v[140:143], v[56:59]
    v_mfma_f32_16x16x32_bf16 v[64:67], v[100:103], v[144:147], v[64:67]
    v_mfma_f32_16x16x32_bf16 v[68:71], v[104:107], v[144:147], v[68:71]
    s_waitcnt lgkmcnt(0)
    v_mfma_f32_16x16x32_bf16 v[28:31], v[88:91], v[112:115], v[28:31]
    ds_read_b64_tr_b16 v[100:101], v20 offset:10240
    ds_read_b64_tr_b16 v[102:103], v20 offset:11520
    v_mfma_f32_16x16x32_bf16 v[32:35], v[92:95], v[112:115], v[32:35]
    ds_read_b64_tr_b16 v[104:105], v21 offset:10240
    ds_read_b64_tr_b16 v[106:107], v21 offset:11520
    v_mfma_f32_16x16x32_bf16 v[40:43], v[88:91], v[116:119], v[40:43]
    ds_read_b128 v[132:135], v23 offset:14336
    ds_read_b128 v[136:139], v23 offset:15360
    v_mfma_f32_16x16x32_bf16 v[44:47], v[92:95], v[116:119], v[44:47]
    ds_read_b128 v[140:143], v23 offset:16384
    ds_read_b128 v[144:147], v23 offset:17408
    v_mfma_f32_16x16x32_bf16 v[52:55], v[88:91], v[120:123], v[52:55]
    v_mfma_f32_16x16x32_bf16 v[56:59], v[92:95], v[120:123], v[56:59]
    v_mfma_f32_16x16x32_bf16 v[64:67], v[88:91], v[124:127], v[64:67]
    v_mfma_f32_16x16x32_bf16 v[68:71], v[92:95], v[124:127], v[68:71]
    s_waitcnt vmcnt(0) lgkmcnt(0)
    s_barrier
    v_mfma_f32_16x16x32_bf16 v[28:31], v[100:103], v[132:135], v[28:31]
    ds_read_b64_tr_b16 v[88:89], v24 offset:0
    ds_read_b64_tr_b16 v[90:91], v24 offset:1280
    v_mfma_f32_16x16x32_bf16 v[32:35], v[104:107], v[132:135], v[32:35]
    ds_read_b64_tr_b16 v[92:93], v25 offset:0
    ds_read_b64_tr_b16 v[94:95], v25 offset:1280
    v_mfma_f32_16x16x32_bf16 v[40:43], v[100:103], v[136:139], v[40:43]
    ds_read_b128 v[112:115], v27 offset:5120
    ds_read_b128 v[116:119], v27 offset:6144
    v_mfma_f32_16x16x32_bf16 v[44:47], v[104:107], v[136:139], v[44:47]
    ds_read_b128 v[120:123], v27 offset:7168
    ds_read_b128 v[124:127], v27 offset:8192
    v_mfma_f32_16x16x32_bf16 v[52:55], v[100:103], v[140:143], v[52:55]
    v_mfma_f32_16x16x32_bf16 v[56:59], v[104:107], v[140:143], v[56:59]
    v_mfma_f32_16x16x32_bf16 v[64:67], v[100:103], v[144:147], v[64:67]
    v_mfma_f32_16x16x32_bf16 v[68:71], v[104:107], v[144:147], v[68:71]
    s_waitcnt lgkmcnt(0)
    v_mfma_f32_16x16x32_bf16 v[28:31], v[88:91], v[112:115], v[28:31]
    ds_read_b64_tr_b16 v[100:101], v24 offset:10240
    ds_read_b64_tr_b16 v[102:103], v24 offset:11520
    v_mfma_f32_16x16x32_bf16 v[32:35], v[92:95], v[112:115], v[32:35]
    ds_read_b64_tr_b16 v[104:105], v25 offset:10240
    ds_read_b64_tr_b16 v[106:107], v25 offset:11520
    v_mfma_f32_16x16x32_bf16 v[40:43], v[88:91], v[116:119], v[40:43]
    ds_read_b128 v[132:135], v27 offset:14336
    ds_read_b128 v[136:139], v27 offset:15360
    v_mfma_f32_16x16x32_bf16 v[44:47], v[92:95], v[116:119], v[44:47]
    ds_read_b128 v[140:143], v27 offset:16384
    ds_read_b128 v[144:147], v27 offset:17408
    v_mfma_f32_16x16x32_bf16 v[52:55], v[88:91], v[120:123], v[52:55]
    v_mfma_f32_16x16x32_bf16 v[56:59], v[92:95], v[120:123], v[56:59]
    v_mfma_f32_16x16x32_bf16 v[64:67], v[88:91], v[124:127], v[64:67]
    v_mfma_f32_16x16x32_bf16 v[68:71], v[92:95], v[124:127], v[68:71]
    s_waitcnt vmcnt(0) lgkmcnt(0)
    s_barrier
    v_mfma_f32_16x16x32_bf16 v[28:31], v[100:103], v[132:135], v[28:31]
    v_mfma_f32_16x16x32_bf16 v[32:35], v[104:107], v[132:135], v[32:35]
    v_mfma_f32_16x16x32_bf16 v[40:43], v[100:103], v[136:139], v[40:43]
    v_mfma_f32_16x16x32_bf16 v[44:47], v[104:107], v[136:139], v[44:47]
    v_mfma_f32_16x16x32_bf16 v[52:55], v[100:103], v[140:143], v[52:55]
    v_mfma_f32_16x16x32_bf16 v[56:59], v[104:107], v[140:143], v[56:59]
    v_mfma_f32_16x16x32_bf16 v[64:67], v[100:103], v[144:147], v[64:67]
    v_mfma_f32_16x16x32_bf16 v[68:71], v[104:107], v[144:147], v[68:71]
    s_nop 7
    s_lshl_b32 s27, s24, 13
    v_add_u32 v4, s27, v1
    s_mul_i32 s28, s37, 65536
    s_cmp_eq_u32 s37, 0
    s_cbranch_scc1 LB_ps_64
    s_add_u32 s30, s28, 0
    v_cvt_pk_bf16_f32 v88, v28, v29
    v_cvt_pk_bf16_f32 v89, v30, v31
    v_cvt_pk_bf16_f32 v90, v52, v53
    v_cvt_pk_bf16_f32 v91, v54, v55
    buffer_store_dwordx4 v[88:91], v4, s[12:15], s30 offen offset:0 sc1
LB_ps_64:
    s_cmp_eq_u32 s37, 1
    s_cbranch_scc1 LB_ps_65
    s_add_u32 s30, s28, 2048
    v_cvt_pk_bf16_f32 v96, v32, v33
    v_cvt_pk_bf16_f32 v97, v34, v35
    v_cvt_pk_bf16_f32 v98, v56, v57
    v_cvt_pk_bf16_f32 v99, v58, v59
    buffer_store_dwordx4 v[96:99], v4, s[12:15], s30 offen offset:0 sc1
LB_ps_65:
    s_cmp_eq_u32 s37, 2
    s_cbranch_scc1 LB_ps_66
    s_add_u32 s30, s28, 4096
    v_cvt_pk_bf16_f32 v104, v40, v41
    v_cvt_pk_bf16_f32 v105, v42, v43
    v_cvt_pk_bf16_f32 v106, v64, v65
    v_cvt_pk_bf16_f32 v107, v66, v67
    buffer_store_dwordx4 v[104:107], v4, s[12:15], s30 offen offset:0 sc1
LB_ps_66:
    s_cmp_eq_u32 s37, 3
    s_cbranch_scc1 LB_ps_67
    s_add_u32 s30, s28, 6144
    v_cvt_pk_bf16_f32 v112, v44, v45
    v_cvt_pk_bf16_f32 v113, v46, v47
    v_cvt_pk_bf16_f32 v114, v68, v69
    v_cvt_pk_bf16_f32 v115, v70, v71
    buffer_store_dwordx4 v[112:115], v4, s[12:15], s30 offen offset:0 sc1
LB_ps_67:
    v_and_b32 v5, 15, v0
    v_mul_u32_u24 v5, 0xa00, v5
    v_lshrrev_b32 v6, 4, v0
    v_lshl_add_u32 v5, v6, 3, v5
    s_lshl_b32 s27, s45, 5
    v_add_u32 v5, s27, v5
    s_waitcnt vmcnt(0)
    s_barrier
    s_barrier
    s_cmp_eq_u32 s37, 0
    s_cbranch_scc0 LB_pr_68
    s_add_u32 s30, s52, 0
    buffer_load_dwordx4 v[88:91], v4, s[12:15], s30 offen offset:0 sc1
    s_add_u32 s30, s53, 0
    buffer_load_dwordx4 v[92:95], v4, s[12:15], s30 offen offset:0 sc1
    s_add_u32 s30, s54, 0
    buffer_load_dwordx4 v[96:99], v4, s[12:15], s30 offen offset:0 sc1
    s_waitcnt vmcnt(0)
    v_lshlrev_b32 v6, 16, v88
    v_and_b32 v7, 0xffff0000, v88
    v_add_f32 v28, v28, v6
    v_add_f32 v29, v29, v7
    v_lshlrev_b32 v6, 16, v89
    v_and_b32 v7, 0xffff0000, v89
    v_add_f32 v30, v30, v6
    v_add_f32 v31, v31, v7
    v_lshlrev_b32 v6, 16, v92
    v_and_b32 v7, 0xffff0000, v92
    v_add_f32 v28, v28, v6
    v_add_f32 v29, v29, v7
    v_lshlrev_b32 v6, 16, v93
    v_and_b32 v7, 0xffff0000, v93
    v_add_f32 v30, v30, v6
    v_add_f32 v31, v31, v7
    v_lshlrev_b32 v6, 16, v96
    v_and_b32 v7, 0xffff0000, v96
    v_add_f32 v28, v28, v6
    v_add_f32 v29, v29, v7
    v_lshlrev_b32 v6, 16, v97
    v_and_b32 v7, 0xffff0000, v97
    v_add_f32 v30, v30, v6
    v_add_f32 v31, v31, v7
    v_cvt_pk_bf16_f32 v28, v28, v29
    v_cvt_pk_bf16_f32 v29, v30, v31
    s_mov_b32 s30, 204800
    buffer_store_dwordx2 v[28:29], v5, s[16:19], s30 offen offset:0
    v_lshlrev_b32 v6, 16, v90
    v_and_b32 v7, 0xffff0000, v90
    v_add_f32 v52, v52, v6
    v_add_f32 v53, v53, v7
    v_lshlrev_b32 v6, 16, v91
    v_and_b32 v7, 0xffff0000, v91
    v_add_f32 v54, v54, v6
    v_add_f32 v55, v55, v7
    v_lshlrev_b32 v6, 16, v94
    v_and_b32 v7, 0xffff0000, v94
    v_add_f32 v52, v52, v6
    v_add_f32 v53, v53, v7
    v_lshlrev_b32 v6, 16, v95
    v_and_b32 v7, 0xffff0000, v95
    v_add_f32 v54, v54, v6
    v_add_f32 v55, v55, v7
    v_lshlrev_b32 v6, 16, v98
    v_and_b32 v7, 0xffff0000, v98
    v_add_f32 v52, v52, v6
    v_add_f32 v53, v53, v7
    v_lshlrev_b32 v6, 16, v99
    v_and_b32 v7, 0xffff0000, v99
    v_add_f32 v54, v54, v6
    v_add_f32 v55, v55, v7
    v_cvt_pk_bf16_f32 v52, v52, v53
    v_cvt_pk_bf16_f32 v53, v54, v55
    s_mov_b32 s30, 286720
    buffer_store_dwordx2 v[52:53], v5, s[16:19], s30 offen offset:0
LB_pr_68:
    s_cmp_eq_u32 s37, 1
    s_cbranch_scc0 LB_pr_69
    s_add_u32 s30, s52, 2048
    buffer_load_dwordx4 v[88:91], v4, s[12:15], s30 offen offset:0 sc1
    s_add_u32 s30, s53, 2048
    buffer_load_dwordx4 v[92:95], v4, s[12:15], s30 offen offset:0 sc1
    s_add_u32 s30, s54, 2048
    buffer_load_dwordx4 v[96:99], v4, s[12:15], s30 offen offset:0 sc1
    s_waitcnt vmcnt(0)
    v_lshlrev_b32 v6, 16, v88
    v_and_b32 v7, 0xffff0000, v88
    v_add_f32 v32, v32, v6
    v_add_f32 v33, v33, v7
    v_lshlrev_b32 v6, 16, v89
    v_and_b32 v7, 0xffff0000, v89
    v_add_f32 v34, v34, v6
    v_add_f32 v35, v35, v7
    v_lshlrev_b32 v6, 16, v92
    v_and_b32 v7, 0xffff0000, v92
    v_add_f32 v32, v32, v6
    v_add_f32 v33, v33, v7
    v_lshlrev_b32 v6, 16, v93
    v_and_b32 v7, 0xffff0000, v93
    v_add_f32 v34, v34, v6
    v_add_f32 v35, v35, v7
    v_lshlrev_b32 v6, 16, v96
    v_and_b32 v7, 0xffff0000, v96
    v_add_f32 v32, v32, v6
    v_add_f32 v33, v33, v7
    v_lshlrev_b32 v6, 16, v97
    v_and_b32 v7, 0xffff0000, v97
    v_add_f32 v34, v34, v6
    v_add_f32 v35, v35, v7
    v_cvt_pk_bf16_f32 v32, v32, v33
    v_cvt_pk_bf16_f32 v33, v34, v35
    s_mov_b32 s30, 204800
    buffer_store_dwordx2 v[32:33], v5, s[16:19], s30 offen offset:32
    v_lshlrev_b32 v6, 16, v90
    v_and_b32 v7, 0xffff0000, v90
    v_add_f32 v56, v56, v6
    v_add_f32 v57, v57, v7
    v_lshlrev_b32 v6, 16, v91
    v_and_b32 v7, 0xffff0000, v91
    v_add_f32 v58, v58, v6
    v_add_f32 v59, v59, v7
    v_lshlrev_b32 v6, 16, v94
    v_and_b32 v7, 0xffff0000, v94
    v_add_f32 v56, v56, v6
    v_add_f32 v57, v57, v7
    v_lshlrev_b32 v6, 16, v95
    v_and_b32 v7, 0xffff0000, v95
    v_add_f32 v58, v58, v6
    v_add_f32 v59, v59, v7
    v_lshlrev_b32 v6, 16, v98
    v_and_b32 v7, 0xffff0000, v98
    v_add_f32 v56, v56, v6
    v_add_f32 v57, v57, v7
    v_lshlrev_b32 v6, 16, v99
    v_and_b32 v7, 0xffff0000, v99
    v_add_f32 v58, v58, v6
    v_add_f32 v59, v59, v7
    v_cvt_pk_bf16_f32 v56, v56, v57
    v_cvt_pk_bf16_f32 v57, v58, v59
    s_mov_b32 s30, 286720
    buffer_store_dwordx2 v[56:57], v5, s[16:19], s30 offen offset:32
LB_pr_69:
    s_cmp_eq_u32 s37, 2
    s_cbranch_scc0 LB_pr_70
    s_add_u32 s30, s52, 4096
    buffer_load_dwordx4 v[88:91], v4, s[12:15], s30 offen offset:0 sc1
    s_add_u32 s30, s53, 4096
    buffer_load_dwordx4 v[92:95], v4, s[12:15], s30 offen offset:0 sc1
    s_add_u32 s30, s54, 4096
    buffer_load_dwordx4 v[96:99], v4, s[12:15], s30 offen offset:0 sc1
    s_waitcnt vmcnt(0)
    v_lshlrev_b32 v6, 16, v88
    v_and_b32 v7, 0xffff0000, v88
    v_add_f32 v40, v40, v6
    v_add_f32 v41, v41, v7
    v_lshlrev_b32 v6, 16, v89
    v_and_b32 v7, 0xffff0000, v89
    v_add_f32 v42, v42, v6
    v_add_f32 v43, v43, v7
    v_lshlrev_b32 v6, 16, v92
    v_and_b32 v7, 0xffff0000, v92
    v_add_f32 v40, v40, v6
    v_add_f32 v41, v41, v7
    v_lshlrev_b32 v6, 16, v93
    v_and_b32 v7, 0xffff0000, v93
    v_add_f32 v42, v42, v6
    v_add_f32 v43, v43, v7
    v_lshlrev_b32 v6, 16, v96
    v_and_b32 v7, 0xffff0000, v96
    v_add_f32 v40, v40, v6
    v_add_f32 v41, v41, v7
    v_lshlrev_b32 v6, 16, v97
    v_and_b32 v7, 0xffff0000, v97
    v_add_f32 v42, v42, v6
    v_add_f32 v43, v43, v7
    v_cvt_pk_bf16_f32 v40, v40, v41
    v_cvt_pk_bf16_f32 v41, v42, v43
    s_mov_b32 s30, 245760
    buffer_store_dwordx2 v[40:41], v5, s[16:19], s30 offen offset:0
    v_lshlrev_b32 v6, 16, v90
    v_and_b32 v7, 0xffff0000, v90
    v_add_f32 v64, v64, v6
    v_add_f32 v65, v65, v7
    v_lshlrev_b32 v6, 16, v91
    v_and_b32 v7, 0xffff0000, v91
    v_add_f32 v66, v66, v6
    v_add_f32 v67, v67, v7
    v_lshlrev_b32 v6, 16, v94
    v_and_b32 v7, 0xffff0000, v94
    v_add_f32 v64, v64, v6
    v_add_f32 v65, v65, v7
    v_lshlrev_b32 v6, 16, v95
    v_and_b32 v7, 0xffff0000, v95
    v_add_f32 v66, v66, v6
    v_add_f32 v67, v67, v7
    v_lshlrev_b32 v6, 16, v98
    v_and_b32 v7, 0xffff0000, v98
    v_add_f32 v64, v64, v6
    v_add_f32 v65, v65, v7
    v_lshlrev_b32 v6, 16, v99
    v_and_b32 v7, 0xffff0000, v99
    v_add_f32 v66, v66, v6
    v_add_f32 v67, v67, v7
    v_cvt_pk_bf16_f32 v64, v64, v65
    v_cvt_pk_bf16_f32 v65, v66, v67
    s_mov_b32 s30, 327680
    buffer_store_dwordx2 v[64:65], v5, s[16:19], s30 offen offset:0
LB_pr_70:
    s_cmp_eq_u32 s37, 3
    s_cbranch_scc0 LB_pr_71
    s_add_u32 s30, s52, 6144
    buffer_load_dwordx4 v[88:91], v4, s[12:15], s30 offen offset:0 sc1
    s_add_u32 s30, s53, 6144
    buffer_load_dwordx4 v[92:95], v4, s[12:15], s30 offen offset:0 sc1
    s_add_u32 s30, s54, 6144
    buffer_load_dwordx4 v[96:99], v4, s[12:15], s30 offen offset:0 sc1
    s_waitcnt vmcnt(0)
    v_lshlrev_b32 v6, 16, v88
    v_and_b32 v7, 0xffff0000, v88
    v_add_f32 v44, v44, v6
    v_add_f32 v45, v45, v7
    v_lshlrev_b32 v6, 16, v89
    v_and_b32 v7, 0xffff0000, v89
    v_add_f32 v46, v46, v6
    v_add_f32 v47, v47, v7
    v_lshlrev_b32 v6, 16, v92
    v_and_b32 v7, 0xffff0000, v92
    v_add_f32 v44, v44, v6
    v_add_f32 v45, v45, v7
    v_lshlrev_b32 v6, 16, v93
    v_and_b32 v7, 0xffff0000, v93
    v_add_f32 v46, v46, v6
    v_add_f32 v47, v47, v7
    v_lshlrev_b32 v6, 16, v96
    v_and_b32 v7, 0xffff0000, v96
    v_add_f32 v44, v44, v6
    v_add_f32 v45, v45, v7
    v_lshlrev_b32 v6, 16, v97
    v_and_b32 v7, 0xffff0000, v97
    v_add_f32 v46, v46, v6
    v_add_f32 v47, v47, v7
    v_cvt_pk_bf16_f32 v44, v44, v45
    v_cvt_pk_bf16_f32 v45, v46, v47
    s_mov_b32 s30, 245760
    buffer_store_dwordx2 v[44:45], v5, s[16:19], s30 offen offset:32
    v_lshlrev_b32 v6, 16, v90
    v_and_b32 v7, 0xffff0000, v90
    v_add_f32 v68, v68, v6
    v_add_f32 v69, v69, v7
    v_lshlrev_b32 v6, 16, v91
    v_and_b32 v7, 0xffff0000, v91
    v_add_f32 v70, v70, v6
    v_add_f32 v71, v71, v7
    v_lshlrev_b32 v6, 16, v94
    v_and_b32 v7, 0xffff0000, v94
    v_add_f32 v68, v68, v6
    v_add_f32 v69, v69, v7
    v_lshlrev_b32 v6, 16, v95
    v_and_b32 v7, 0xffff0000, v95
    v_add_f32 v70, v70, v6
    v_add_f32 v71, v71, v7
    v_lshlrev_b32 v6, 16, v98
    v_and_b32 v7, 0xffff0000, v98
    v_add_f32 v68, v68, v6
    v_add_f32 v69, v69, v7
    v_lshlrev_b32 v6, 16, v99
    v_and_b32 v7, 0xffff0000, v99
    v_add_f32 v70, v70, v6
    v_add_f32 v71, v71, v7
    v_cvt_pk_bf16_f32 v68, v68, v69
    v_cvt_pk_bf16_f32 v69, v70, v71
    s_mov_b32 s30, 327680
    buffer_store_dwordx2 v[68:69], v5, s[16:19], s30 offen offset:32
LB_pr_71:
    s_endpgm
LB_v3:
    s_add_u32 m0, s33, 0x0
    s_add_u32 s30, s31, 0x0
    buffer_load_dwordx4 v13, s[4:7], s30 offen lds
    s_add_u32 m0, s33, 0x400
    s_add_u32 s30, s31, 0x400
    buffer_load_dwordx4 v13, s[4:7], s30 offen lds
    s_add_u32 m0, s33, 0x800
    s_add_u32 s30, s31, 0x800
    buffer_load_dwordx4 v13, s[4:7], s30 offen lds
    s_add_u32 m0, s33, 0xc00
    s_add_u32 s30, s31, 0xc00
    buffer_load_dwordx4 v13, s[4:7], s30 offen lds
    s_add_u32 m0, s33, 0x1000
    s_add_u32 s30, s31, 0x1000
    s_mov_b32 exec_hi, 0
    buffer_load_dwordx4 v13, s[4:7], s30 offen lds
    s_mov_b32 exec_hi, -1
    s_add_u32 s31, s31, 18432
    s_cmp_ge_u32 s31, 442368
    s_cselect_b32 s31, 0, s31
    s_add_u32 m0, s33, 0x9800
    s_add_u32 s30, s31, 0x0
    buffer_load_dwordx4 v13, s[4:7], s30 offen lds
    s_add_u32 m0, s33, 0x9c00
    s_add_u32 s30, s31, 0x400
    buffer_load_dwordx4 v13, s[4:7], s30 offen lds
    s_add_u32 m0, s33, 0xa000
    s_add_u32 s30, s31, 0x800
    buffer_load_dwordx4 v13, s[4:7], s30 offen lds
    s_add_u32 m0, s33, 0xa400
    s_add_u32 s30, s31, 0xc00
    buffer_load_dwordx4 v13, s[4:7], s30 offen lds
    s_add_u32 m0, s33, 0xa800
    s_add_u32 s30, s31, 0x1000
    s_mov_b32 exec_hi, 0
    buffer_load_dwordx4 v13, s[4:7], s30 offen lds
    s_mov_b32 exec_hi, -1
    s_add_u32 s31, s31, 18432
    s_cmp_ge_u32 s31, 442368
    s_cselect_b32 s31, 0, s31
    v_mul_u32_u24 v6, 0xa00, v4
    v_bfe_u32 v7, v0, 2, 2
    v_lshl_add_u32 v6, v7, 6, v6
    v_and_b32 v7, 3, v0
    v_lshl_add_u32 v6, v7, 3, v6
    s_add_u32 s30, s45, 0
    v_xor_b32 v7, s30, v4
    v_and_b32 v7, 1, v7
    v_lshl_add_u32 v16, v7, 5, v6
    s_lshr_b32 s30, s30, 1
    s_lshl_b32 s30, s30, 8
    s_add_u32 s30, s30, 0x4800
    v_add_u32 v16, s30, v16
    s_add_u32 s30, s45, 1
    v_xor_b32 v7, s30, v4
    v_and_b32 v7, 1, v7
    v_lshl_add_u32 v17, v7, 5, v6
    s_lshr_b32 s30, s30, 1
    s_lshl_b32 s30, s30, 8
    s_add_u32 s30, s30, 0x4800
    v_add_u32 v17, s30, v17
    s_add_u32 s30, s45, 2
    v_xor_b32 v7, s30, v4
    v_and_b32 v7, 1, v7
    v_lshl_add_u32 v18, v7, 5, v6
    s_lshr_b32 s30, s30, 1
    s_lshl_b32 s30, s30, 8
    s_add_u32 s30, s30, 0x4800
    v_add_u32 v18, s30, v18
    v_mov_b32 v19, v1
    v_add_u32 v20, 0x9800, v16
    v_add_u32 v21, 0x9800, v17
    v_add_u32 v22, 0x9800, v18
    v_add_u32 v23, 0x9800, v19
    v_add_u32 v24, 0x13000, v16
    v_add_u32 v25, 0x13000, v17
    v_add_u32 v26, 0x13000, v18
    v_add_u32 v27, 0x13000, v19
    v_mov_b32 v28, 0
    v_mov_b32 v29, 0
    v_mov_b32 v30, 0
    v_mov_b32 v31, 0
    v_mov_b32 v32, 0
    v_mov_b32 v33, 0
    v_mov_b32 v34, 0
    v_mov_b32 v35, 0
    v_mov_b32 v36, 0
    v_mov_b32 v37, 0
    v_mov_b32 v38, 0
    v_mov_b32 v39, 0
    v_mov_b32 v40, 0
    v_mov_b32 v41, 0
    v_mov_b32 v42, 0
    v_mov_b32 v43, 0
    v_mov_b32 v44, 0
    v_mov_b32 v45, 0
    v_mov_b32 v46, 0
    v_mov_b32 v47, 0
    v_mov_b32 v48, 0
    v_mov_b32 v49, 0
    v_mov_b32 v50, 0
    v_mov_b32 v51, 0
    v_mov_b32 v52, 0
    v_mov_b32 v53, 0
    v_mov_b32 v54, 0
    v_mov_b32 v55, 0
    v_mov_b32 v56, 0
    v_mov_b32 v57, 0
    v_mov_b32 v58, 0
    v_mov_b32 v59, 0
    v_mov_b32 v60, 0
    v_mov_b32 v61, 0
    v_mov_b32 v62, 0
    v_mov_b32 v63, 0
    v_mov_b32 v64, 0
    v_mov_b32 v65, 0
    v_mov_b32 v66, 0
    v_mov_b32 v67, 0
    v_mov_b32 v68, 0
    v_mov_b32 v69, 0
    v_mov_b32 v70, 0
    v_mov_b32 v71, 0
    v_mov_b32 v72, 0
    v_mov_b32 v73, 0
    v_mov_b32 v74, 0
    v_mov_b32 v75, 0
    v_mov_b32 v76, 0
    v_mov_b32 v77, 0
    v_mov_b32 v78, 0
    v_mov_b32 v79, 0
    v_mov_b32 v80, 0
    v_mov_b32 v81, 0
    v_mov_b32 v82, 0
    v_mov_b32 v83, 0
    v_mov_b32 v84, 0
    v_mov_b32 v85, 0
    v_mov_b32 v86, 0
    v_mov_b32 v87, 0
    s_waitcnt vmcnt(5)
    s_barrier
    ds_read_b64_tr_b16 v[88:89], v16 offset:0
    ds_read_b64_tr_b16 v[90:91], v16 offset:1280
    ds_read_b64_tr_b16 v[92:93], v17 offset:0
    ds_read_b64_tr_b16 v[94:95], v17 offset:1280
    ds_read_b64_tr_b16 v[96:97], v18 offset:0
    ds_read_b64_tr_b16 v[98:99], v18 offset:1280
    ds_read_b128 v[112:115], v19 offset:5120
    ds_read_b128 v[116:119], v19 offset:6144
    ds_read_b128 v[120:123], v19 offset:7168
    ds_read_b128 v[124:127], v19 offset:8192
    s_add_u32 m0, s33, 0x13000
    s_add_u32 s30, s31, 0x0
    buffer_load_dwordx4 v13, s[4:7], s30 offen lds
    s_add_u32 m0, s33, 0x13400
    s_add_u32 s30, s31, 0x400
    buffer_load_dwordx4 v13, s[4:7], s30 offen lds
    s_add_u32 m0, s33, 0x13800
    s_add_u32 s30, s31, 0x800
    buffer_load_dwordx4 v13, s[4:7], s30 offen lds
    s_mov_b32 s35, 0
LB_loop3:
    s_waitcnt lgkmcnt(0)
    v_mfma_f32_16x16x32_bf16 v[28:31], v[88:91], v[112:115], v[28:31]
    ds_read_b64_tr_b16 v[100:101], v16 offset:10240
    ds_read_b64_tr_b16 v[102:103], v16 offset:11520
    v_mfma_f32_16x16x32_bf16 v[32:35], v[92:95], v[112:115], v[32:35]
    ds_read_b64_tr_b16 v[104:105], v17 offset:10240
    ds_read_b64_tr_b16 v[106:107], v17 offset:11520
    v_mfma_f32_16x16x32_bf16 v[36:39], v[96:99], v[112:115], v[36:39]
    ds_read_b64_tr_b16 v[108:109], v18 offset:10240
    ds_read_b64_tr_b16 v[110:111], v18 offset:11520
    v_mfma_f32_16x16x32_bf16 v[40:43], v[88:91], v[116:119], v[40:43]
    ds_read_b128 v[132:135], v19 offset:14336
    v_mfma_f32_16x16x32_bf16 v[44:47], v[92:95], v[116:119], v[44:47]
    ds_read_b128 v[136:139], v19 offset:15360
    v_mfma_f32_16x16x32_bf16 v[48:51], v[96:99], v[116:119], v[48:51]
    ds_read_b128 v[140:143], v19 offset:16384
    v_mfma_f32_16x16x32_bf16 v[52:55], v[88:91], v[120:123], v[52:55]
    ds_read_b128 v[144:147], v19 offset:17408
    v_mfma_f32_16x16x32_bf16 v[56:59], v[92:95], v[120:123], v[56:59]
    s_add_u32 m0, s33, 0x13c00
    s_add_u32 s30, s31, 0xc00
    buffer_load_dwordx4 v13, s[4:7], s30 offen lds
    v_mfma_f32_16x16x32_bf16 v[60:63], v[96:99], v[120:123], v[60:63]
    s_add_u32 m0, s33, 0x14000
    s_add_u32 s30, s31, 0x1000
    s_mov_b32 exec_hi, 0
    buffer_load_dwordx4 v13, s[4:7], s30 offen lds
    s_mov_b32 exec_hi, -1
    v_mfma_f32_16x16x32_bf16 v[64:67], v[88:91], v[124:127], v[64:67]
    s_add_u32 s31, s31, 18432
    s_cmp_ge_u32 s31, 442368
    s_cselect_b32 s31, 0, s31
    v_mfma_f32_16x16x32_bf16 v[68:71], v[92:95], v[124:127], v[68:71]
    v_mfma_f32_16x16x32_bf16 v[72:75], v[96:99], v[124:127], v[72:75]
    s_waitcnt vmcnt(5) lgkmcnt(0)
    s_barrier
    v_mfma_f32_16x16x32_bf16 v[28:31], v[100:103], v[132:135], v[28:31]
    ds_read_b64_tr_b16 v[88:89], v20 offset:0
    ds_read_b64_tr_b16 v[90:91], v20 offset:1280
    v_mfma_f32_16x16x32_bf16 v[32:35], v[104:107], v[132:135], v[32:35]
    ds_read_b64_tr_b16 v[92:93], v21 offset:0
    ds_read_b64_tr_b16 v[94:95], v21 offset:1280
    v_mfma_f32_16x16x32_bf16 v[36:39], v[108:111], v[132:135], v[36:39]
    ds_read_b64_tr_b16 v[96:97], v22 offset:0
    ds_read_b64_tr_b16 v[98:99], v22 offset:1280
    v_mfma_f32_16x16x32_bf16 v[40:43], v[100:103], v[136:139], v[40:43]
    ds_read_b128 v[112:115], v23 offset:5120
    v_mfma_f32_16x16x32_bf16 v[44:47], v[104:107], v[136:139], v[44:47]
    ds_read_b128 v[116:119], v23 offset:6144
    v_mfma_f32_16x16x32_bf16 v[48:51], v[108:111], v[136:139], v[48:51]
    ds_read_b128 v[120:123], v23 offset:7168
    v_mfma_f32_16x16x32_bf16 v[52:55], v[100:103], v[140:143], v[52:55]
    ds_read_b128 v[124:127], v23 offset:8192
    v_mfma_f32_16x16x32_bf16 v[56:59], v[104:107], v[140:143], v[56:59]
    s_add_u32 m0, s33, 0x0
    s_add_u32 s30, s31, 0x0
    buffer_load_dwordx4 v13, s[4:7], s30 offen lds
    v_mfma_f32_16x16x32_bf16 v[60:63], v[108:111], v[140:143], v[60:63]
    s_add_u32 m0, s33, 0x400
    s_add_u32 s30, s31, 0x400
    buffer_load_dwordx4 v13, s[4:7], s30 offen lds
    v_mfma_f32_16x16x32_bf16 v[64:67], v[100:103], v[144:147], v[64:67]
    s_add_u32 m0, s33, 0x800
    s_add_u32 s30, s31, 0x800
    buffer_load_dwordx4 v13, s[4:7], s30 offen lds
    v_mfma_f32_16x16x32_bf16 v[68:71], v[104:107], v[144:147], v[68:71]
    v_mfma_f32_16x16x32_bf16 v[72:75], v[108:111], v[144:147], v[72:75]
    s_waitcnt lgkmcnt(0)
    v_mfma_f32_16x16x32_bf16 v[28:31], v[88:91], v[112:115], v[28:31]
    ds_read_b64_tr_b16 v[100:101], v20 offset:10240
    ds_read_b64_tr_b16 v[102:103], v20 offset:11520
    v_mfma_f32_16x16x32_bf16 v[32:35], v[92:95], v[112:115], v[32:35]
    ds_read_b64_tr_b16 v[104:105], v21 offset:10240
    ds_read_b64_tr_b16 v[106:107], v21 offset:11520
    v_mfma_f32_16x16x32_bf16 v[36:39], v[96:99], v[112:115], v[36:39]
    ds_read_b64_tr_b16 v[108:109], v22 offset:10240
    ds_read_b64_tr_b16 v[110:111], v22 offset:11520
    v_mfma_f32_16x16x32_bf16 v[40:43], v[88:91], v[116:119], v[40:43]
    ds_read_b128 v[132:135], v23 offset:14336
    v_mfma_f32_16x16x32_bf16 v[44:47], v[92:95], v[116:119], v[44:47]
    ds_read_b128 v[136:139], v23 offset:15360
    v_mfma_f32_16x16x32_bf16 v[48:51], v[96:99], v[116:119], v[48:51]
    ds_read_b128 v[140:143], v23 offset:16384
    v_mfma_f32_16x16x32_bf16 v[52:55], v[88:91], v[120:123], v[52:55]
    ds_read_b128 v[144:147], v23 offset:17408
    v_mfma_f32_16x16x32_bf16 v[56:59], v[92:95], v[120:123], v[56:59]
    s_add_u32 m0, s33, 0xc00
    s_add_u32 s30, s31, 0xc00
    buffer_load_dwordx4 v13, s[4:7], s30 offen lds
    v_mfma_f32_16x16x32_bf16 v[60:63], v[96:99], v[120:123], v[60:63]
    s_add_u32 m0, s33, 0x1000
    s_add_u32 s30, s31, 0x1000
    s_mov_b32 exec_hi, 0
    buffer_load_dwordx4 v13, s[4:7], s30 offen lds
    s_mov_b32 exec_hi, -1
    v_mfma_f32_16x16x32_bf16 v[64:67], v[88:91], v[124:127], v[64:67]
    s_add_u32 s31, s31, 18432
    s_cmp_ge_u32 s31, 442368
    s_cselect_b32 s31, 0, s31
    v_mfma_f32_16x16x32_bf16 v[68:71], v[92:95], v[124:127], v[68:71]
    v_mfma_f32_16x16x32_bf16 v[72:75], v[96:99], v[124:127], v[72:75]
    s_waitcnt vmcnt(5) lgkmcnt(0)
    s_barrier
    v_mfma_f32_16x16x32_bf16 v[28:31], v[100:103], v[132:135], v[28:31]
    ds_read_b64_tr_b16 v[88:89], v24 offset:0
    ds_read_b64_tr_b16 v[90:91], v24 offset:1280
    v_mfma_f32_16x16x32_bf16 v[32:35], v[104:107], v[132:135], v[32:35]
    ds_read_b64_tr_b16 v[92:93], v25 offset:0
    ds_read_b64_tr_b16 v[94:95], v25 offset:1280
    v_mfma_f32_16x16x32_bf16 v[36:39], v[108:111], v[132:135], v[36:39]
    ds_read_b64_tr_b16 v[96:97], v26 offset:0
    ds_read_b64_tr_b16 v[98:99], v26 offset:1280
    v_mfma_f32_16x16x32_bf16 v[40:43], v[100:103], v[136:139], v[40:43]
    ds_read_b128 v[112:115], v27 offset:5120
    v_mfma_f32_16x16x32_bf16 v[44:47], v[104:107], v[136:139], v[44:47]
    ds_read_b128 v[116:119], v27 offset:6144
    v_mfma_f32_16x16x32_bf16 v[48:51], v[108:111], v[136:139], v[48:51]
    ds_read_b128 v[120:123], v27 offset:7168
    v_mfma_f32_16x16x32_bf16 v[52:55], v[100:103], v[140:143], v[52:55]
    ds_read_b128 v[124:127], v27 offset:8192
    v_mfma_f32_16x16x32_bf16 v[56:59], v[104:107], v[140:143], v[56:59]
    s_add_u32 m0, s33, 0x9800
    s_add_u32 s30, s31, 0x0
    buffer_load_dwordx4 v13, s[4:7], s30 offen lds
    v_mfma_f32_16x16x32_bf16 v[60:63], v[108:111], v[140:143], v[60:63]
    s_add_u32 m0, s33, 0x9c00
    s_add_u32 s30, s31, 0x400
    buffer_load_dwordx4 v13, s[4:7], s30 offen lds
    v_mfma_f32_16x16x32_bf16 v[64:67], v[100:103], v[144:147], v[64:67]
    s_add_u32 m0, s33, 0xa000
    s_add_u32 s30, s31, 0x800
    buffer_load_dwordx4 v13, s[4:7], s30 offen lds
    v_mfma_f32_16x16x32_bf16 v[68:71], v[104:107], v[144:147], v[68:71]
    v_mfma_f32_16x16x32_bf16 v[72:75], v[108:111], v[144:147], v[72:75]
    s_waitcnt lgkmcnt(0)
    v_mfma_f32_16x16x32_bf16 v[28:31], v[88:91], v[112:115], v[28:31]
    ds_read_b64_tr_b16 v[100:101], v24 offset:10240
    ds_read_b64_tr_b16 v[102:103], v24 offset:11520
    v_mfma_f32_16x16x32_bf16 v[32:35], v[92:95], v[112:115], v[32:35]
    ds_read_b64_tr_b16 v[104:105], v25 offset:10240
    ds_read_b64_tr_b16 v[106:107], v25 offset:11520
    v_mfma_f32_16x16x32_bf16 v[36:39], v[96:99], v[112:115], v[36:39]
    ds_read_b64_tr_b16 v[108:109], v26 offset:10240
    ds_read_b64_tr_b16 v[110:111], v26 offset:11520
    v_mfma_f32_16x16x32_bf16 v[40:43], v[88:91], v[116:119], v[40:43]
    ds_read_b128 v[132:135], v27 offset:14336
    v_mfma_f32_16x16x32_bf16 v[44:47], v[92:95], v[116:119], v[44:47]
    ds_read_b128 v[136:139], v27 offset:15360
    v_mfma_f32_16x16x32_bf16 v[48:51], v[96:99], v[116:119], v[48:51]
    ds_read_b128 v[140:143], v27 offset:16384
    v_mfma_f32_16x16x32_bf16 v[52:55], v[88:91], v[120:123], v[52:55]
    ds_read_b128 v[144:147], v27 offset:17408
    v_mfma_f32_16x16x32_bf16 v[56:59], v[92:95], v[120:123], v[56:59]
    s_add_u32 m0, s33, 0xa400
    s_add_u32 s30, s31, 0xc00
    buffer_load_dwordx4 v13, s[4:7], s30 offen lds
    v_mfma_f32_16x16x32_bf16 v[60:63], v[96:99], v[120:123], v[60:63]
    s_add_u32 m0, s33, 0xa800
    s_add_u32 s30, s31, 0x1000
    s_mov_b32 exec_hi, 0
    buffer_load_dwordx4 v13, s[4:7], s30 offen lds
    s_mov_b32 exec_hi, -1
    v_mfma_f32_16x16x32_bf16 v[64:67], v[88:91], v[124:127], v[64:67]
    s_add_u32 s31, s31, 18432
    s_cmp_ge_u32 s31, 442368
    s_cselect_b32 s31, 0, s31
    v_mfma_f32_16x16x32_bf16 v[68:71], v[92:95], v[124:127], v[68:71]
    v_mfma_f32_16x16x32_bf16 v[72:75], v[96:99], v[124:127], v[72:75]
    s_waitcnt vmcnt(5) lgkmcnt(0)
    s_barrier
    v_mfma_f32_16x16x32_bf16 v[28:31], v[100:103], v[132:135], v[28:31]
    ds_read_b64_tr_b16 v[88:89], v16 offset:0
    ds_read_b64_tr_b16 v[90:91], v16 offset:1280
    v_mfma_f32_16x16x32_bf16 v[32:35], v[104:107], v[132:135], v[32:35]
    ds_read_b64_tr_b16 v[92:93], v17 offset:0
    ds_read_b64_tr_b16 v[94:95], v17 offset:1280
    v_mfma_f32_16x16x32_bf16 v[36:39], v[108:111], v[132:135], v[36:39]
    ds_read_b64_tr_b16 v[96:97], v18 offset:0
    ds_read_b64_tr_b16 v[98:99], v18 offset:1280
    v_mfma_f32_16x16x32_bf16 v[40:43], v[100:103], v[136:139], v[40:43]
    ds_read_b128 v[112:115], v19 offset:5120
    v_mfma_f32_16x16x32_bf16 v[44:47], v[104:107], v[136:139], v[44:47]
    ds_read_b128 v[116:119], v19 offset:6144
    v_mfma_f32_16x16x32_bf16 v[48:51], v[108:111], v[136:139], v[48:51]
    ds_read_b128 v[120:123], v19 offset:7168
    v_mfma_f32_16x16x32_bf16 v[52:55], v[100:103], v[140:143], v[52:55]
    ds_read_b128 v[124:127], v19 offset:8192
    v_mfma_f32_16x16x32_bf16 v[56:59], v[104:107], v[140:143], v[56:59]
    s_add_u32 m0, s33, 0x13000
    s_add_u32 s30, s31, 0x0
    buffer_load_dwordx4 v13, s[4:7], s30 offen lds
    v_mfma_f32_16x16x32_bf16 v[60:63], v[108:111], v[140:143], v[60:63]
    s_add_u32 m0, s33, 0x13400
    s_add_u32 s30, s31, 0x400
    buffer_load_dwordx4 v13, s[4:7], s30 offen lds
    v_mfma_f32_16x16x32_bf16 v[64:67], v[100:103], v[144:147], v[64:67]
    s_add_u32 m0, s33, 0x13800
    s_add_u32 s30, s31, 0x800
    buffer_load_dwordx4 v13, s[4:7], s30 offen lds
    v_mfma_f32_16x16x32_bf16 v[68:71], v[104:107], v[144:147], v[68:71]
    v_mfma_f32_16x16x32_bf16 v[72:75], v[108:111], v[144:147], v[72:75]
    s_add_u32 s35, s35, 1
    s_cmp_lt_u32 s35, 7
    s_cbranch_scc1 LB_loop3
    s_waitcnt lgkmcnt(0)
    v_mfma_f32_16x16x32_bf16 v[28:31], v[88:91], v[112:115], v[28:31]
    ds_read_b64_tr_b16 v[100:101], v16 offset:10240
    ds_read_b64_tr_b16 v[102:103], v16 offset:11520
    v_mfma_f32_16x16x32_bf16 v[32:35], v[92:95], v[112:115], v[32:35]
    ds_read_b64_tr_b16 v[104:105], v17 offset:10240
    ds_read_b64_tr_b16 v[106:107], v17 offset:11520
    v_mfma_f32_16x16x32_bf16 v[36:39], v[96:99], v[112:115], v[36:39]
    ds_read_b64_tr_b16 v[108:109], v18 offset:10240
    ds_read_b64_tr_b16 v[110:111], v18 offset:11520
    v_mfma_f32_16x16x32_bf16 v[40:43], v[88:91], v[116:119], v[40:43]
    ds_read_b128 v[132:135], v19 offset:14336
    v_mfma_f32_16x16x32_bf16 v[44:47], v[92:95], v[116:119], v[44:47]
    ds_read_b128 v[136:139], v19 offset:15360
    v_mfma_f32_16x16x32_bf16 v[48:51], v[96:99], v[116:119], v[48:51]
    ds_read_b128 v[140:143], v19 offset:16384
    v_mfma_f32_16x16x32_bf16 v[52:55], v[88:91], v[120:123], v[52:55]
    ds_read_b128 v[144:147], v19 offset:17408
    v_mfma_f32_16x16x32_bf16 v[56:59], v[92:95], v[120:123], v[56:59]
    s_add_u32 m0, s33, 0x13c00
    s_add_u32 s30, s31, 0xc00
    buffer_load_dwordx4 v13, s[4:7], s30 offen lds
    v_mfma_f32_16x16x32_bf16 v[60:63], v[96:99], v[120:123], v[60:63]
    s_add_u32 m0, s33, 0x14000
    s_add_u32 s30, s31, 0x1000
    s_mov_b32 exec_hi, 0
    buffer_load_dwordx4 v13, s[4:7], s30 offen lds
    s_mov_b32 exec_hi, -1
    v_mfma_f32_16x16x32_bf16 v[64:67], v[88:91], v[124:127], v[64:67]
    s_add_u32 s31, s31, 18432
    s_cmp_ge_u32 s31, 442368
    s_cselect_b32 s31, 0, s31
    v_mfma_f32_16x16x32_bf16 v[68:71], v[92:95], v[124:127], v[68:71]
    v_mfma_f32_16x16x32_bf16 v[72:75], v[96:99], v[124:127], v[72:75]
    s_waitcnt vmcnt(5) lgkmcnt(0)
    s_barrier
    v_mfma_f32_16x16x32_bf16 v[28:31], v[100:103], v[132:135], v[28:31]
    ds_read_b64_tr_b16 v[88:89], v20 offset:0
    ds_read_b64_tr_b16 v[90:91], v20 offset:1280
    v_mfma_f32_16x16x32_bf16 v[32:35], v[104:107], v[132:135], v[32:35]
    ds_read_b64_tr_b16 v[92:93], v21 offset:0
    ds_read_b64_tr_b16 v[94:95], v21 offset:1280
    v_mfma_f32_16x16x32_bf16 v[36:39], v[108:111], v[132:135], v[36:39]
    ds_read_b64_tr_b16 v[96:97], v22 offset:0
    ds_read_b64_tr_b16 v[98:99], v22 offset:1280
    v_mfma_f32_16x16x32_bf16 v[40:43], v[100:103], v[136:139], v[40:43]
    ds_read_b128 v[112:115], v23 offset:5120
    v_mfma_f32_16x16x32_bf16 v[44:47], v[104:107], v[136:139], v[44:47]
    ds_read_b128 v[116:119], v23 offset:6144
    v_mfma_f32_16x16x32_bf16 v[48:51], v[108:111], v[136:139], v[48:51]
    ds_read_b128 v[120:123], v23 offset:7168
    v_mfma_f32_16x16x32_bf16 v[52:55], v[100:103], v[140:143], v[52:55]
    ds_read_b128 v[124:127], v23 offset:8192
    v_mfma_f32_16x16x32_bf16 v[56:59], v[104:107], v[140:143], v[56:59]
    v_mfma_f32_16x16x32_bf16 v[60:63], v[108:111], v[140:143], v[60:63]
    v_mfma_f32_16x16x32_bf16 v[64:67], v[100:103], v[144:147], v[64:67]
    v_mfma_f32_16x16x32_bf16 v[68:71], v[104:107], v[144:147], v[68:71]
    v_mfma_f32_16x16x32_bf16 v[72:75], v[108:111], v[144:147], v[72:75]
    s_waitcnt lgkmcnt(0)
    v_mfma_f32_16x16x32_bf16 v[28:31], v[88:91], v[112:115], v[28:31]
    ds_read_b64_tr_b16 v[100:101], v20 offset:10240
    ds_read_b64_tr_b16 v[102:103], v20 offset:11520
    v_mfma_f32_16x16x32_bf16 v[32:35], v[92:95], v[112:115], v[32:35]
    ds_read_b64_tr_b16 v[104:105], v21 offset:10240
    ds_read_b64_tr_b16 v[106:107], v21 offset:11520
    v_mfma_f32_16x16x32_bf16 v[36:39], v[96:99], v[112:115], v[36:39]
    ds_read_b64_tr_b16 v[108:109], v22 offset:10240
    ds_read_b64_tr_b16 v[110:111], v22 offset:11520
    v_mfma_f32_16x16x32_bf16 v[40:43], v[88:91], v[116:119], v[40:43]
    ds_read_b128 v[132:135], v23 offset:14336
    v_mfma_f32_16x16x32_bf16 v[44:47], v[92:95], v[116:119], v[44:47]
    ds_read_b128 v[136:139], v23 offset:15360
    v_mfma_f32_16x16x32_bf16 v[48:51], v[96:99], v[116:119], v[48:51]
    ds_read_b128 v[140:143], v23 offset:16384
    v_mfma_f32_16x16x32_bf16 v[52:55], v[88:91], v[120:123], v[52:55]
    ds_read_b128 v[144:147], v23 offset:17408
    v_mfma_f32_16x16x32_bf16 v[56:59], v[92:95], v[120:123], v[56:59]
    v_mfma_f32_16x16x32_bf16 v[60:63], v[96:99], v[120:123], v[60:63]
    v_mfma_f32_16x16x32_bf16 v[64:67], v[88:91], v[124:127], v[64:67]
    v_mfma_f32_16x16x32_bf16 v[68:71], v[92:95], v[124:127], v[68:71]
    v_mfma_f32_16x16x32_bf16 v[72:75], v[96:99], v[124:127], v[72:75]
    s_waitcnt vmcnt(0) lgkmcnt(0)
    s_barrier
    v_mfma_f32_16x16x32_bf16 v[28:31], v[100:103], v[132:135], v[28:31]
    ds_read_b64_tr_b16 v[88:89], v24 offset:0
    ds_read_b64_tr_b16 v[90:91], v24 offset:1280
    v_mfma_f32_16x16x32_bf16 v[32:35], v[104:107], v[132:135], v[32:35]
    ds_read_b64_tr_b16 v[92:93], v25 offset:0
    ds_read_b64_tr_b16 v[94:95], v25 offset:1280
    v_mfma_f32_16x16x32_bf16 v[36:39], v[108:111], v[132:135], v[36:39]
    ds_read_b64_tr_b16 v[96:97], v26 offset:0
    ds_read_b64_tr_b16 v[98:99], v26 offset:1280
    v_mfma_f32_16x16x32_bf16 v[40:43], v[100:103], v[136:139], v[40:43]
    ds_read_b128 v[112:115], v27 offset:5120
    v_mfma_f32_16x16x32_bf16 v[44:47], v[104:107], v[136:139], v[44:47]
    ds_read_b128 v[116:119], v27 offset:6144
    v_mfma_f32_16x16x32_bf16 v[48:51], v[108:111], v[136:139], v[48:51]
    ds_read_b128 v[120:123], v27 offset:7168
    v_mfma_f32_16x16x32_bf16 v[52:55], v[100:103], v[140:143], v[52:55]
    ds_read_b128 v[124:127], v27 offset:8192
    v_mfma_f32_16x16x32_bf16 v[56:59], v[104:107], v[140:143], v[56:59]
    v_mfma_f32_16x16x32_bf16 v[60:63], v[108:111], v[140:143], v[60:63]
    v_mfma_f32_16x16x32_bf16 v[64:67], v[100:103], v[144:147], v[64:67]
    v_mfma_f32_16x16x32_bf16 v[68:71], v[104:107], v[144:147], v[68:71]
    v_mfma_f32_16x16x32_bf16 v[72:75], v[108:111], v[144:147], v[72:75]
    s_waitcnt lgkmcnt(0)
    v_mfma_f32_16x16x32_bf16 v[28:31], v[88:91], v[112:115], v[28:31]
    ds_read_b64_tr_b16 v[100:101], v24 offset:10240
    ds_read_b64_tr_b16 v[102:103], v24 offset:11520
    v_mfma_f32_16x16x32_bf16 v[32:35], v[92:95], v[112:115], v[32:35]
    ds_read_b64_tr_b16 v[104:105], v25 offset:10240
    ds_read_b64_tr_b16 v[106:107], v25 offset:11520
    v_mfma_f32_16x16x32_bf16 v[36:39], v[96:99], v[112:115], v[36:39]
    ds_read_b64_tr_b16 v[108:109], v26 offset:10240
    ds_read_b64_tr_b16 v[110:111], v26 offset:11520
    v_mfma_f32_16x16x32_bf16 v[40:43], v[88:91], v[116:119], v[40:43]
    ds_read_b128 v[132:135], v27 offset:14336
    v_mfma_f32_16x16x32_bf16 v[44:47], v[92:95], v[116:119], v[44:47]
    ds_read_b128 v[136:139], v27 offset:15360
    v_mfma_f32_16x16x32_bf16 v[48:51], v[96:99], v[116:119], v[48:51]
    ds_read_b128 v[140:143], v27 offset:16384
    v_mfma_f32_16x16x32_bf16 v[52:55], v[88:91], v[120:123], v[52:55]
    ds_read_b128 v[144:147], v27 offset:17408
    v_mfma_f32_16x16x32_bf16 v[56:59], v[92:95], v[120:123], v[56:59]
    v_mfma_f32_16x16x32_bf16 v[60:63], v[96:99], v[120:123], v[60:63]
    v_mfma_f32_16x16x32_bf16 v[64:67], v[88:91], v[124:127], v[64:67]
    v_mfma_f32_16x16x32_bf16 v[68:71], v[92:95], v[124:127], v[68:71]
    v_mfma_f32_16x16x32_bf16 v[72:75], v[96:99], v[124:127], v[72:75]
    s_waitcnt vmcnt(0) lgkmcnt(0)
    s_barrier
    v_mfma_f32_16x16x32_bf16 v[28:31], v[100:103], v[132:135], v[28:31]
    v_mfma_f32_16x16x32_bf16 v[32:35], v[104:107], v[132:135], v[32:35]
    v_mfma_f32_16x16x32_bf16 v[36:39], v[108:111], v[132:135], v[36:39]
    v_mfma_f32_16x16x32_bf16 v[40:43], v[100:103], v[136:139], v[40:43]
    v_mfma_f32_16x16x32_bf16 v[44:47], v[104:107], v[136:139], v[44:47]
    v_mfma_f32_16x16x32_bf16 v[48:51], v[108:111], v[136:139], v[48:51]
    v_mfma_f32_16x16x32_bf16 v[52:55], v[100:103], v[140:143], v[52:55]
    v_mfma_f32_16x16x32_bf16 v[56:59], v[104:107], v[140:143], v[56:59]
    v_mfma_f32_16x16x32_bf16 v[60:63], v[108:111], v[140:143], v[60:63]
    v_mfma_f32_16x16x32_bf16 v[64:67], v[100:103], v[144:147], v[64:67]
    v_mfma_f32_16x16x32_bf16 v[68:71], v[104:107], v[144:147], v[68:71]
    v_mfma_f32_16x16x32_bf16 v[72:75], v[108:111], v[144:147], v[72:75]
    s_nop 7
    s_lshl_b32 s27, s24, 13
    v_add_u32 v4, s27, v1
    s_mul_i32 s28, s37, 65536
    s_cmp_eq_u32 s37, 0
    s_cbranch_scc1 LB_ps_72
    s_add_u32 s30, s28, 0
    v_cvt_pk_bf16_f32 v88, v28, v29
    v_cvt_pk_bf16_f32 v89, v30, v31
    v_cvt_pk_bf16_f32 v90, v44, v45
    v_cvt_pk_bf16_f32 v91, v46, v47
    buffer_store_dwordx4 v[88:91], v4, s[12:15], s30 offen offset:0 sc1
    v_cvt_pk_bf16_f32 v92, v60, v61
    v_cvt_pk_bf16_f32 v93, v62, v63
    buffer_store_dwordx4 v[92:95], v4, s[12:15], s30 offen offset:1024 sc1
LB_ps_72:
    s_cmp_eq_u32 s37, 1
    s_cbranch_scc1 LB_ps_73
    s_add_u32 s30, s28, 2048
    v_cvt_pk_bf16_f32 v96, v32, v33
    v_cvt_pk_bf16_f32 v97, v34, v35
    v_cvt_pk_bf16_f32 v98, v48, v49
    v_cvt_pk_bf16_f32 v99, v50, v51
    buffer_store_dwordx4 v[96:99], v4, s[12:15], s30 offen offset:0 sc1
    v_cvt_pk_bf16_f32 v100, v64, v65
    v_cvt_pk_bf16_f32 v101, v66, v67
    buffer_store_dwordx4 v[100:103], v4, s[12:15], s30 offen offset:1024 sc1
LB_ps_73:
    s_cmp_eq_u32 s37, 2
    s_cbranch_scc1 LB_ps_74
    s_add_u32 s30, s28, 4096
    v_cvt_pk_bf16_f32 v104, v36, v37
    v_cvt_pk_bf16_f32 v105, v38, v39
    v_cvt_pk_bf16_f32 v106, v52, v53
    v_cvt_pk_bf16_f32 v107, v54, v55
    buffer_store_dwordx4 v[104:107], v4, s[12:15], s30 offen offset:0 sc1
    v_cvt_pk_bf16_f32 v108, v68, v69
    v_cvt_pk_bf16_f32 v109, v70, v71
    buffer_store_dwordx4 v[108:111], v4, s[12:15], s30 offen offset:1024 sc1
LB_ps_74:
    s_cmp_eq_u32 s37, 3
    s_cbranch_scc1 LB_ps_75
    s_add_u32 s30, s28, 6144
    v_cvt_pk_bf16_f32 v112, v40, v41
    v_cvt_pk_bf16_f32 v113, v42, v43
    v_cvt_pk_bf16_f32 v114, v56, v57
    v_cvt_pk_bf16_f32 v115, v58, v59
    buffer_store_dwordx4 v[112:115], v4, s[12:15], s30 offen offset:0 sc1
    v_cvt_pk_bf16_f32 v116, v72, v73
    v_cvt_pk_bf16_f32 v117, v74, v75
    buffer_store_dwordx4 v[116:119], v4, s[12:15], s30 offen offset:1024 sc1
LB_ps_75:
    v_and_b32 v5, 15, v0
    v_mul_u32_u24 v5, 0xa00, v5
    v_lshrrev_b32 v6, 4, v0
    v_lshl_add_u32 v5, v6, 3, v5
    s_lshl_b32 s27, s45, 5
    v_add_u32 v5, s27, v5
    s_waitcnt vmcnt(0)
    s_barrier
    s_barrier
    s_cmp_eq_u32 s37, 0
    s_cbranch_scc0 LB_pr_76
    s_add_u32 s30, s52, 0
    buffer_load_dwordx4 v[88:91], v4, s[12:15], s30 offen offset:0 sc1
    s_add_u32 s30, s53, 0
    buffer_load_dwordx4 v[92:95], v4, s[12:15], s30 offen offset:0 sc1
    s_add_u32 s30, s54, 0
    buffer_load_dwordx4 v[96:99], v4, s[12:15], s30 offen offset:0 sc1
    s_add_u32 s30, s52, 0
    buffer_load_dwordx4 v[100:103], v4, s[12:15], s30 offen offset:1024 sc1
    s_add_u32 s30, s53, 0
    buffer_load_dwordx4 v[104:107], v4, s[12:15], s30 offen offset:1024 sc1
    s_add_u32 s30, s54, 0
    buffer_load_dwordx4 v[108:111], v4, s[12:15], s30 offen offset:1024 sc1
    s_waitcnt vmcnt(3)
    v_lshlrev_b32 v6, 16, v88
    v_and_b32 v7, 0xffff0000, v88
    v_add_f32 v28, v28, v6
    v_add_f32 v29, v29, v7
    v_lshlrev_b32 v6, 16, v89
    v_and_b32 v7, 0xffff0000, v89
    v_add_f32 v30, v30, v6
    v_add_f32 v31, v31, v7
    v_lshlrev_b32 v6, 16, v92
    v_and_b32 v7, 0xffff0000, v92
    v_add_f32 v28, v28, v6
    v_add_f32 v29, v29, v7
    v_lshlrev_b32 v6, 16, v93
    v_and_b32 v7, 0xffff0000, v93
    v_add_f32 v30, v30, v6
    v_add_f32 v31, v31, v7
    v_lshlrev_b32 v6, 16, v96
    v_and_b32 v7, 0xffff0000, v96
    v_add_f32 v28, v28, v6
    v_add_f32 v29, v29, v7
    v_lshlrev_b32 v6, 16, v97
    v_and_b32 v7, 0xffff0000, v97
    v_add_f32 v30, v30, v6
    v_add_f32 v31, v31, v7
    v_cvt_pk_bf16_f32 v28, v28, v29
    v_cvt_pk_bf16_f32 v29, v30, v31
    s_mov_b32 s30, 204800
    buffer_store_dwordx2 v[28:29], v5, s[16:19], s30 offen offset:0
    v_lshlrev_b32 v6, 16, v90
    v_and_b32 v7, 0xffff0000, v90
    v_add_f32 v44, v44, v6
    v_add_f32 v45, v45, v7
    v_lshlrev_b32 v6, 16, v91
    v_and_b32 v7, 0xffff0000, v91
    v_add_f32 v46, v46, v6
    v_add_f32 v47, v47, v7
    v_lshlrev_b32 v6, 16, v94
    v_and_b32 v7, 0xffff0000, v94
    v_add_f32 v44, v44, v6
    v_add_f32 v45, v45, v7
    v_lshlrev_b32 v6, 16, v95
    v_and_b32 v7, 0xffff0000, v95
    v_add_f32 v46, v46, v6
    v_add_f32 v47, v47, v7
    v_lshlrev_b32 v6, 16, v98
    v_and_b32 v7, 0xffff0000, v98
    v_add_f32 v44, v44, v6
    v_add_f32 v45, v45, v7
    v_lshlrev_b32 v6, 16, v99
    v_and_b32 v7, 0xffff0000, v99
    v_add_f32 v46, v46, v6
    v_add_f32 v47, v47, v7
    v_cvt_pk_bf16_f32 v44, v44, v45
    v_cvt_pk_bf16_f32 v45, v46, v47
    s_mov_b32 s30, 245760
    buffer_store_dwordx2 v[44:45], v5, s[16:19], s30 offen offset:32
    s_waitcnt vmcnt(2)
    v_lshlrev_b32 v6, 16, v100
    v_and_b32 v7, 0xffff0000, v100
    v_add_f32 v60, v60, v6
    v_add_f32 v61, v61, v7
    v_lshlrev_b32 v6, 16, v101
    v_and_b32 v7, 0xffff0000, v101
    v_add_f32 v62, v62, v6
    v_add_f32 v63, v63, v7
    v_lshlrev_b32 v6, 16, v104
    v_and_b32 v7, 0xffff0000, v104
    v_add_f32 v60, v60, v6
    v_add_f32 v61, v61, v7
    v_lshlrev_b32 v6, 16, v105
    v_and_b32 v7, 0xffff0000, v105
    v_add_f32 v62, v62, v6
    v_add_f32 v63, v63, v7
    v_lshlrev_b32 v6, 16, v108
    v_and_b32 v7, 0xffff0000, v108
    v_add_f32 v60, v60, v6
    v_add_f32 v61, v61, v7
    v_lshlrev_b32 v6, 16, v109
    v_and_b32 v7, 0xffff0000, v109
    v_add_f32 v62, v62, v6
    v_add_f32 v63, v63, v7
    v_cvt_pk_bf16_f32 v60, v60, v61
    v_cvt_pk_bf16_f32 v61, v62, v63
    s_mov_b32 s30, 286720
    buffer_store_dwordx2 v[60:61], v5, s[16:19], s30 offen offset:64
LB_pr_76:
    s_cmp_eq_u32 s37, 1
    s_cbranch_scc0 LB_pr_77
    s_add_u32 s30, s52, 2048
    buffer_load_dwordx4 v[88:91], v4, s[12:15], s30 offen offset:0 sc1
    s_add_u32 s30, s53, 2048
    buffer_load_dwordx4 v[92:95], v4, s[12:15], s30 offen offset:0 sc1
    s_add_u32 s30, s54, 2048
    buffer_load_dwordx4 v[96:99], v4, s[12:15], s30 offen offset:0 sc1
    s_add_u32 s30, s52, 2048
    buffer_load_dwordx4 v[100:103], v4, s[12:15], s30 offen offset:1024 sc1
    s_add_u32 s30, s53, 2048
    buffer_load_dwordx4 v[104:107], v4, s[12:15], s30 offen offset:1024 sc1
    s_add_u32 s30, s54, 2048
    buffer_load_dwordx4 v[108:111], v4, s[12:15], s30 offen offset:1024 sc1
    s_waitcnt vmcnt(3)
    v_lshlrev_b32 v6, 16, v88
    v_and_b32 v7, 0xffff0000, v88
    v_add_f32 v32, v32, v6
    v_add_f32 v33, v33, v7
    v_lshlrev_b32 v6, 16, v89
    v_and_b32 v7, 0xffff0000, v89
    v_add_f32 v34, v34, v6
    v_add_f32 v35, v35, v7
    v_lshlrev_b32 v6, 16, v92
    v_and_b32 v7, 0xffff0000, v92
    v_add_f32 v32, v32, v6
    v_add_f32 v33, v33, v7
    v_lshlrev_b32 v6, 16, v93
    v_and_b32 v7, 0xffff0000, v93
    v_add_f32 v34, v34, v6
    v_add_f32 v35, v35, v7
    v_lshlrev_b32 v6, 16, v96
    v_and_b32 v7, 0xffff0000, v96
    v_add_f32 v32, v32, v6
    v_add_f32 v33, v33, v7
    v_lshlrev_b32 v6, 16, v97
    v_and_b32 v7, 0xffff0000, v97
    v_add_f32 v34, v34, v6
    v_add_f32 v35, v35, v7
    v_cvt_pk_bf16_f32 v32, v32, v33
    v_cvt_pk_bf16_f32 v33, v34, v35
    s_mov_b32 s30, 204800
    buffer_store_dwordx2 v[32:33], v5, s[16:19], s30 offen offset:32
    v_lshlrev_b32 v6, 16, v90
    v_and_b32 v7, 0xffff0000, v90
    v_add_f32 v48, v48, v6
    v_add_f32 v49, v49, v7
    v_lshlrev_b32 v6, 16, v91
    v_and_b32 v7, 0xffff0000, v91
    v_add_f32 v50, v50, v6
    v_add_f32 v51, v51, v7
    v_lshlrev_b32 v6, 16, v94
    v_and_b32 v7, 0xffff0000, v94
    v_add_f32 v48, v48, v6
    v_add_f32 v49, v49, v7
    v_lshlrev_b32 v6, 16, v95
    v_and_b32 v7, 0xffff0000, v95
    v_add_f32 v50, v50, v6
    v_add_f32 v51, v51, v7
    v_lshlrev_b32 v6, 16, v98
    v_and_b32 v7, 0xffff0000, v98
    v_add_f32 v48, v48, v6
    v_add_f32 v49, v49, v7
    v_lshlrev_b32 v6, 16, v99
    v_and_b32 v7, 0xffff0000, v99
    v_add_f32 v50, v50, v6
    v_add_f32 v51, v51, v7
    v_cvt_pk_bf16_f32 v48, v48, v49
    v_cvt_pk_bf16_f32 v49, v50, v51
    s_mov_b32 s30, 245760
    buffer_store_dwordx2 v[48:49], v5, s[16:19], s30 offen offset:64
    s_waitcnt vmcnt(2)
    v_lshlrev_b32 v6, 16, v100
    v_and_b32 v7, 0xffff0000, v100
    v_add_f32 v64, v64, v6
    v_add_f32 v65, v65, v7
    v_lshlrev_b32 v6, 16, v101
    v_and_b32 v7, 0xffff0000, v101
    v_add_f32 v66, v66, v6
    v_add_f32 v67, v67, v7
    v_lshlrev_b32 v6, 16, v104
    v_and_b32 v7, 0xffff0000, v104
    v_add_f32 v64, v64, v6
    v_add_f32 v65, v65, v7
    v_lshlrev_b32 v6, 16, v105
    v_and_b32 v7, 0xffff0000, v105
    v_add_f32 v66, v66, v6
    v_add_f32 v67, v67, v7
    v_lshlrev_b32 v6, 16, v108
    v_and_b32 v7, 0xffff0000, v108
    v_add_f32 v64, v64, v6
    v_add_f32 v65, v65, v7
    v_lshlrev_b32 v6, 16, v109
    v_and_b32 v7, 0xffff0000, v109
    v_add_f32 v66, v66, v6
    v_add_f32 v67, v67, v7
    v_cvt_pk_bf16_f32 v64, v64, v65
    v_cvt_pk_bf16_f32 v65, v66, v67
    s_mov_b32 s30, 327680
    buffer_store_dwordx2 v[64:65], v5, s[16:19], s30 offen offset:0
LB_pr_77:
    s_cmp_eq_u32 s37, 2
    s_cbranch_scc0 LB_pr_78
    s_add_u32 s30, s52, 4096
    buffer_load_dwordx4 v[88:91], v4, s[12:15], s30 offen offset:0 sc1
    s_add_u32 s30, s53, 4096
    buffer_load_dwordx4 v[92:95], v4, s[12:15], s30 offen offset:0 sc1
    s_add_u32 s30, s54, 4096
    buffer_load_dwordx4 v[96:99], v4, s[12:15], s30 offen offset:0 sc1
    s_add_u32 s30, s52, 4096
    buffer_load_dwordx4 v[100:103], v4, s[12:15], s30 offen offset:1024 sc1
    s_add_u32 s30, s53, 4096
    buffer_load_dwordx4 v[104:107], v4, s[12:15], s30 offen offset:1024 sc1
    s_add_u32 s30, s54, 4096
    buffer_load_dwordx4 v[108:111], v4, s[12:15], s30 offen offset:1024 sc1
    s_waitcnt vmcnt(3)
    v_lshlrev_b32 v6, 16, v88
    v_and_b32 v7, 0xffff0000, v88
    v_add_f32 v36, v36, v6
    v_add_f32 v37, v37, v7
    v_lshlrev_b32 v6, 16, v89
    v_and_b32 v7, 0xffff0000, v89
    v_add_f32 v38, v38, v6
    v_add_f32 v39, v39, v7
    v_lshlrev_b32 v6, 16, v92
    v_and_b32 v7, 0xffff0000, v92
    v_add_f32 v36, v36, v6
    v_add_f32 v37, v37, v7
    v_lshlrev_b32 v6, 16, v93
    v_and_b32 v7, 0xffff0000, v93
    v_add_f32 v38, v38, v6
    v_add_f32 v39, v39, v7
    v_lshlrev_b32 v6, 16, v96
    v_and_b32 v7, 0xffff0000, v96
    v_add_f32 v36, v36, v6
    v_add_f32 v37, v37, v7
    v_lshlrev_b32 v6, 16, v97
    v_and_b32 v7, 0xffff0000, v97
    v_add_f32 v38, v38, v6
    v_add_f32 v39, v39, v7
    v_cvt_pk_bf16_f32 v36, v36, v37
    v_cvt_pk_bf16_f32 v37, v38, v39
    s_mov_b32 s30, 204800
    buffer_store_dwordx2 v[36:37], v5, s[16:19], s30 offen offset:64
    v_lshlrev_b32 v6, 16, v90
    v_and_b32 v7, 0xffff0000, v90
    v_add_f32 v52, v52, v6
    v_add_f32 v53, v53, v7
    v_lshlrev_b32 v6, 16, v91
    v_and_b32 v7, 0xffff0000, v91
    v_add_f32 v54, v54, v6
    v_add_f32 v55, v55, v7
    v_lshlrev_b32 v6, 16, v94
    v_and_b32 v7, 0xffff0000, v94
    v_add_f32 v52, v52, v6
    v_add_f32 v53, v53, v7
    v_lshlrev_b32 v6, 16, v95
    v_and_b32 v7, 0xffff0000, v95
    v_add_f32 v54, v54, v6
    v_add_f32 v55, v55, v7
    v_lshlrev_b32 v6, 16, v98
    v_and_b32 v7, 0xffff0000, v98
    v_add_f32 v52, v52, v6
    v_add_f32 v53, v53, v7
    v_lshlrev_b32 v6, 16, v99
    v_and_b32 v7, 0xffff0000, v99
    v_add_f32 v54, v54, v6
    v_add_f32 v55, v55, v7
    v_cvt_pk_bf16_f32 v52, v52, v53
    v_cvt_pk_bf16_f32 v53, v54, v55
    s_mov_b32 s30, 286720
    buffer_store_dwordx2 v[52:53], v5, s[16:19], s30 offen offset:0
    s_waitcnt vmcnt(2)
    v_lshlrev_b32 v6, 16, v100
    v_and_b32 v7, 0xffff0000, v100
    v_add_f32 v68, v68, v6
    v_add_f32 v69, v69, v7
    v_lshlrev_b32 v6, 16, v101
    v_and_b32 v7, 0xffff0000, v101
    v_add_f32 v70, v70, v6
    v_add_f32 v71, v71, v7
    v_lshlrev_b32 v6, 16, v104
    v_and_b32 v7, 0xffff0000, v104
    v_add_f32 v68, v68, v6
    v_add_f32 v69, v69, v7
    v_lshlrev_b32 v6, 16, v105
    v_and_b32 v7, 0xffff0000, v105
    v_add_f32 v70, v70, v6
    v_add_f32 v71, v71, v7
    v_lshlrev_b32 v6, 16, v108
    v_and_b32 v7, 0xffff0000, v108
    v_add_f32 v68, v68, v6
    v_add_f32 v69, v69, v7
    v_lshlrev_b32 v6, 16, v109
    v_and_b32 v7, 0xffff0000, v109
    v_add_f32 v70, v70, v6
    v_add_f32 v71, v71, v7
    v_cvt_pk_bf16_f32 v68, v68, v69
    v_cvt_pk_bf16_f32 v69, v70, v71
    s_mov_b32 s30, 327680
    buffer_store_dwordx2 v[68:69], v5, s[16:19], s30 offen offset:32
LB_pr_78:
    s_cmp_eq_u32 s37, 3
    s_cbranch_scc0 LB_pr_79
    s_add_u32 s30, s52, 6144
    buffer_load_dwordx4 v[88:91], v4, s[12:15], s30 offen offset:0 sc1
    s_add_u32 s30, s53, 6144
    buffer_load_dwordx4 v[92:95], v4, s[12:15], s30 offen offset:0 sc1
    s_add_u32 s30, s54, 6144
    buffer_load_dwordx4 v[96:99], v4, s[12:15], s30 offen offset:0 sc1
    s_add_u32 s30, s52, 6144
    buffer_load_dwordx4 v[100:103], v4, s[12:15], s30 offen offset:1024 sc1
    s_add_u32 s30, s53, 6144
    buffer_load_dwordx4 v[104:107], v4, s[12:15], s30 offen offset:1024 sc1
    s_add_u32 s30, s54, 6144
    buffer_load_dwordx4 v[108:111], v4, s[12:15], s30 offen offset:1024 sc1
    s_waitcnt vmcnt(3)
    v_lshlrev_b32 v6, 16, v88
    v_and_b32 v7, 0xffff0000, v88
    v_add_f32 v40, v40, v6
    v_add_f32 v41, v41, v7
    v_lshlrev_b32 v6, 16, v89
    v_and_b32 v7, 0xffff0000, v89
    v_add_f32 v42, v42, v6
    v_add_f32 v43, v43, v7
    v_lshlrev_b32 v6, 16, v92
    v_and_b32 v7, 0xffff0000, v92
    v_add_f32 v40, v40, v6
    v_add_f32 v41, v41, v7
    v_lshlrev_b32 v6, 16, v93
    v_and_b32 v7, 0xffff0000, v93
    v_add_f32 v42, v42, v6
    v_add_f32 v43, v43, v7
    v_lshlrev_b32 v6, 16, v96
    v_and_b32 v7, 0xffff0000, v96
    v_add_f32 v40, v40, v6
    v_add_f32 v41, v41, v7
    v_lshlrev_b32 v6, 16, v97
    v_and_b32 v7, 0xffff0000, v97
    v_add_f32 v42, v42, v6
    v_add_f32 v43, v43, v7
    v_cvt_pk_bf16_f32 v40, v40, v41
    v_cvt_pk_bf16_f32 v41, v42, v43
    s_mov_b32 s30, 245760
    buffer_store_dwordx2 v[40:41], v5, s[16:19], s30 offen offset:0
    v_lshlrev_b32 v6, 16, v90
    v_and_b32 v7, 0xffff0000, v90
    v_add_f32 v56, v56, v6
    v_add_f32 v57, v57, v7
    v_lshlrev_b32 v6, 16, v91
    v_and_b32 v7, 0xffff0000, v91
    v_add_f32 v58, v58, v6
    v_add_f32 v59, v59, v7
    v_lshlrev_b32 v6, 16, v94
    v_and_b32 v7, 0xffff0000, v94
    v_add_f32 v56, v56, v6
    v_add_f32 v57, v57, v7
    v_lshlrev_b32 v6, 16, v95
    v_and_b32 v7, 0xffff0000, v95
    v_add_f32 v58, v58, v6
    v_add_f32 v59, v59, v7
    v_lshlrev_b32 v6, 16, v98
    v_and_b32 v7, 0xffff0000, v98
    v_add_f32 v56, v56, v6
    v_add_f32 v57, v57, v7
    v_lshlrev_b32 v6, 16, v99
    v_and_b32 v7, 0xffff0000, v99
    v_add_f32 v58, v58, v6
    v_add_f32 v59, v59, v7
    v_cvt_pk_bf16_f32 v56, v56, v57
    v_cvt_pk_bf16_f32 v57, v58, v59
    s_mov_b32 s30, 286720
    buffer_store_dwordx2 v[56:57], v5, s[16:19], s30 offen offset:32
    s_waitcnt vmcnt(2)
    v_lshlrev_b32 v6, 16, v100
    v_and_b32 v7, 0xffff0000, v100
    v_add_f32 v72, v72, v6
    v_add_f32 v73, v73, v7
    v_lshlrev_b32 v6, 16, v101
    v_and_b32 v7, 0xffff0000, v101
    v_add_f32 v74, v74, v6
    v_add_f32 v75, v75, v7
    v_lshlrev_b32 v6, 16, v104
    v_and_b32 v7, 0xffff0000, v104
    v_add_f32 v72, v72, v6
    v_add_f32 v73, v73, v7
    v_lshlrev_b32 v6, 16, v105
    v_and_b32 v7, 0xffff0000, v105
    v_add_f32 v74, v74, v6
    v_add_f32 v75, v75, v7
    v_lshlrev_b32 v6, 16, v108
    v_and_b32 v7, 0xffff0000, v108
    v_add_f32 v72, v72, v6
    v_add_f32 v73, v73, v7
    v_lshlrev_b32 v6, 16, v109
    v_and_b32 v7, 0xffff0000, v109
    v_add_f32 v74, v74, v6
    v_add_f32 v75, v75, v7
    v_cvt_pk_bf16_f32 v72, v72, v73
    v_cvt_pk_bf16_f32 v73, v74, v75
    s_mov_b32 s30, 327680
    buffer_store_dwordx2 v[72:73], v5, s[16:19], s30 offen offset:64
LB_pr_79:
    s_endpgm
LB_end:
    s_endpgm
.section .rodata,"a"
.p2align 6
.amdhsa_kernel attn_kernel
  .amdhsa_next_free_vgpr 256
  .amdhsa_next_free_sgpr 102
  .amdhsa_accum_offset 256
  .amdhsa_group_segment_fixed_size 0
  .amdhsa_kernarg_size 104
  .amdhsa_user_sgpr_count 2
  .amdhsa_user_sgpr_kernarg_segment_ptr 1
  .amdhsa_system_sgpr_workgroup_id_x 1
.end_amdhsa_kernel
.p2align 6
.amdhsa_kernel oproj_kernel
  .amdhsa_next_free_vgpr 152
  .amdhsa_next_free_sgpr 102
  .amdhsa_accum_offset 152
  .amdhsa_group_segment_fixed_size 0
  .amdhsa_kernarg_size 104
  .amdhsa_user_sgpr_count 2
  .amdhsa_user_sgpr_kernarg_segment_ptr 1
  .amdhsa_system_sgpr_workgroup_id_x 1
.end_amdhsa_kernel
```
